```python
import torch

def _softmax(x, axis=-1):
    return torch.softmax(x, dim=axis)
def _gelu(x):
    return torch.nn.functional.gelu(x, approximate="tanh")
def _silu(x):
    return torch.nn.functional.silu(x)
def _sigmoid(x):
    return torch.sigmoid(x)
def _layernorm(x, axis=-1, eps=1e-5):
    m = x.mean(dim=axis, keepdim=True)
    v = x.var(dim=axis, keepdim=True, unbiased=False)
    return (x - m) / torch.sqrt(v + eps)
def _scatter_add(tgt, idx, src, axis=0):
    return tgt.clone().index_add_(axis, idx, src)
def _segment_sum(src, seg, n):
    out = torch.zeros((n,) + src.shape[1:], dtype=src.dtype)
    return out.index_add_(0, seg, src)
def _pad(x, pw):
    flat = tuple(v for pair in reversed(pw) for v in pair)
    return torch.nn.functional.pad(x, flat)

kernel_name = 'recurrent_scan__sliding_local_dilated__dense_activation_squared_relu__prompt'

def setup_inputs():

    _w = (lambda a: (lambda t: t.to(torch.bfloat16) if t.is_floating_point() else t)(torch.as_tensor(a)))
    def _A_setup():
        B, S, D = 1, 2048, 512
        return {
            "x": _w((lambda *s: torch.randn(*s, dtype=torch.bfloat16) * 0.05)(B, S, D)),
            "wqkv": _w((lambda *s: torch.randn(*s, dtype=torch.bfloat16) * 0.05)(D, 3 * D)),
            "wo": _w((lambda *s: torch.randn(*s, dtype=torch.bfloat16) * 0.05)(D, D)),
        }
    _A_in = _A_setup()

    def _B_setup():
        B, S, D, F = 1, 2048, 512, 1792
        return {
            "x": _w((lambda *s: torch.randn(*s, dtype=torch.bfloat16) * 0.05)(B, S, D)),
            "w1": _w((lambda *s: torch.randn(*s, dtype=torch.bfloat16) * 0.05)(D, F)),
            "b1": _w((lambda *s: torch.randn(*s, dtype=torch.bfloat16) * 0.4)(F)),
            "w2": _w((lambda *s: torch.randn(*s, dtype=torch.bfloat16) * 0.05)(F, D)),
            "b2": _w((lambda *s: torch.randn(*s, dtype=torch.bfloat16) * 0.8)(D)),
        }
    _B_in = _B_setup()

    return {
        "A_x": _A_in["x"],
        "A_wqkv": _A_in["wqkv"],
        "A_wo": _A_in["wo"],
        "B_x": _B_in["x"],
        "B_w1": _B_in["w1"],
        "B_b1": _B_in["b1"],
        "B_w2": _B_in["w2"],
        "B_b2": _B_in["b2"],
    }

def reference(A_x, A_wqkv, A_wo, B_x, B_w1, B_b1, B_w2, B_b2):
    def _A_ref(x, wqkv, wo):
        B, S, D = x.shape
        H = 32; Dh = D // H
        W, dil = 8, 2
        qkv = (lambda x, *d: x.permute(*d))((x @ wqkv).reshape(B, S, 3, H, Dh), 2, 0, 3, 1, 4)
        q, k, v = qkv[0], qkv[1], qkv[2]
        scale = Dh ** -0.5
        pos = torch.arange(S)
        off = torch.arange(W) * dil
        idx = pos[:, None] - off[None, :]
        mask = idx >= 0
        idx_c = torch.where(mask, idx, 0).reshape(-1)
        kg = k[:, :, idx_c, :].reshape(B, H, S, W, Dh)
        vg = v[:, :, idx_c, :].reshape(B, H, S, W, Dh)
        logits = torch.einsum("bhsd,bhswd->bhsw", q, kg) * scale
        logits = torch.where(mask[None, None, :, :], logits, -1e9)
        attn = _softmax(logits, axis=-1)
        o = torch.einsum("bhsw,bhswd->bhsd", attn, vg)
        return (lambda x, *d: x.permute(*d))(o, 0, 2, 1, 3).reshape(B, S, D) @ wo

    def _B_ref(x, w1, b1, w2, b2):
        h = torch.einsum("bsd,df->bsf", x, w1) + b1
        zero = torch.zeros_like(h)
        r = torch.where(h > zero, h, zero)
        h = r * r
        out = torch.einsum("bsf,fd->bsd", h, w2) + b2
        return out

    x = A_x
    xn = _layernorm(x, axis=-1)
    s = _A_ref(xn, A_wqkv, A_wo)
    g = _silu(_B_ref(xn, B_w1, B_b1, B_w2, B_b2))
    return x + s * g
```

```asm
; @launch grid=(256,1,1) block=(256,1,1) lds=163840
.amdgcn_target "amdgcn-amd-amdhsa--gfx950"
.text
.globl recurrent_scan__sliding_local_dilated__dense_activation_squared_relu__prompt_kernel
.p2align 8
.type recurrent_scan__sliding_local_dilated__dense_activation_squared_relu__prompt_kernel,@function
recurrent_scan__sliding_local_dilated__dense_activation_squared_relu__prompt_kernel:
L_START:
    s_load_dwordx16 s[4:19], s[0:1], 0
    s_load_dwordx4 s[20:23], s[0:1], 64
    s_load_dwordx2 s[24:25], s[0:1], 80
    s_cmp_ge_u32 s2, 256
    s_cbranch_scc1 L_END
    s_getpc_b64 s[74:75]
L_PCREF:
    s_lshr_b32 s76, s2, 3
    s_lshl_b32 s76, s76, 11
    v_and_b32 v8, 15, v0
    v_lshlrev_b32 v8, 7, v8
    v_add_u32 v9, s76, v8
    v_cmp_gt_u32 vcc, 16, v0
    v_lshlrev_b32 v8, 7, v0
    v_min_u32 v8, L_EARLY_END-L_PCREF, v8
    v_min_u32 v9, L_CODE_END-L_PCREF-4, v9
    v_cndmask_b32 v8, v8, v9, vcc
    global_load_dword v253, v8, s[74:75]
    s_memrealtime s[66:67]
    v_lshrrev_b32 v2, 6, v0
    v_and_b32 v1, 63, v0
    v_readfirstlane_b32 s60, v2
    s_and_b32 s74, s2, 7
    s_lshr_b32 s3, s2, 3
    s_and_b32 s76, s3, 7
    s_lshr_b32 s77, s3, 3
    s_lshr_b32 s63, s3, 4
    s_xor_b32 s63, s63, 1
    s_and_b32 s61, s3, 15
    s_mov_b32 s62, s74
    s_lshr_b32 s64, s74, 1
    s_lshl_b32 s64, s64, 3
    s_add_u32 s64, s64, s76
    s_and_b32 s65, s74, 1
    s_lshl_b32 s65, s65, 2
    s_add_u32 s65, s65, s77
    s_lshr_b32 s68, s60, 1
    s_and_b32 s69, s60, 1
    s_lshl_b32 s86, s61, 4
    s_add_u32 s86, s86, s62
    s_lshl_b32 s75, s63, 3
    s_add_u32 s86, s86, s75
    s_lshl_b32 s75, s86, 2
    s_add_u32 s75, s75, s60
    s_lshl_b32 s76, s75, 11
    v_lshlrev_b32 v63, 4, v1
    v_add_u32 v37, s76, v63
    s_cmp_eq_u32 s63, 1
    s_movk_i32 s75, 3584
    s_cselect_b32 s75, s75, 3072
    s_movk_i32 s76, 448
    s_cselect_b32 s76, s76, 128
    s_cselect_b32 s77, 7, 10
    s_movk_i32 s78, 444
    s_cselect_b32 s78, s78, 2048
    s_mul_i32 s76, s76, s62
    s_lshl_b32 s90, s61, 2
    s_add_u32 s90, s90, s60
    s_lshl_b32 s90, s90, 3
    v_lshrrev_b32 v2, 2, v1
    v_add_u32 v2, s90, v2
    v_mul_u32_u24 v2, s75, v2
    v_and_b32 v3, 3, v1
    v_lshlrev_b32 v3, s77, v3
    v_min_u32 v3, s78, v3
    v_add3_u32 v2, v2, v3, s76
    v_mov_b32 v3, 2146435072
    v_cmp_gt_u32 vcc, 32, v1
    s_cmp_lt_u32 s61, 16
    s_cselect_b32 s90, 0, 2146435072
    s_cselect_b32 s79, 2146435072, 0
    v_cndmask_b32 v232, v3, v2, vcc
    s_cmp_eq_u32 s63, 1
    s_waitcnt lgkmcnt(0)
    s_cselect_b32 s32, s12, s6
    s_cselect_b32 s33, s13, s7
    s_mov_b32 s34, 1572864
    s_cselect_b32 s34, 1835008, s34
    s_mov_b32 s35, 0x00020000
    s_mov_b32 s28, s4
    s_mov_b32 s29, s5
    s_mov_b32 s30, 2097152
    s_mov_b32 s31, 0x00020000
    buffer_load_dword v253, v232, s[32:35], s90 offen
    buffer_load_dwordx4 v[204:207], v37, s[28:31], 0 offen
    buffer_load_dwordx4 v[208:211], v37, s[28:31], 0 offen offset:1024
    s_mov_b32 s40, s22
    s_mov_b32 s41, s23
    s_mov_b32 s42, 256
    s_mov_b32 s43, 0x00020000
    s_or_b32 s66, s66, 1
    v_mov_b32 v2, s66
    v_mov_b32 v3, s67
    v_mov_b32 v4, 0
    v_mov_b32 v5, 0
    v_or_b32 v6, s3, v0
    v_mov_b32 v7, 2146435072
    v_cmp_eq_u32 vcc, 0, v6
    s_nop 1
    v_cndmask_b32 v6, v7, v6, vcc
    buffer_atomic_cmpswap_x2 v[2:5], v6, s[40:43], 0 offen sc1
    s_cmp_eq_u32 s63, 1
    s_cselect_b32 s44, s14, s12
    s_cselect_b32 s45, s15, s13
    s_movk_i32 s46, 3584
    s_cselect_b32 s46, s46, 1835008
    s_mov_b32 s47, 0x00020000
    s_cmp_eq_u32 s63, 0
    s_cbranch_scc0 L_FFN
    v_lshrrev_b32 v2, 3, v1
    s_lshl_b32 s74, s69, 3
    v_add_u32 v2, s74, v2
    v_lshrrev_b32 v3, 1, v2
    v_and_b32 v4, 7, v1
    v_xor_b32 v3, v3, v4
    v_lshlrev_b32 v3, 4, v3
    v_lshl_add_u32 v4, v2, 11, v3
    s_lshl_b32 s74, s61, 17
    s_xor_b32 s75, s68, 1
    s_lshl_b32 s75, s75, 10
    s_add_u32 s75, s74, s75
    v_add_u32 v10, s75, v4
    v_add_u32 v11, 32768, v10
    v_add_u32 v12, 65536, v10
    v_add_u32 v13, 98304, v10
    v_lshrrev_b32 v5, 3, v1
    v_lshlrev_b32 v5, 1, v5
    s_lshl_b32 s75, s61, 7
    s_add_u32 s75, s75, s69
    s_sub_u32 s75, s75, 16
    v_add_u32 v5, s75, v5
    v_max_i32 v5, 0, v5
    v_lshl_add_u32 v5, v5, 10, v3
    s_lshl_b32 s27, s60, 10
    s_cmp_eq_u32 s68, 0
    s_cselect_b32 s75, 0, 2146435072
    s_cselect_b32 s26, 1, 0
    s_cselect_b32 s27, s27, 159744
    v_or_b32 v14, s75, v5
    s_xor_b32 s75, s68, 1
    s_lshl_b32 s75, s75, 2
    s_add_u32 s75, s75, s60
    s_lshl_b32 s72, s75, 10
    s_mul_i32 s74, s60, 49152
    s_lshl_b32 s75, s62, 7
    s_add_u32 s74, s74, s75
    s_movk_i32 s76, 171
    s_movk_i32 s77, 3072
    s_mul_i32 s73, s60, 6144
    s_add_u32 s73, s73, 18432
    v_lshrrev_b32 v9, 3, v1
    v_and_b32 v7, 7, v1
    v_mov_b32 v6, s74
    v_add_u32 v2, 0, v9
    v_mul_u32_u24 v3, s76, v2
    v_lshrrev_b32 v3, 9, v3
    v_mul_u32_u24 v4, 3, v3
    v_sub_u32 v4, v2, v4
    v_and_b32 v5, 2, v3
    v_lshrrev_b32 v8, 1, v3
    v_and_b32 v8, 4, v8
    v_or3_b32 v5, v5, v8, 0
    v_xor_b32 v5, v5, v7
    v_mad_u32_u24 v3, v3, s77, v6
    v_lshl_add_u32 v3, v4, 10, v3
    v_lshl_add_u32 v15, v5, 4, v3
    v_add_u32 v2, 8, v9
    v_mul_u32_u24 v3, s76, v2
    v_lshrrev_b32 v3, 9, v3
    v_mul_u32_u24 v4, 3, v3
    v_sub_u32 v4, v2, v4
    v_and_b32 v5, 2, v3
    v_lshrrev_b32 v8, 1, v3
    v_and_b32 v8, 4, v8
    v_or3_b32 v5, v5, v8, 0
    v_xor_b32 v5, v5, v7
    v_mad_u32_u24 v3, v3, s77, v6
    v_lshl_add_u32 v3, v4, 10, v3
    v_lshl_add_u32 v16, v5, 4, v3
    v_add_u32 v2, 16, v9
    v_mul_u32_u24 v3, s76, v2
    v_lshrrev_b32 v3, 9, v3
    v_mul_u32_u24 v4, 3, v3
    v_sub_u32 v4, v2, v4
    v_and_b32 v5, 2, v3
    v_lshrrev_b32 v8, 1, v3
    v_and_b32 v8, 4, v8
    v_or3_b32 v5, v5, v8, 0
    v_xor_b32 v5, v5, v7
    v_mad_u32_u24 v3, v3, s77, v6
    v_lshl_add_u32 v3, v4, 10, v3
    v_lshl_add_u32 v17, v5, 4, v3
    v_add_u32 v2, 24, v9
    v_mul_u32_u24 v3, s76, v2
    v_lshrrev_b32 v3, 9, v3
    v_mul_u32_u24 v4, 3, v3
    v_sub_u32 v4, v2, v4
    v_and_b32 v5, 2, v3
    v_lshrrev_b32 v8, 1, v3
    v_and_b32 v8, 4, v8
    v_or3_b32 v5, v5, v8, 0
    v_xor_b32 v5, v5, v7
    v_mad_u32_u24 v3, v3, s77, v6
    v_lshl_add_u32 v3, v4, 10, v3
    v_lshl_add_u32 v18, v5, 4, v3
    v_add_u32 v2, 32, v9
    v_mul_u32_u24 v3, s76, v2
    v_lshrrev_b32 v3, 9, v3
    v_mul_u32_u24 v4, 3, v3
    v_sub_u32 v4, v2, v4
    v_and_b32 v5, 2, v3
    v_lshrrev_b32 v8, 1, v3
    v_and_b32 v8, 4, v8
    v_or3_b32 v5, v5, v8, 0
    v_xor_b32 v5, v5, v7
    v_mad_u32_u24 v3, v3, s77, v6
    v_lshl_add_u32 v3, v4, 10, v3
    v_lshl_add_u32 v19, v5, 4, v3
    v_add_u32 v2, 40, v9
    v_mul_u32_u24 v3, s76, v2
    v_lshrrev_b32 v3, 9, v3
    v_mul_u32_u24 v4, 3, v3
    v_sub_u32 v4, v2, v4
    v_and_b32 v5, 2, v3
    v_lshrrev_b32 v8, 1, v3
    v_and_b32 v8, 4, v8
    v_or3_b32 v5, v5, v8, 0
    v_xor_b32 v5, v5, v7
    v_mad_u32_u24 v3, v3, s77, v6
    v_lshl_add_u32 v3, v4, 10, v3
    v_lshl_add_u32 v20, v5, 4, v3
    v_and_b32 v2, 15, v1
    v_lshrrev_b32 v3, 4, v1
    v_lshrrev_b32 v4, 1, v2
    v_xor_b32 v4, v4, v3
    v_lshlrev_b32 v4, 4, v4
    v_lshl_add_u32 v4, v2, 7, v4
    v_xor_b32 v5, 64, v4
    v_add_u32 v22, 0, v4
    v_add_u32 v23, 0, v5
    v_add_u32 v24, 45056, v4
    v_add_u32 v25, 45056, v5
    v_add_u32 v26, 90112, v4
    v_add_u32 v27, 90112, v5
    v_lshrrev_b32 v4, 2, v2
    v_lshl_add_u32 v4, v3, 3, v4
    v_and_b32 v5, 3, v2
    v_lshlrev_b32 v5, 3, v5
    s_movk_i32 s74, 384
    v_mad_u32_u24 v4, v4, s74, v5
    v_lshrrev_b32 v6, 3, v2
    v_and_b32 v7, 1, v3
    v_lshl_or_b32 v6, v7, 1, v6
    v_xor_b32 v6, s60, v6
    v_lshl_add_u32 v4, v6, 5, v4
    v_add_u32 v28, 18432, v4
    v_add_u32 v31, 63488, v4
    v_add_u32 v34, 108544, v4
    v_and_b32 v2, 7, v1
    v_cmp_eq_u32 s[88:89], 0, v2
    v_mov_b32 v46, 0x3f803f80
    v_mov_b32 v47, 0x3f803f80
    v_mov_b32 v48, 0x3f803f80
    v_mov_b32 v49, 0x3f803f80
    v_mov_b32 v3, 2146435072
    s_lshl_b32 s74, s61, 2
    s_add_u32 s74, s74, s60
    s_mul_i32 s74, s74, 28672
    s_mul_i32 s75, s62, 448
    s_mov_b32 s70, 0
    s_mov_b32 s71, 0
    s_add_u32 m0, s72, 0
    s_add_u32 s74, s74, s75
    buffer_load_dwordx4 v10, s[28:31], s70 offen lds
    v_lshlrev_b32 v2, 4, v1
    v_add_u32 v2, s74, v2
    v_add_u32 v4, 3136, v2
    v_cmp_gt_u32 vcc, 28, v1
    s_nop 1
    v_cndmask_b32 v2, v4, v2, vcc
    v_cmp_gt_u32 vcc, 56, v1
    s_nop 1
    v_cndmask_b32 v226, v3, v2, vcc
    v_mov_b32 v3, 2146435072
    v_and_b32 v2, 15, v1
    v_lshrrev_b32 v4, 4, v1
    v_lshrrev_b32 v5, 3, v2
    v_lshl_add_u32 v5, v4, 2, v5
    s_add_u32 m0, s72, 4096
    v_lshlrev_b32 v5, 10, v5
    buffer_load_dwordx4 v11, s[28:31], s70 offen lds
    v_bfe_u32 v6, v2, 2, 1
    s_movk_i32 s74, 448
    v_mad_u32_u24 v5, v6, s74, v5
    v_and_b32 v6, 3, v2
    v_lshl_add_u32 v5, v6, 3, v5
    s_lshl_b32 s74, s60, 5
    s_add_u32 s74, s74, 135168
    v_add_u32 v227, s74, v5
    s_lshl_b32 s74, s62, 4
    s_add_u32 m0, s72, 8192
    s_add_u32 s74, s74, s61
    buffer_load_dwordx4 v12, s[28:31], s70 offen lds
    s_lshl_b32 s74, s74, 10
    s_lshl_b32 s75, s60, 6
    s_add_u32 s74, s74, s75
    s_add_u32 s74, s74, 9764864
    v_lshlrev_b32 v4, 4, v4
    v_add_u32 v4, s74, v4
    v_cmp_eq_u32 vcc, 0, v2
    s_nop 1
    v_cndmask_b32 v230, v3, v4, vcc
    v_mov_b32 v3, 2146435072
    v_and_b32 v2, 15, v1
    v_subrev_u32 v4, 18, v1
    s_add_u32 m0, s72, 12288
    v_lshrrev_b32 v5, 1, v1
    buffer_load_dwordx4 v13, s[28:31], s70 offen lds
    v_cmp_eq_u32 vcc, 8, v5
    s_cmp_eq_u32 s61, 0
    s_cselect_b64 vcc, 0, vcc
    s_nop 1
    v_cndmask_b32 v2, v2, v4, vcc
    s_lshl_b32 s74, s61, 4
    v_add_u32 v2, s74, v2
    v_lshlrev_b32 v2, 7, v2
    v_add_u32 v2, 9502720, v2
    s_mov_b32 s84, 262143
    s_mov_b32 s85, 0
    v_cndmask_b32 v40, v3, v2, s[84:85]
    v_subrev_u32 v5, 16, v0
    s_mul_i32 m0, s26, 0
    s_add_u32 m0, m0, s27
    v_lshrrev_b32 v2, 5, v5
    buffer_load_dwordx4 v14, s[28:31], s70 offen lds
    v_lshlrev_b32 v2, 5, v2
    v_and_b32 v4, 15, v5
    v_lshl_add_u32 v2, v4, 1, v2
    v_bfe_u32 v4, v5, 4, 1
    v_add_u32 v2, v2, v4
    v_and_b32 v4, 7, v0
    v_lshlrev_b32 v4, 1, v4
    v_bfe_u32 v5, v0, 3, 1
    v_add_u32 v4, v4, v5
    s_add_u32 m0, s73, 0
    v_subrev_u32 v4, 16, v4
    buffer_load_dwordx4 v15, s[32:35], s71 offen  lds
    v_cmp_gt_u32 vcc, 16, v0
    s_nop 1
    v_cndmask_b32 v2, v2, v4, vcc
    s_lshl_b32 s74, s61, 7
    v_add_u32 v2, s74, v2
    v_max_i32 v2, 0, v2
    v_lshlrev_b32 v2, 3, v2
    v_add_u32 v2, 9437184, v2
    v_cmp_gt_u32 vcc, 0x90, v0
    s_nop 1
    v_cndmask_b32 v41, v3, v2, vcc
    v_lshlrev_b32 v60, 2, v0
    s_mov_b32 s56, s20
    s_mov_b32 s57, s21
    s_add_u32 m0, s73, 1024
    s_mov_b32 s58, 2097152
    buffer_load_dwordx4 v16, s[32:35], s71 offen  lds
    s_mov_b32 s59, 0x00020000
    s_mov_b32 s36, s24
    s_mov_b32 s37, s25
    s_mov_b32 s38, 10485760
    s_mov_b32 s39, 0x00020000
    v_mov_b32 v3, 2146435072
    s_lshl_b32 s74, s86, 2
    s_add_u32 s74, s74, s60
    s_lshl_b32 s74, s74, 4
    s_add_u32 m0, s73, 2048
    s_add_u32 s74, s74, 9437184
    buffer_load_dwordx4 v17, s[32:35], s71 offen  lds
    v_lshrrev_b32 v2, 1, v1
    v_add_u32 v2, s74, v2
    s_mov_b32 s76, 0x10001
    s_mov_b32 s77, 0
    v_cndmask_b32 v38, v3, v2, s[76:77]
    s_lshl_b32 s74, s86, 7
    s_add_u32 s74, s74, 9502720
    v_mov_b32 v2, s74
    v_cmp_eq_u32 vcc, 0, v0
    s_nop 1
    v_cndmask_b32 v39, v3, v2, vcc
    s_mov_b32 s48, s16
    s_add_u32 m0, s73, 3072
    s_mov_b32 s49, s17
    buffer_load_dwordx4 v18, s[32:35], s71 offen  lds
    s_mov_b32 s50, 1835008
    s_mov_b32 s51, 0x00020000
    s_mov_b32 s52, s8
    s_mov_b32 s53, s9
    s_mov_b32 s54, 524288
    s_mov_b32 s55, 0x00020000
    s_mul_i32 s80, s60, 458752
    s_lshl_b32 s81, s60, 17
    s_sub_u32 s81, s81, 458752
    s_add_u32 m0, s73, 4096
    s_movk_i32 s74, 2048
    buffer_load_dwordx4 v19, s[32:35], s71 offen  lds
    s_cmp_eq_u32 s60, 3
    s_cselect_b32 s74, s74, 7168
    s_cselect_b32 s75, 16, 0
    s_cselect_b32 s12, s8, s16
    s_cselect_b32 s13, s9, s17
    s_mov_b32 s14, 524288
    s_cmp_eq_u32 s60, 0
    s_cselect_b32 s75, 56, s75
    s_cselect_b32 s14, 1835008, s14
    s_mov_b32 s15, 0x00020000
    s_mul_i32 s74, s74, s2
    v_lshlrev_b32 v2, 7, v1
    v_add_u32 v2, s74, v2
    v_cmp_gt_u32 vcc, s75, v1
    s_nop 1
    v_cndmask_b32 v43, v3, v2, vcc
    v_lshrrev_b32 v2, 4, v1
    v_lshlrev_b32 v2, 1, v2
    s_add_u32 m0, s73, 5120
    v_and_b32 v4, 7, v1
    buffer_load_dwordx4 v20, s[32:35], s71 offen  lds
    v_xor_b32 v2, v2, v4
    v_lshlrev_b32 v2, 4, v2
    v_lshrrev_b32 v4, 3, v1
    v_lshl_add_u32 v2, v4, 10, v2
    s_lshl_b32 s74, s65, 7
    v_add_u32 v61, s74, v2
    v_add_u32 v62, 7168, v61
    v_add_u32 v252, 14336, v61
    v_add_u32 v254, 21504, v61
    s_mov_b32 s70, 128
    s_mov_b32 s71, 196608
    s_add_u32 m0, s72, 45056
    s_lshl_b32 s82, s60, 12
    buffer_load_dwordx4 v10, s[28:31], s70 offen lds
    v_and_b32 v2, 15, v1
    v_lshrrev_b32 v3, 4, v1
    v_lshrrev_b32 v4, 2, v2
    v_lshl_add_u32 v4, v3, 2, v4
    v_lshrrev_b32 v5, 1, v4
    v_and_b32 v5, 3, v5
    v_and_b32 v6, 3, v2
    v_lshlrev_b32 v6, 3, v6
    v_lshl_add_u32 v6, v4, 7, v6
    v_xor_b32 v7, 0, v5
    s_add_u32 m0, s72, 49152
    v_lshl_add_u32 v7, v7, 5, v6
    buffer_load_dwordx4 v11, s[28:31], s70 offen lds
    v_add_u32 v240, s82, v7
    v_add_u32 v244, 0x10000, v240
    v_add_u32 v248, 0x20000, v240
    v_xor_b32 v7, 1, v5
    v_lshl_add_u32 v7, v7, 5, v6
    v_add_u32 v241, s82, v7
    v_add_u32 v245, 0x10000, v241
    v_add_u32 v249, 0x20000, v241
    v_xor_b32 v7, 2, v5
    s_add_u32 m0, s72, 53248
    v_lshl_add_u32 v7, v7, 5, v6
    buffer_load_dwordx4 v12, s[28:31], s70 offen lds
    v_add_u32 v242, s82, v7
    v_add_u32 v246, 0x10000, v242
    v_add_u32 v250, 0x20000, v242
    v_xor_b32 v7, 3, v5
    v_lshl_add_u32 v7, v7, 5, v6
    v_add_u32 v243, s82, v7
    v_add_u32 v247, 0x10000, v243
    v_add_u32 v251, 0x20000, v243
    v_lshrrev_b32 v2, 4, v1
    s_add_u32 m0, s72, 57344
    v_lshlrev_b32 v2, 4, v2
    buffer_load_dwordx4 v13, s[28:31], s70 offen lds
    v_and_b32 v4, 15, v1
    v_lshlrev_b32 v4, 3, v4
    v_add_u32 v233, 147456, v4
    v_add_u32 v234, 149504, v2
    s_mul_i32 s10, s61, 144
    s_lshl_b32 s74, s62, 1
    s_add_u32 s10, s10, s74
    s_add_u32 s10, s10, s68
    s_add_u32 s10, s10, 56
    s_lshl_b32 s10, s10, 12
    s_mul_i32 m0, s26, 45056
    s_add_u32 m0, m0, s27
    s_lshl_b32 s74, s69, 10
    buffer_load_dwordx4 v14, s[28:31], s70 offen lds
    s_add_u32 s10, s10, s74
    v_and_b32 v4, 15, v1
    v_lshrrev_b32 v5, 4, v1
    s_lshl_b32 s74, s64, 6
    s_lshl_b32 s75, s68, 5
    s_add_u32 s74, s74, s75
    s_add_u32 s74, s74, s69
    s_lshl_b32 s74, s74, 10
    s_lshl_b32 s75, s65, 7
    s_add_u32 m0, s73, 45056
    s_add_u32 s74, s74, s75
    buffer_load_dwordx4 v15, s[32:35], s71 offen  lds
    v_lshlrev_b32 v4, 11, v4
    v_and_b32 v6, 1, v5
    v_lshl_add_u32 v4, v6, 5, v4
    v_lshrrev_b32 v6, 1, v5
    v_lshl_add_u32 v4, v6, 4, v4
    v_add_u32 v239, s74, v4
    v_lshrrev_b32 v4, 3, v1
    v_lshlrev_b32 v4, 11, v4
    v_and_b32 v6, 7, v1
    v_lshl_add_u32 v4, v6, 4, v4
    s_add_u32 m0, s73, 46080
    v_add_u32 v228, s74, v4
    buffer_load_dwordx4 v16, s[32:35], s71 offen  lds
    v_lshlrev_b32 v5, 3, v5
    v_add_u32 v37, s75, v5
    v_and_b32 v4, 15, v1
    v_lshl_add_u32 v4, v4, 7, v5
    s_lshl_b32 s74, s60, 11
    s_add_u32 s74, s74, 135168
    v_add_u32 v229, s74, v4
    s_mov_b32 s96, s18
    s_mov_b32 s97, s19
    s_add_u32 m0, s73, 47104
    s_mov_b32 s98, 1024
    buffer_load_dwordx4 v17, s[32:35], s71 offen  lds
    s_mov_b32 s99, 0x00020000
    s_lshl_b32 s74, s86, 2
    s_add_u32 s74, s74, s60
    s_lshl_b32 s74, s74, 7
    s_add_u32 s74, s74, 9568256
    v_mov_b32 v2, s74
    v_mov_b32 v3, 2146435072
    v_cmp_eq_u32 vcc, 0, v1
    s_nop 1
    v_cndmask_b32 v238, v3, v2, vcc
    v_and_b32 v5, 15, v1
    v_lshrrev_b32 v4, 4, v1
    s_add_u32 m0, s73, 48128
    v_lshlrev_b32 v4, 2, v4
    buffer_load_dwordx4 v18, s[32:35], s71 offen  lds
    v_sub_u32 v5, v5, v4
    v_mov_b32 v6, 4048155338
    s_cmp_eq_u32 s61, 0
    s_cselect_b64 s[76:77], 0, -1
    s_cselect_b32 s74, 0, -1
    s_mov_b32 s75, 0
    v_mov_b32 v2, 0xffff
    v_mov_b32 v3, 0xffff0000
    v_subrev_u32 v7, 0, v5
    v_cmp_gt_u32 s[90:91], 8, v7
    v_cmp_ge_i32 s[100:101], -9, v7
    v_cmp_gt_i32 vcc, 0, v7
    v_cndmask_b32 v172, v6, 0, s[90:91]
    v_cndmask_b32 v176, v6, 0, s[100:101]
    s_and_b64 s[100:101], s[100:101], s[76:77]
    v_cndmask_b32 v4, v2, 0, vcc
    s_and_b64 vcc, vcc, s[74:75]
    v_cndmask_b32 v184, v6, 0, s[100:101]
    v_mov_b32 v188, v4
    v_cndmask_b32 v180, v6, 0, vcc
    v_subrev_u32 v7, 1, v5
    v_cmp_gt_u32 s[90:91], 8, v7
    v_cmp_ge_i32 s[100:101], -9, v7
    v_cmp_gt_i32 vcc, 0, v7
    v_cndmask_b32 v173, v6, 0, s[90:91]
    v_cndmask_b32 v177, v6, 0, s[100:101]
    s_and_b64 s[100:101], s[100:101], s[76:77]
    v_cndmask_b32 v4, v3, 0, vcc
    s_and_b64 vcc, vcc, s[74:75]
    v_cndmask_b32 v185, v6, 0, s[100:101]
    v_or_b32 v188, v188, v4
    v_cndmask_b32 v181, v6, 0, vcc
    v_subrev_u32 v7, 2, v5
    v_cmp_gt_u32 s[90:91], 8, v7
    v_cmp_ge_i32 s[100:101], -9, v7
    v_cmp_gt_i32 vcc, 0, v7
    v_cndmask_b32 v174, v6, 0, s[90:91]
    v_cndmask_b32 v178, v6, 0, s[100:101]
    s_and_b64 s[100:101], s[100:101], s[76:77]
    v_cndmask_b32 v4, v2, 0, vcc
    s_and_b64 vcc, vcc, s[74:75]
    v_cndmask_b32 v186, v6, 0, s[100:101]
    v_mov_b32 v189, v4
    v_cndmask_b32 v182, v6, 0, vcc
    s_add_u32 m0, s73, 49152
    v_subrev_u32 v7, 3, v5
    buffer_load_dwordx4 v19, s[32:35], s71 offen  lds
    v_cmp_gt_u32 s[90:91], 8, v7
    v_cmp_ge_i32 s[100:101], -9, v7
    v_cmp_gt_i32 vcc, 0, v7
    v_cndmask_b32 v175, v6, 0, s[90:91]
    v_cndmask_b32 v179, v6, 0, s[100:101]
    s_and_b64 s[100:101], s[100:101], s[76:77]
    v_cndmask_b32 v4, v3, 0, vcc
    s_and_b64 vcc, vcc, s[74:75]
    v_cndmask_b32 v187, v6, 0, s[100:101]
    v_or_b32 v189, v189, v4
    v_cndmask_b32 v183, v6, 0, vcc
    v_mov_b32 v8, 0
    v_mov_b32 v3, 2146435072
    v_cmp_eq_u32 vcc, 0, v1
    s_nop 1
    v_cndmask_b32 v8, v3, v8, vcc
    buffer_load_dwordx2 v[44:45], v8, s[40:43], 0 offen
    s_waitcnt vmcnt(23)
    v_dot2_f32_bf16 v212, v204, v46, 0
    v_dot2_f32_bf16 v213, v204, v204, 0
    v_dot2_f32_bf16 v214, v208, v46, 0
    v_dot2_f32_bf16 v215, v208, v208, 0
    v_dot2_f32_bf16 v212, v205, v46, v212
    s_add_u32 m0, s73, 50176
    v_dot2_f32_bf16 v213, v205, v205, v213
    buffer_load_dwordx4 v20, s[32:35], s71 offen  lds
    v_dot2_f32_bf16 v214, v209, v46, v214
    v_dot2_f32_bf16 v215, v209, v209, v215
    v_dot2_f32_bf16 v212, v206, v46, v212
    v_dot2_f32_bf16 v213, v206, v206, v213
    v_dot2_f32_bf16 v214, v210, v46, v214
    v_dot2_f32_bf16 v215, v210, v210, v215
    v_dot2_f32_bf16 v212, v207, v46, v212
    v_dot2_f32_bf16 v213, v207, v207, v213
    v_dot2_f32_bf16 v214, v211, v46, v214
    s_mov_b32 s70, 256
    s_mov_b32 s71, 393216
    s_add_u32 m0, s72, 90112
    v_dot2_f32_bf16 v215, v211, v211, v215
    buffer_load_dwordx4 v10, s[28:31], s70 offen lds
    s_nop 2
    v_add_f32_dpp v212, v212, v212 quad_perm:[1,0,3,2] row_mask:0xf bank_mask:0xf
    v_add_f32_dpp v213, v213, v213 quad_perm:[1,0,3,2] row_mask:0xf bank_mask:0xf
    v_add_f32_dpp v214, v214, v214 quad_perm:[1,0,3,2] row_mask:0xf bank_mask:0xf
    v_add_f32_dpp v215, v215, v215 quad_perm:[1,0,3,2] row_mask:0xf bank_mask:0xf
    v_add_f32_dpp v212, v212, v212 quad_perm:[2,3,0,1] row_mask:0xf bank_mask:0xf
    v_add_f32_dpp v213, v213, v213 quad_perm:[2,3,0,1] row_mask:0xf bank_mask:0xf
    v_add_f32_dpp v214, v214, v214 quad_perm:[2,3,0,1] row_mask:0xf bank_mask:0xf
    v_add_f32_dpp v215, v215, v215 quad_perm:[2,3,0,1] row_mask:0xf bank_mask:0xf
    s_add_u32 m0, s72, 94208
    v_add_f32_dpp v212, v212, v212 row_half_mirror row_mask:0xf bank_mask:0xf
    buffer_load_dwordx4 v11, s[28:31], s70 offen lds
    v_add_f32_dpp v213, v213, v213 row_half_mirror row_mask:0xf bank_mask:0xf
    v_add_f32_dpp v214, v214, v214 row_half_mirror row_mask:0xf bank_mask:0xf
    v_add_f32_dpp v215, v215, v215 row_half_mirror row_mask:0xf bank_mask:0xf
    v_add_f32_dpp v212, v212, v212 row_mirror row_mask:0xf bank_mask:0xf
    v_add_f32_dpp v213, v213, v213 row_mirror row_mask:0xf bank_mask:0xf
    v_add_f32_dpp v214, v214, v214 row_mirror row_mask:0xf bank_mask:0xf
    v_add_f32_dpp v215, v215, v215 row_mirror row_mask:0xf bank_mask:0xf
    s_nop 0
    v_permlane16_swap_b32 v212, v214
    v_permlane16_swap_b32 v213, v215
    s_add_u32 m0, s72, 98304
    v_add_f32 v212, v212, v214
    buffer_load_dwordx4 v12, s[28:31], s70 offen lds
    v_add_f32 v213, v213, v215
    s_nop 1
    v_permlane32_swap_b32 v212, v213
    v_add_f32 v216, v212, v213
    v_mov_b32 v217, v216
    s_nop 1
    v_permlane32_swap_b32 v216, v217
    v_mul_f32 v216, 0x3b000000, v216
    v_mul_f32 v217, 0x3b000000, v217
    s_add_u32 m0, s72, 102400
    v_fma_f32 v217, -v216, v216, v217
    buffer_load_dwordx4 v13, s[28:31], s70 offen lds
    v_max_f32 v217, 0, v217
    v_cvt_pk_bf16_f32 v218, v216, v217
    v_lshlrev_b32 v216, 16, v218
    v_and_b32 v217, 0xffff0000, v218
    v_add_f32 v217, 0x3727c5ac, v217
    v_cvt_pk_bf16_f32 v218, v217, v217
    v_and_b32 v217, 0xffff0000, v218
    v_sqrt_f32 v217, v217
    s_nop 0
    v_cvt_pk_bf16_f32 v218, v217, v217
    s_mul_i32 m0, s26, 90112
    s_add_u32 m0, m0, s27
    v_and_b32 v217, 0xffff0000, v218
    buffer_load_dwordx4 v14, s[28:31], s70 offen lds
    v_rcp_f32 v225, v217
    v_xor_b32 v224, 0x80000000, v216
    s_nop 0
    buffer_store_dwordx2 v[224:225], v38, s[36:39], 0 offen sc1
    s_branch L_QLOOP
L_FFN:
    v_lshrrev_b32 v2, 3, v1
    s_lshl_b32 s74, s69, 3
    v_add_u32 v2, s74, v2
    v_lshrrev_b32 v3, 1, v2
    v_and_b32 v4, 7, v1
    v_xor_b32 v3, v3, v4
    v_lshlrev_b32 v3, 4, v3
    v_lshl_add_u32 v4, v2, 11, v3
    s_lshl_b32 s74, s61, 17
    s_lshl_b32 s75, s68, 10
    s_add_u32 s74, s74, s75
    v_add_u32 v10, s74, v4
    v_add_u32 v11, 32768, v10
    v_add_u32 v12, 65536, v10
    v_add_u32 v13, 98304, v10
    s_lshl_b32 s72, s60, 10
    s_mul_i32 s74, s60, 57344
    s_mul_i32 s75, s62, 448
    s_add_u32 s74, s74, s75
    s_movk_i32 s76, 9363
    s_movk_i32 s77, 3584
    s_mul_i32 s73, s60, 7168
    s_add_u32 s73, s73, 16384
    v_mov_b32 v6, s74
    v_add_u32 v2, 0, v1
    v_mul_u32_u24 v3, s76, v2
    v_lshrrev_b32 v3, 18, v3
    v_mul_u32_u24 v4, 28, v3
    v_sub_u32 v4, v2, v4
    v_lshrrev_b32 v5, 2, v3
    v_and_b32 v5, 2, v5
    v_xor_b32 v4, v4, v5
    v_mad_u32_u24 v3, v3, s77, v6
    v_lshl_add_u32 v15, v4, 4, v3
    v_add_u32 v2, 64, v1
    v_mul_u32_u24 v3, s76, v2
    v_lshrrev_b32 v3, 18, v3
    v_mul_u32_u24 v4, 28, v3
    v_sub_u32 v4, v2, v4
    v_lshrrev_b32 v5, 2, v3
    v_and_b32 v5, 2, v5
    v_xor_b32 v4, v4, v5
    v_mad_u32_u24 v3, v3, s77, v6
    v_lshl_add_u32 v16, v4, 4, v3
    v_add_u32 v2, 128, v1
    v_mul_u32_u24 v3, s76, v2
    v_lshrrev_b32 v3, 18, v3
    v_mul_u32_u24 v4, 28, v3
    v_sub_u32 v4, v2, v4
    v_lshrrev_b32 v5, 2, v3
    v_and_b32 v5, 2, v5
    v_xor_b32 v4, v4, v5
    v_mad_u32_u24 v3, v3, s77, v6
    v_lshl_add_u32 v17, v4, 4, v3
    v_add_u32 v2, 192, v1
    v_mul_u32_u24 v3, s76, v2
    v_lshrrev_b32 v3, 18, v3
    v_mul_u32_u24 v4, 28, v3
    v_sub_u32 v4, v2, v4
    v_lshrrev_b32 v5, 2, v3
    v_and_b32 v5, 2, v5
    v_xor_b32 v4, v4, v5
    v_mad_u32_u24 v3, v3, s77, v6
    v_lshl_add_u32 v18, v4, 4, v3
    v_add_u32 v2, 256, v1
    v_mul_u32_u24 v3, s76, v2
    v_lshrrev_b32 v3, 18, v3
    v_mul_u32_u24 v4, 28, v3
    v_sub_u32 v4, v2, v4
    v_lshrrev_b32 v5, 2, v3
    v_and_b32 v5, 2, v5
    v_xor_b32 v4, v4, v5
    v_mad_u32_u24 v3, v3, s77, v6
    v_lshl_add_u32 v19, v4, 4, v3
    v_add_u32 v2, 320, v1
    v_mul_u32_u24 v3, s76, v2
    v_lshrrev_b32 v3, 18, v3
    v_mul_u32_u24 v4, 28, v3
    v_sub_u32 v4, v2, v4
    v_lshrrev_b32 v5, 2, v3
    v_and_b32 v5, 2, v5
    v_xor_b32 v4, v4, v5
    v_mad_u32_u24 v3, v3, s77, v6
    v_lshl_add_u32 v20, v4, 4, v3
    v_add_u32 v2, 384, v1
    v_mul_u32_u24 v3, s76, v2
    v_lshrrev_b32 v3, 18, v3
    v_mul_u32_u24 v4, 28, v3
    v_sub_u32 v4, v2, v4
    v_lshrrev_b32 v5, 2, v3
    v_and_b32 v5, 2, v5
    v_xor_b32 v4, v4, v5
    v_mad_u32_u24 v3, v3, s77, v6
    v_lshl_add_u32 v21, v4, 4, v3
    v_and_b32 v2, 15, v1
    v_lshrrev_b32 v3, 4, v1
    v_lshrrev_b32 v4, 1, v2
    v_xor_b32 v4, v4, v3
    v_lshlrev_b32 v4, 4, v4
    v_lshl_add_u32 v4, v2, 7, v4
    s_lshl_b32 s74, s68, 13
    v_add_u32 v4, s74, v4
    v_xor_b32 v5, 64, v4
    v_add_u32 v22, 0, v4
    v_add_u32 v23, 0, v5
    v_add_u32 v24, 45056, v4
    v_add_u32 v25, 45056, v5
    v_add_u32 v26, 90112, v4
    v_add_u32 v27, 90112, v5
    v_lshrrev_b32 v4, 2, v2
    v_lshl_add_u32 v4, v3, 3, v4
    v_and_b32 v5, 3, v2
    v_lshlrev_b32 v5, 3, v5
    s_movk_i32 s74, 448
    v_mad_u32_u24 v4, v4, s74, v5
    v_and_b32 v6, 1, v3
    v_lshlrev_b32 v6, 5, v6
    s_lshl_b32 s74, s69, 8
    v_add_u32 v7, s74, v4
    v_add_u32 v8, v7, v6
    v_sub_u32 v9, v7, v6
    v_add_u32 v7, 192, v4
    v_add_u32 v7, v7, v6
    v_add_u32 v2, 224, v4
    v_sub_u32 v2, v2, v6
    s_cmp_eq_u32 s69, 0
    s_cselect_b64 vcc, -1, 0
    s_nop 1
    v_cndmask_b32 v7, v2, v7, vcc
    v_add_u32 v28, 16384, v8
    v_add_u32 v29, 16384, v9
    v_add_u32 v30, 16384, v7
    v_add_u32 v31, 61440, v8
    v_add_u32 v32, 61440, v9
    v_add_u32 v33, 61440, v7
    v_add_u32 v34, 106496, v8
    v_add_u32 v35, 106496, v9
    v_add_u32 v36, 106496, v7
    v_mov_b32 v46, 0x3f803f80
    v_mov_b32 v47, 0x3f803f80
    v_mov_b32 v48, 0x3f803f80
    v_mov_b32 v49, 0x3f803f80
    v_mov_b32 v3, 2146435072
    v_and_b32 v2, 15, v1
    s_lshl_b32 s74, s61, 4
    v_add_u32 v2, s74, v2
    v_and_b32 v4, 15, v1
    s_mov_b32 s70, 0
    s_mov_b32 s71, 0
    s_add_u32 m0, s72, 0
    v_lshlrev_b32 v4, 4, v4
    buffer_load_dwordx4 v10, s[28:31], s70 offen lds
    v_add_u32 v4, s62, v4
    v_cmp_gt_u32 vcc, 16, v1
    s_nop 1
    v_cndmask_b32 v2, v4, v2, vcc
    v_lshlrev_b32 v2, 7, v2
    v_lshrrev_b32 v4, 1, v1
    v_and_or_b32 v2, v4, 8, v2
    v_add_u32 v2, 9502720, v2
    s_mov_b32 s84, 4294967295
    s_mov_b32 s85, 0
    s_add_u32 m0, s72, 4096
    v_cndmask_b32 v40, v3, v2, s[84:85]
    buffer_load_dwordx4 v11, s[28:31], s70 offen lds
    v_lshrrev_b32 v2, 5, v0
    v_lshlrev_b32 v2, 5, v2
    v_and_b32 v4, 15, v0
    v_lshl_add_u32 v2, v4, 1, v2
    v_bfe_u32 v4, v0, 4, 1
    v_add_u32 v2, v2, v4
    s_lshl_b32 s74, s61, 7
    v_add_u32 v2, s74, v2
    v_lshlrev_b32 v2, 3, v2
    s_add_u32 m0, s72, 8192
    v_add_u32 v2, 9437184, v2
    buffer_load_dwordx4 v12, s[28:31], s70 offen lds
    v_cmp_gt_u32 vcc, 0x80, v0
    s_nop 1
    v_cndmask_b32 v41, v3, v2, vcc
    s_mul_i32 s74, s62, 448
    v_lshlrev_b32 v2, 1, v0
    v_add_u32 v2, s74, v2
    v_cmp_gt_u32 vcc, 0xe0, v0
    s_nop 1
    v_cndmask_b32 v42, v3, v2, vcc
    s_lshl_b32 s74, s62, 14
    s_add_u32 s74, s74, 9764864
    v_lshlrev_b32 v2, 2, v0
    s_add_u32 m0, s72, 12288
    v_add_u32 v2, s74, v2
    buffer_load_dwordx4 v13, s[28:31], s70 offen lds
    v_cmp_gt_u32 vcc, 0xe0, v0
    s_nop 1
    v_cndmask_b32 v226, v3, v2, vcc
    v_lshlrev_b32 v60, 2, v0
    s_mov_b32 s56, s20
    s_mov_b32 s57, s21
    s_mov_b32 s58, 2097152
    s_mov_b32 s59, 0x00020000
    s_mov_b32 s36, s24
    s_mov_b32 s37, s25
    s_mov_b32 s38, 10485760
    s_add_u32 m0, s73, 0
    s_mov_b32 s39, 0x00020000
    buffer_load_dwordx4 v15, s[32:35], s71 offen  lds
    v_mov_b32 v3, 2146435072
    s_lshl_b32 s74, s86, 2
    s_add_u32 s74, s74, s60
    s_lshl_b32 s74, s74, 4
    s_add_u32 s74, s74, 9437184
    v_lshrrev_b32 v2, 1, v1
    v_add_u32 v2, s74, v2
    s_mov_b32 s76, 0x10001
    s_add_u32 m0, s73, 1024
    s_mov_b32 s77, 0
    buffer_load_dwordx4 v16, s[32:35], s71 offen  lds
    v_cndmask_b32 v38, v3, v2, s[76:77]
    s_lshl_b32 s74, s86, 7
    s_add_u32 s74, s74, 9502720
    v_mov_b32 v2, s74
    v_cmp_eq_u32 vcc, 0, v0
    s_nop 1
    v_cndmask_b32 v39, v3, v2, vcc
    s_mov_b32 s48, s16
    s_mov_b32 s49, s17
    s_mov_b32 s50, 1835008
    s_mov_b32 s51, 0x00020000
    s_add_u32 m0, s73, 2048
    s_mov_b32 s52, s8
    buffer_load_dwordx4 v17, s[32:35], s71 offen  lds
    s_mov_b32 s53, s9
    s_mov_b32 s54, 524288
    s_mov_b32 s55, 0x00020000
    s_mul_i32 s80, s60, 458752
    s_lshl_b32 s81, s60, 17
    s_sub_u32 s81, s81, 458752
    s_movk_i32 s74, 2048
    s_cmp_eq_u32 s60, 3
    s_cselect_b32 s74, s74, 7168
    s_cselect_b32 s75, 16, 0
    s_cselect_b32 s12, s8, s16
    s_cselect_b32 s13, s9, s17
    s_add_u32 m0, s73, 3072
    s_mov_b32 s14, 524288
    buffer_load_dwordx4 v18, s[32:35], s71 offen  lds
    s_cmp_eq_u32 s60, 0
    s_cselect_b32 s75, 56, s75
    s_cselect_b32 s14, 1835008, s14
    s_mov_b32 s15, 0x00020000
    s_mul_i32 s74, s74, s2
    v_lshlrev_b32 v2, 7, v1
    v_add_u32 v2, s74, v2
    v_cmp_gt_u32 vcc, s75, v1
    s_nop 1
    v_cndmask_b32 v43, v3, v2, vcc
    v_lshrrev_b32 v2, 4, v1
    v_lshlrev_b32 v2, 1, v2
    v_and_b32 v4, 7, v1
    s_add_u32 m0, s73, 4096
    v_xor_b32 v2, v2, v4
    buffer_load_dwordx4 v19, s[32:35], s71 offen  lds
    v_lshlrev_b32 v2, 4, v2
    v_lshrrev_b32 v4, 3, v1
    v_lshl_add_u32 v2, v4, 10, v2
    s_lshl_b32 s74, s65, 7
    v_add_u32 v61, s74, v2
    v_add_u32 v62, 7168, v61
    v_add_u32 v252, 14336, v61
    v_add_u32 v254, 21504, v61
    s_add_u32 m0, s73, 5120
    s_lshl_b32 s82, s60, 12
    buffer_load_dwordx4 v20, s[32:35], s71 offen  lds
    v_and_b32 v2, 15, v1
    v_lshrrev_b32 v3, 4, v1
    v_lshrrev_b32 v4, 2, v2
    v_lshl_add_u32 v4, v3, 2, v4
    v_lshrrev_b32 v5, 1, v4
    v_and_b32 v5, 3, v5
    v_and_b32 v6, 3, v2
    v_lshlrev_b32 v6, 3, v6
    v_lshl_add_u32 v6, v4, 7, v6
    s_add_u32 m0, s73, 6144
    v_xor_b32 v7, 0, v5
    buffer_load_dwordx4 v21, s[32:35], s71 offen  lds
    v_lshl_add_u32 v7, v7, 5, v6
    v_add_u32 v240, s82, v7
    v_add_u32 v244, 0x10000, v240
    v_add_u32 v248, 0x20000, v240
    v_xor_b32 v7, 1, v5
    v_lshl_add_u32 v7, v7, 5, v6
    v_add_u32 v241, s82, v7
    v_add_u32 v245, 0x10000, v241
    s_mov_b32 s70, 128
    s_mov_b32 s71, 229376
    s_add_u32 m0, s72, 45056
    v_add_u32 v249, 0x20000, v241
    buffer_load_dwordx4 v10, s[28:31], s70 offen lds
    v_xor_b32 v7, 2, v5
    v_lshl_add_u32 v7, v7, 5, v6
    v_add_u32 v242, s82, v7
    v_add_u32 v246, 0x10000, v242
    v_add_u32 v250, 0x20000, v242
    v_xor_b32 v7, 3, v5
    v_lshl_add_u32 v7, v7, 5, v6
    v_add_u32 v243, s82, v7
    v_add_u32 v247, 0x10000, v243
    s_add_u32 m0, s72, 49152
    v_add_u32 v251, 0x20000, v243
    buffer_load_dwordx4 v11, s[28:31], s70 offen lds
    v_lshrrev_b32 v2, 4, v1
    v_lshlrev_b32 v2, 4, v2
    v_and_b32 v4, 15, v1
    v_lshlrev_b32 v4, 3, v4
    s_mul_i32 s74, s60, 448
    s_add_u32 s74, s74, 152576
    v_add_u32 v233, s74, v2
    s_xor_b32 s74, s60, 2
    s_add_u32 m0, s72, 53248
    s_mul_i32 s74, s74, 448
    buffer_load_dwordx4 v12, s[28:31], s70 offen lds
    s_add_u32 s74, s74, 152576
    v_add_u32 v234, s74, v2
    s_lshl_b32 s74, s69, 9
    s_add_u32 s74, s74, 151552
    v_add_u32 v235, s74, v2
    s_lshl_b32 s74, s69, 6
    s_add_u32 s74, s74, 151936
    v_add_u32 v236, s74, v2
    s_add_u32 m0, s72, 57344
    s_lshl_b32 s74, s68, 9
    buffer_load_dwordx4 v13, s[28:31], s70 offen lds
    s_add_u32 s74, s74, 147456
    v_add_u32 v237, s74, v4
    s_lshl_b32 s74, s61, 1
    s_add_u32 s74, s74, s68
    s_mul_i32 s74, s74, 72
    s_mul_i32 s75, s62, 7
    s_add_u32 s74, s74, s75
    s_lshl_b32 s74, s74, 12
    s_lshl_b32 s10, s69, 14
    s_add_u32 m0, s73, 45056
    s_add_u32 s10, s10, s74
    buffer_load_dwordx4 v15, s[32:35], s71 offen  lds
    s_lshl_b32 s11, s69, 10
    s_add_u32 s11, s11, s74
    s_add_u32 s11, s11, 12288
    v_and_b32 v4, 15, v1
    v_lshrrev_b32 v5, 4, v1
    s_lshl_b32 s74, s64, 6
    s_lshl_b32 s75, s68, 5
    s_add_u32 s74, s74, s75
    s_add_u32 m0, s73, 46080
    s_add_u32 s74, s74, s69
    buffer_load_dwordx4 v16, s[32:35], s71 offen  lds
    s_lshl_b32 s74, s74, 10
    s_lshl_b32 s75, s65, 7
    s_add_u32 s74, s74, s75
    v_lshlrev_b32 v4, 11, v4
    v_and_b32 v6, 1, v5
    v_lshl_add_u32 v4, v6, 5, v4
    v_lshrrev_b32 v6, 1, v5
    v_lshl_add_u32 v4, v6, 4, v4
    v_add_u32 v239, s74, v4
    s_add_u32 m0, s73, 47104
    v_lshrrev_b32 v4, 3, v1
    buffer_load_dwordx4 v17, s[32:35], s71 offen  lds
    v_lshlrev_b32 v4, 11, v4
    v_and_b32 v6, 7, v1
    v_lshl_add_u32 v4, v6, 4, v4
    v_add_u32 v228, s74, v4
    v_lshlrev_b32 v5, 3, v5
    v_add_u32 v37, s75, v5
    v_and_b32 v4, 15, v1
    v_lshl_add_u32 v4, v4, 7, v5
    s_add_u32 m0, s73, 48128
    s_lshl_b32 s74, s60, 11
    buffer_load_dwordx4 v18, s[32:35], s71 offen  lds
    s_add_u32 s74, s74, 135168
    v_add_u32 v229, s74, v4
    s_mov_b32 s96, s18
    s_mov_b32 s97, s19
    s_mov_b32 s98, 1024
    s_mov_b32 s99, 0x00020000
    s_lshl_b32 s74, s86, 2
    s_add_u32 s74, s74, s60
    s_lshl_b32 s74, s74, 7
    s_add_u32 m0, s73, 49152
    s_add_u32 s74, s74, 9568256
    buffer_load_dwordx4 v19, s[32:35], s71 offen  lds
    v_mov_b32 v2, s74
    v_mov_b32 v3, 2146435072
    v_cmp_eq_u32 vcc, 0, v1
    s_nop 1
    v_cndmask_b32 v238, v3, v2, vcc
    v_mov_b32 v8, 0
    v_mov_b32 v3, 2146435072
    v_cmp_eq_u32 vcc, 0, v1
    s_nop 1
    v_cndmask_b32 v8, v3, v8, vcc
    buffer_load_dwordx2 v[44:45], v8, s[40:43], 0 offen
    s_waitcnt vmcnt(22)
    s_add_u32 m0, s73, 50176
    v_dot2_f32_bf16 v212, v204, v46, 0
    buffer_load_dwordx4 v20, s[32:35], s71 offen  lds
    v_dot2_f32_bf16 v213, v204, v204, 0
    v_dot2_f32_bf16 v214, v208, v46, 0
    v_dot2_f32_bf16 v215, v208, v208, 0
    v_dot2_f32_bf16 v212, v205, v46, v212
    v_dot2_f32_bf16 v213, v205, v205, v213
    v_dot2_f32_bf16 v214, v209, v46, v214
    v_dot2_f32_bf16 v215, v209, v209, v215
    v_dot2_f32_bf16 v212, v206, v46, v212
    v_dot2_f32_bf16 v213, v206, v206, v213
    s_add_u32 m0, s73, 51200
    v_dot2_f32_bf16 v214, v210, v46, v214
    buffer_load_dwordx4 v21, s[32:35], s71 offen  lds
    v_dot2_f32_bf16 v215, v210, v210, v215
    v_dot2_f32_bf16 v212, v207, v46, v212
    v_dot2_f32_bf16 v213, v207, v207, v213
    v_dot2_f32_bf16 v214, v211, v46, v214
    v_dot2_f32_bf16 v215, v211, v211, v215
    s_nop 2
    v_add_f32_dpp v212, v212, v212 quad_perm:[1,0,3,2] row_mask:0xf bank_mask:0xf
    v_add_f32_dpp v213, v213, v213 quad_perm:[1,0,3,2] row_mask:0xf bank_mask:0xf
    s_mov_b32 s70, 256
    s_mov_b32 s71, 458752
    s_add_u32 m0, s72, 90112
    v_add_f32_dpp v214, v214, v214 quad_perm:[1,0,3,2] row_mask:0xf bank_mask:0xf
    buffer_load_dwordx4 v10, s[28:31], s70 offen lds
    v_add_f32_dpp v215, v215, v215 quad_perm:[1,0,3,2] row_mask:0xf bank_mask:0xf
    v_add_f32_dpp v212, v212, v212 quad_perm:[2,3,0,1] row_mask:0xf bank_mask:0xf
    v_add_f32_dpp v213, v213, v213 quad_perm:[2,3,0,1] row_mask:0xf bank_mask:0xf
    v_add_f32_dpp v214, v214, v214 quad_perm:[2,3,0,1] row_mask:0xf bank_mask:0xf
    v_add_f32_dpp v215, v215, v215 quad_perm:[2,3,0,1] row_mask:0xf bank_mask:0xf
    v_add_f32_dpp v212, v212, v212 row_half_mirror row_mask:0xf bank_mask:0xf
    v_add_f32_dpp v213, v213, v213 row_half_mirror row_mask:0xf bank_mask:0xf
    v_add_f32_dpp v214, v214, v214 row_half_mirror row_mask:0xf bank_mask:0xf
    v_add_f32_dpp v215, v215, v215 row_half_mirror row_mask:0xf bank_mask:0xf
    s_add_u32 m0, s72, 94208
    v_add_f32_dpp v212, v212, v212 row_mirror row_mask:0xf bank_mask:0xf
    buffer_load_dwordx4 v11, s[28:31], s70 offen lds
    v_add_f32_dpp v213, v213, v213 row_mirror row_mask:0xf bank_mask:0xf
    v_add_f32_dpp v214, v214, v214 row_mirror row_mask:0xf bank_mask:0xf
    v_add_f32_dpp v215, v215, v215 row_mirror row_mask:0xf bank_mask:0xf
    s_nop 0
    v_permlane16_swap_b32 v212, v214
    v_permlane16_swap_b32 v213, v215
    v_add_f32 v212, v212, v214
    v_add_f32 v213, v213, v215
    s_add_u32 m0, s72, 98304
    s_nop 1
    buffer_load_dwordx4 v12, s[28:31], s70 offen lds
    v_permlane32_swap_b32 v212, v213
    v_add_f32 v216, v212, v213
    v_mov_b32 v217, v216
    s_nop 1
    v_permlane32_swap_b32 v216, v217
    v_mul_f32 v216, 0x3b000000, v216
    v_mul_f32 v217, 0x3b000000, v217
    v_fma_f32 v217, -v216, v216, v217
    v_max_f32 v217, 0, v217
    s_add_u32 m0, s72, 102400
    v_cvt_pk_bf16_f32 v218, v216, v217
    buffer_load_dwordx4 v13, s[28:31], s70 offen lds
    v_lshlrev_b32 v216, 16, v218
    v_and_b32 v217, 0xffff0000, v218
    v_add_f32 v217, 0x3727c5ac, v217
    v_cvt_pk_bf16_f32 v218, v217, v217
    v_and_b32 v217, 0xffff0000, v218
    v_sqrt_f32 v217, v217
    s_nop 0
    v_cvt_pk_bf16_f32 v218, v217, v217
    s_add_u32 m0, s73, 90112
    v_and_b32 v217, 0xffff0000, v218
    buffer_load_dwordx4 v15, s[32:35], s71 offen  lds
    v_rcp_f32 v225, v217
    v_xor_b32 v224, 0x80000000, v216
    s_nop 0
    buffer_store_dwordx2 v[224:225], v38, s[36:39], 0 offen sc1
L_EARLY_END:
    s_waitcnt vmcnt(18)
    s_barrier
    ds_read_b64_tr_b16 a[16:17], v28 offset:0
    ds_read_b64_tr_b16 a[18:19], v28 offset:1792
    ds_read_b128 a[0:3], v22 offset:0
    ds_read_b64_tr_b16 a[20:21], v29 offset:32
    ds_read_b64_tr_b16 a[22:23], v29 offset:1824
    ds_read_b64_tr_b16 a[24:25], v28 offset:64
    ds_read_b128 a[4:7], v22 offset:2048
    ds_read_b64_tr_b16 a[26:27], v28 offset:1856
    ds_read_b64_tr_b16 a[28:29], v29 offset:96
    ds_read_b64_tr_b16 a[30:31], v29 offset:1888
    ds_read_b64_tr_b16 a[32:33], v28 offset:128
    ds_read_b128 a[8:11], v22 offset:4096
    ds_read_b64_tr_b16 a[34:35], v28 offset:1920
    ds_read_b64_tr_b16 a[36:37], v29 offset:160
    ds_read_b64_tr_b16 a[38:39], v29 offset:1952
    ds_read_b128 a[12:15], v22 offset:6144
    ds_read_b64_tr_b16 a[40:41], v30 offset:0
    ds_read_b64_tr_b16 a[42:43], v30 offset:1792
    s_waitcnt lgkmcnt(0)
    v_mfma_f32_16x16x32_bf16 v[64:67], a[16:19], a[0:3], 0
    ds_read_b64_tr_b16 a[60:61], v28 offset:14336
    v_mfma_f32_16x16x32_bf16 v[68:71], a[20:23], a[0:3], 0
    ds_read_b64_tr_b16 a[62:63], v28 offset:16128
    v_mfma_f32_16x16x32_bf16 v[72:75], a[24:27], a[0:3], 0
    v_mfma_f32_16x16x32_bf16 v[76:79], a[28:31], a[0:3], 0
    ds_read_b128 a[44:47], v23 offset:0
    s_add_u32 m0, s73, 91136
    v_mfma_f32_16x16x32_bf16 v[80:83], a[32:35], a[0:3], 0
    buffer_load_dwordx4 v16, s[32:35], s71 offen  lds
    ds_read_b64_tr_b16 a[64:65], v29 offset:14368
    v_mfma_f32_16x16x32_bf16 v[84:87], a[36:39], a[0:3], 0
    ds_read_b64_tr_b16 a[66:67], v29 offset:16160
    v_mfma_f32_16x16x32_bf16 v[88:91], a[40:43], a[0:3], 0
    ds_read_b64_tr_b16 a[68:69], v28 offset:14400
    v_mfma_f32_16x16x32_bf16 v[92:95], a[16:19], a[4:7], 0
    s_add_u32 m0, s73, 92160
    v_mfma_f32_16x16x32_bf16 v[96:99], a[20:23], a[4:7], 0
    buffer_load_dwordx4 v17, s[32:35], s71 offen  lds
    ds_read_b128 a[48:51], v23 offset:2048
    v_mfma_f32_16x16x32_bf16 v[100:103], a[24:27], a[4:7], 0
    ds_read_b64_tr_b16 a[70:71], v28 offset:16192
    v_mfma_f32_16x16x32_bf16 v[104:107], a[28:31], a[4:7], 0
    ds_read_b64_tr_b16 a[72:73], v29 offset:14432
    s_add_u32 m0, s73, 93184
    v_mfma_f32_16x16x32_bf16 v[108:111], a[32:35], a[4:7], 0
    buffer_load_dwordx4 v18, s[32:35], s71 offen  lds
    ds_read_b64_tr_b16 a[74:75], v29 offset:16224
    v_mfma_f32_16x16x32_bf16 v[112:115], a[36:39], a[4:7], 0
    v_mfma_f32_16x16x32_bf16 v[116:119], a[40:43], a[4:7], 0
    ds_read_b64_tr_b16 a[76:77], v28 offset:14464
    v_mfma_f32_16x16x32_bf16 v[120:123], a[16:19], a[8:11], 0
    ds_read_b128 a[52:55], v23 offset:4096
    s_add_u32 m0, s73, 94208
    v_mfma_f32_16x16x32_bf16 v[124:127], a[20:23], a[8:11], 0
    buffer_load_dwordx4 v19, s[32:35], s71 offen  lds
    ds_read_b64_tr_b16 a[78:79], v28 offset:16256
    v_mfma_f32_16x16x32_bf16 v[128:131], a[24:27], a[8:11], 0
    ds_read_b64_tr_b16 a[80:81], v29 offset:14496
    v_mfma_f32_16x16x32_bf16 v[132:135], a[28:31], a[8:11], 0
    v_mfma_f32_16x16x32_bf16 v[136:139], a[32:35], a[8:11], 0
    ds_read_b64_tr_b16 a[82:83], v29 offset:16288
    s_add_u32 m0, s73, 95232
    v_mfma_f32_16x16x32_bf16 v[140:143], a[36:39], a[8:11], 0
    buffer_load_dwordx4 v20, s[32:35], s71 offen  lds
    ds_read_b128 a[56:59], v23 offset:6144
    v_mfma_f32_16x16x32_bf16 v[144:147], a[40:43], a[8:11], 0
    ds_read_b64_tr_b16 a[84:85], v30 offset:14336
    v_mfma_f32_16x16x32_bf16 v[148:151], a[16:19], a[12:15], 0
    ds_read_b64_tr_b16 a[86:87], v30 offset:16128
    v_mfma_f32_16x16x32_bf16 v[152:155], a[20:23], a[12:15], 0
    s_add_u32 m0, s73, 96256
    v_mfma_f32_16x16x32_bf16 v[156:159], a[24:27], a[12:15], 0
    buffer_load_dwordx4 v21, s[32:35], s71 offen  lds
    v_mfma_f32_16x16x32_bf16 v[160:163], a[28:31], a[12:15], 0
    v_mfma_f32_16x16x32_bf16 v[164:167], a[32:35], a[12:15], 0
    v_mfma_f32_16x16x32_bf16 v[168:171], a[36:39], a[12:15], 0
    s_mul_i32 s90, s2, 3
    s_lshr_b32 s90, s90, 8
    s_cmp_eq_u32 s90, 0
    s_cselect_b32 s90, 0, 2146435072
    buffer_load_dword v253, v43, s[12:15], s90 offen
    v_mfma_f32_16x16x32_bf16 v[172:175], a[40:43], a[12:15], 0
    s_waitcnt vmcnt(7) lgkmcnt(0)
NON_1:
    v_readfirstlane_b32 s66, v44
    v_readfirstlane_b32 s67, v45
    s_nop 3
    s_cmp_lg_u32 s66, 0
    s_cbranch_scc1 NON_1_ok
    s_mov_b32 s48, s22
    s_mov_b32 s49, s23
    s_mov_b32 s50, 256
    s_mov_b32 s51, 0x00020000
    v_mov_b32 v8, 0
    buffer_load_dwordx2 v[44:45], v8, s[48:51], 0 offen sc1
    s_waitcnt vmcnt(0)
    s_mov_b32 s48, s16
    s_mov_b32 s49, s17
    s_mov_b32 s50, 1835008
    s_mov_b32 s51, 0x00020000
    s_branch NON_1
NON_1_ok:
    s_barrier
    v_mfma_f32_16x16x32_bf16 v[64:67], a[60:63], a[44:47], v[64:67]
    ds_read_b64_tr_b16 a[16:17], v31 offset:0
    v_mov_b32 v8, s66
    v_mov_b32 v9, s67
    buffer_store_dwordx2 v[8:9], v39, s[36:39], 0 offen sc1
    v_mfma_f32_16x16x32_bf16 v[68:71], a[64:67], a[44:47], v[68:71]
    ds_read_b64_tr_b16 a[18:19], v31 offset:1792
    v_mfma_f32_16x16x32_bf16 v[72:75], a[68:71], a[44:47], v[72:75]
    v_mfma_f32_16x16x32_bf16 v[76:79], a[72:75], a[44:47], v[76:79]
    ds_read_b128 a[0:3], v24 offset:0
    s_mov_b32 s70, 384
    s_mov_b32 s71, 688128
    s_add_u32 m0, s72, 0
    v_mfma_f32_16x16x32_bf16 v[80:83], a[76:79], a[44:47], v[80:83]
    buffer_load_dwordx4 v10, s[28:31], s70 offen lds
    ds_read_b64_tr_b16 a[20:21], v32 offset:32
    v_mfma_f32_16x16x32_bf16 v[84:87], a[80:83], a[44:47], v[84:87]
    ds_read_b64_tr_b16 a[22:23], v32 offset:1824
    v_mfma_f32_16x16x32_bf16 v[88:91], a[84:87], a[44:47], v[88:91]
    ds_read_b64_tr_b16 a[24:25], v31 offset:64
    v_mfma_f32_16x16x32_bf16 v[92:95], a[60:63], a[48:51], v[92:95]
    v_mfma_f32_16x16x32_bf16 v[96:99], a[64:67], a[48:51], v[96:99]
    s_add_u32 m0, s72, 4096
    v_mfma_f32_16x16x32_bf16 v[100:103], a[68:71], a[48:51], v[100:103]
    buffer_load_dwordx4 v11, s[28:31], s70 offen lds
    ds_read_b128 a[4:7], v24 offset:2048
    ds_read_b64_tr_b16 a[26:27], v31 offset:1856
    v_mfma_f32_16x16x32_bf16 v[104:107], a[72:75], a[48:51], v[104:107]
    ds_read_b64_tr_b16 a[28:29], v32 offset:96
    v_mfma_f32_16x16x32_bf16 v[108:111], a[76:79], a[48:51], v[108:111]
    ds_read_b64_tr_b16 a[30:31], v32 offset:1888
    v_mfma_f32_16x16x32_bf16 v[112:115], a[80:83], a[48:51], v[112:115]
    s_add_u32 m0, s72, 8192
    v_mfma_f32_16x16x32_bf16 v[116:119], a[84:87], a[48:51], v[116:119]
    buffer_load_dwordx4 v12, s[28:31], s70 offen lds
    ds_read_b64_tr_b16 a[32:33], v31 offset:128
    v_mfma_f32_16x16x32_bf16 v[120:123], a[60:63], a[52:55], v[120:123]
    ds_read_b128 a[8:11], v24 offset:4096
    v_mfma_f32_16x16x32_bf16 v[124:127], a[64:67], a[52:55], v[124:127]
    ds_read_b64_tr_b16 a[34:35], v31 offset:1920
    v_mfma_f32_16x16x32_bf16 v[128:131], a[68:71], a[52:55], v[128:131]
    ds_read_b64_tr_b16 a[36:37], v32 offset:160
    s_add_u32 m0, s72, 12288
    v_mfma_f32_16x16x32_bf16 v[132:135], a[72:75], a[52:55], v[132:135]
    buffer_load_dwordx4 v13, s[28:31], s70 offen lds
    v_mfma_f32_16x16x32_bf16 v[136:139], a[76:79], a[52:55], v[136:139]
    ds_read_b64_tr_b16 a[38:39], v32 offset:1952
    v_mfma_f32_16x16x32_bf16 v[140:143], a[80:83], a[52:55], v[140:143]
    ds_read_b128 a[12:15], v24 offset:6144
    v_mfma_f32_16x16x32_bf16 v[144:147], a[84:87], a[52:55], v[144:147]
    ds_read_b64_tr_b16 a[40:41], v33 offset:0
    v_mfma_f32_16x16x32_bf16 v[148:151], a[60:63], a[56:59], v[148:151]
    s_add_u32 m0, s73, 0
    v_mfma_f32_16x16x32_bf16 v[152:155], a[64:67], a[56:59], v[152:155]
    buffer_load_dwordx4 v15, s[32:35], s71 offen  lds
    ds_read_b64_tr_b16 a[42:43], v33 offset:1792
    v_mfma_f32_16x16x32_bf16 v[156:159], a[68:71], a[56:59], v[156:159]
    v_mfma_f32_16x16x32_bf16 v[160:163], a[72:75], a[56:59], v[160:163]
    v_mfma_f32_16x16x32_bf16 v[164:167], a[76:79], a[56:59], v[164:167]
    s_add_u32 m0, s73, 1024
    v_mfma_f32_16x16x32_bf16 v[168:171], a[80:83], a[56:59], v[168:171]
    buffer_load_dwordx4 v16, s[32:35], s71 offen  lds
    v_mfma_f32_16x16x32_bf16 v[172:175], a[84:87], a[56:59], v[172:175]
    s_waitcnt lgkmcnt(0)
    v_mfma_f32_16x16x32_bf16 v[64:67], a[16:19], a[0:3], v[64:67]
    ds_read_b64_tr_b16 a[60:61], v31 offset:14336
    v_mfma_f32_16x16x32_bf16 v[68:71], a[20:23], a[0:3], v[68:71]
    ds_read_b64_tr_b16 a[62:63], v31 offset:16128
    v_mfma_f32_16x16x32_bf16 v[72:75], a[24:27], a[0:3], v[72:75]
    v_mfma_f32_16x16x32_bf16 v[76:79], a[28:31], a[0:3], v[76:79]
    ds_read_b128 a[44:47], v25 offset:0
    s_add_u32 m0, s73, 2048
    v_mfma_f32_16x16x32_bf16 v[80:83], a[32:35], a[0:3], v[80:83]
    buffer_load_dwordx4 v17, s[32:35], s71 offen  lds
    ds_read_b64_tr_b16 a[64:65], v32 offset:14368
    v_mfma_f32_16x16x32_bf16 v[84:87], a[36:39], a[0:3], v[84:87]
    ds_read_b64_tr_b16 a[66:67], v32 offset:16160
    v_mfma_f32_16x16x32_bf16 v[88:91], a[40:43], a[0:3], v[88:91]
    ds_read_b64_tr_b16 a[68:69], v31 offset:14400
    v_mfma_f32_16x16x32_bf16 v[92:95], a[16:19], a[4:7], v[92:95]
    v_mfma_f32_16x16x32_bf16 v[96:99], a[20:23], a[4:7], v[96:99]
    s_add_u32 m0, s73, 3072
    v_mfma_f32_16x16x32_bf16 v[100:103], a[24:27], a[4:7], v[100:103]
    buffer_load_dwordx4 v18, s[32:35], s71 offen  lds
    ds_read_b128 a[48:51], v25 offset:2048
    ds_read_b64_tr_b16 a[70:71], v31 offset:16192
    v_mfma_f32_16x16x32_bf16 v[104:107], a[28:31], a[4:7], v[104:107]
    ds_read_b64_tr_b16 a[72:73], v32 offset:14432
    v_mfma_f32_16x16x32_bf16 v[108:111], a[32:35], a[4:7], v[108:111]
    ds_read_b64_tr_b16 a[74:75], v32 offset:16224
    v_mfma_f32_16x16x32_bf16 v[112:115], a[36:39], a[4:7], v[112:115]
    s_add_u32 m0, s73, 4096
    v_mfma_f32_16x16x32_bf16 v[116:119], a[40:43], a[4:7], v[116:119]
    buffer_load_dwordx4 v19, s[32:35], s71 offen  lds
    ds_read_b64_tr_b16 a[76:77], v31 offset:14464
    v_mfma_f32_16x16x32_bf16 v[120:123], a[16:19], a[8:11], v[120:123]
    ds_read_b128 a[52:55], v25 offset:4096
    v_mfma_f32_16x16x32_bf16 v[124:127], a[20:23], a[8:11], v[124:127]
    ds_read_b64_tr_b16 a[78:79], v31 offset:16256
    v_mfma_f32_16x16x32_bf16 v[128:131], a[24:27], a[8:11], v[128:131]
    ds_read_b64_tr_b16 a[80:81], v32 offset:14496
    s_add_u32 m0, s73, 5120
    v_mfma_f32_16x16x32_bf16 v[132:135], a[28:31], a[8:11], v[132:135]
    buffer_load_dwordx4 v20, s[32:35], s71 offen  lds
    v_mfma_f32_16x16x32_bf16 v[136:139], a[32:35], a[8:11], v[136:139]
    ds_read_b64_tr_b16 a[82:83], v32 offset:16288
    v_mfma_f32_16x16x32_bf16 v[140:143], a[36:39], a[8:11], v[140:143]
    ds_read_b128 a[56:59], v25 offset:6144
    v_mfma_f32_16x16x32_bf16 v[144:147], a[40:43], a[8:11], v[144:147]
    ds_read_b64_tr_b16 a[84:85], v33 offset:14336
    v_mfma_f32_16x16x32_bf16 v[148:151], a[16:19], a[12:15], v[148:151]
    s_add_u32 m0, s73, 6144
    v_mfma_f32_16x16x32_bf16 v[152:155], a[20:23], a[12:15], v[152:155]
    buffer_load_dwordx4 v21, s[32:35], s71 offen  lds
    ds_read_b64_tr_b16 a[86:87], v33 offset:16128
    v_mfma_f32_16x16x32_bf16 v[156:159], a[24:27], a[12:15], v[156:159]
    v_mfma_f32_16x16x32_bf16 v[160:163], a[28:31], a[12:15], v[160:163]
    v_mfma_f32_16x16x32_bf16 v[164:167], a[32:35], a[12:15], v[164:167]
    s_mul_i32 s90, s2, 3
    s_lshr_b32 s90, s90, 8
    s_cmp_eq_u32 s90, 1
    s_cselect_b32 s90, 0, 2146435072
    buffer_load_dword v253, v43, s[12:15], s90 offen
    v_mfma_f32_16x16x32_bf16 v[168:171], a[36:39], a[12:15], v[168:171]
    v_mfma_f32_16x16x32_bf16 v[172:175], a[40:43], a[12:15], v[172:175]
    s_waitcnt vmcnt(14) lgkmcnt(0)
    s_barrier
    v_mfma_f32_16x16x32_bf16 v[64:67], a[60:63], a[44:47], v[64:67]
    ds_read_b64_tr_b16 a[16:17], v34 offset:0
    v_mfma_f32_16x16x32_bf16 v[68:71], a[64:67], a[44:47], v[68:71]
    ds_read_b64_tr_b16 a[18:19], v34 offset:1792
    v_mfma_f32_16x16x32_bf16 v[72:75], a[68:71], a[44:47], v[72:75]
    v_mfma_f32_16x16x32_bf16 v[76:79], a[72:75], a[44:47], v[76:79]
    ds_read_b128 a[0:3], v26 offset:0
    s_mov_b32 s70, 512
    s_mov_b32 s71, 917504
    s_add_u32 m0, s72, 45056
    v_mfma_f32_16x16x32_bf16 v[80:83], a[76:79], a[44:47], v[80:83]
    buffer_load_dwordx4 v10, s[28:31], s70 offen lds
    ds_read_b64_tr_b16 a[20:21], v35 offset:32
    v_mfma_f32_16x16x32_bf16 v[84:87], a[80:83], a[44:47], v[84:87]
    ds_read_b64_tr_b16 a[22:23], v35 offset:1824
    v_mfma_f32_16x16x32_bf16 v[88:91], a[84:87], a[44:47], v[88:91]
    ds_read_b64_tr_b16 a[24:25], v34 offset:64
    v_mfma_f32_16x16x32_bf16 v[92:95], a[60:63], a[48:51], v[92:95]
    v_mfma_f32_16x16x32_bf16 v[96:99], a[64:67], a[48:51], v[96:99]
    s_add_u32 m0, s72, 49152
    v_mfma_f32_16x16x32_bf16 v[100:103], a[68:71], a[48:51], v[100:103]
    buffer_load_dwordx4 v11, s[28:31], s70 offen lds
    ds_read_b128 a[4:7], v26 offset:2048
    ds_read_b64_tr_b16 a[26:27], v34 offset:1856
    v_mfma_f32_16x16x32_bf16 v[104:107], a[72:75], a[48:51], v[104:107]
    ds_read_b64_tr_b16 a[28:29], v35 offset:96
    v_mfma_f32_16x16x32_bf16 v[108:111], a[76:79], a[48:51], v[108:111]
    ds_read_b64_tr_b16 a[30:31], v35 offset:1888
    v_mfma_f32_16x16x32_bf16 v[112:115], a[80:83], a[48:51], v[112:115]
    s_add_u32 m0, s72, 53248
    v_mfma_f32_16x16x32_bf16 v[116:119], a[84:87], a[48:51], v[116:119]
    buffer_load_dwordx4 v12, s[28:31], s70 offen lds
    ds_read_b64_tr_b16 a[32:33], v34 offset:128
    v_mfma_f32_16x16x32_bf16 v[120:123], a[60:63], a[52:55], v[120:123]
    ds_read_b128 a[8:11], v26 offset:4096
    v_mfma_f32_16x16x32_bf16 v[124:127], a[64:67], a[52:55], v[124:127]
    ds_read_b64_tr_b16 a[34:35], v34 offset:1920
    v_mfma_f32_16x16x32_bf16 v[128:131], a[68:71], a[52:55], v[128:131]
    ds_read_b64_tr_b16 a[36:37], v35 offset:160
    s_add_u32 m0, s72, 57344
    v_mfma_f32_16x16x32_bf16 v[132:135], a[72:75], a[52:55], v[132:135]
    buffer_load_dwordx4 v13, s[28:31], s70 offen lds
    v_mfma_f32_16x16x32_bf16 v[136:139], a[76:79], a[52:55], v[136:139]
    ds_read_b64_tr_b16 a[38:39], v35 offset:1952
    v_mfma_f32_16x16x32_bf16 v[140:143], a[80:83], a[52:55], v[140:143]
    ds_read_b128 a[12:15], v26 offset:6144
    v_mfma_f32_16x16x32_bf16 v[144:147], a[84:87], a[52:55], v[144:147]
    ds_read_b64_tr_b16 a[40:41], v36 offset:0
    v_mfma_f32_16x16x32_bf16 v[148:151], a[60:63], a[56:59], v[148:151]
    s_add_u32 m0, s73, 45056
    v_mfma_f32_16x16x32_bf16 v[152:155], a[64:67], a[56:59], v[152:155]
    buffer_load_dwordx4 v15, s[32:35], s71 offen  lds
    ds_read_b64_tr_b16 a[42:43], v36 offset:1792
    v_mfma_f32_16x16x32_bf16 v[156:159], a[68:71], a[56:59], v[156:159]
    v_mfma_f32_16x16x32_bf16 v[160:163], a[72:75], a[56:59], v[160:163]
    v_mfma_f32_16x16x32_bf16 v[164:167], a[76:79], a[56:59], v[164:167]
    s_add_u32 m0, s73, 46080
    v_mfma_f32_16x16x32_bf16 v[168:171], a[80:83], a[56:59], v[168:171]
    buffer_load_dwordx4 v16, s[32:35], s71 offen  lds
    v_mfma_f32_16x16x32_bf16 v[172:175], a[84:87], a[56:59], v[172:175]
    s_waitcnt lgkmcnt(0)
    v_mfma_f32_16x16x32_bf16 v[64:67], a[16:19], a[0:3], v[64:67]
    ds_read_b64_tr_b16 a[60:61], v34 offset:14336
    v_mfma_f32_16x16x32_bf16 v[68:71], a[20:23], a[0:3], v[68:71]
    ds_read_b64_tr_b16 a[62:63], v34 offset:16128
    v_mfma_f32_16x16x32_bf16 v[72:75], a[24:27], a[0:3], v[72:75]
    s_add_u32 m0, s73, 47104
    v_mfma_f32_16x16x32_bf16 v[76:79], a[28:31], a[0:3], v[76:79]
    buffer_load_dwordx4 v17, s[32:35], s71 offen  lds
    ds_read_b128 a[44:47], v27 offset:0
    v_mfma_f32_16x16x32_bf16 v[80:83], a[32:35], a[0:3], v[80:83]
    ds_read_b64_tr_b16 a[64:65], v35 offset:14368
    v_mfma_f32_16x16x32_bf16 v[84:87], a[36:39], a[0:3], v[84:87]
    s_add_u32 m0, s73, 48128
    v_mfma_f32_16x16x32_bf16 v[88:91], a[40:43], a[0:3], v[88:91]
    buffer_load_dwordx4 v18, s[32:35], s71 offen  lds
    ds_read_b64_tr_b16 a[66:67], v35 offset:16160
    ds_read_b64_tr_b16 a[68:69], v34 offset:14400
    v_mfma_f32_16x16x32_bf16 v[92:95], a[16:19], a[4:7], v[92:95]
    s_add_u32 m0, s73, 49152
    v_mfma_f32_16x16x32_bf16 v[96:99], a[20:23], a[4:7], v[96:99]
    buffer_load_dwordx4 v19, s[32:35], s71 offen  lds
    ds_read_b128 a[48:51], v27 offset:2048
    v_mfma_f32_16x16x32_bf16 v[100:103], a[24:27], a[4:7], v[100:103]
    ds_read_b64_tr_b16 a[70:71], v34 offset:16192
    s_add_u32 m0, s73, 50176
    v_mfma_f32_16x16x32_bf16 v[104:107], a[28:31], a[4:7], v[104:107]
    buffer_load_dwordx4 v20, s[32:35], s71 offen  lds
    ds_read_b64_tr_b16 a[72:73], v35 offset:14432
    v_mfma_f32_16x16x32_bf16 v[108:111], a[32:35], a[4:7], v[108:111]
    ds_read_b64_tr_b16 a[74:75], v35 offset:16224
    v_mfma_f32_16x16x32_bf16 v[112:115], a[36:39], a[4:7], v[112:115]
    s_add_u32 m0, s73, 51200
    v_mfma_f32_16x16x32_bf16 v[116:119], a[40:43], a[4:7], v[116:119]
    buffer_load_dwordx4 v21, s[32:35], s71 offen  lds
    ds_read_b64_tr_b16 a[76:77], v34 offset:14464
    v_mfma_f32_16x16x32_bf16 v[120:123], a[16:19], a[8:11], v[120:123]
    ds_read_b128 a[52:55], v27 offset:4096
    s_mul_i32 s90, s2, 3
    s_lshr_b32 s90, s90, 8
    s_cmp_eq_u32 s90, 2
    s_cselect_b32 s90, 0, 2146435072
    buffer_load_dword v253, v43, s[12:15], s90 offen
    v_mfma_f32_16x16x32_bf16 v[124:127], a[20:23], a[8:11], v[124:127]
    ds_read_b64_tr_b16 a[78:79], v34 offset:16256
    v_mfma_f32_16x16x32_bf16 v[128:131], a[24:27], a[8:11], v[128:131]
    ds_read_b64_tr_b16 a[80:81], v35 offset:14496
    v_mfma_f32_16x16x32_bf16 v[132:135], a[28:31], a[8:11], v[132:135]
    buffer_load_dwordx2 a[104:105], v37, s[96:99], 0 offen offset:0
    v_mfma_f32_16x16x32_bf16 v[136:139], a[32:35], a[8:11], v[136:139]
    ds_read_b64_tr_b16 a[82:83], v35 offset:16288
    v_mfma_f32_16x16x32_bf16 v[140:143], a[36:39], a[8:11], v[140:143]
    ds_read_b128 a[56:59], v27 offset:6144
    buffer_load_dwordx2 a[106:107], v37, s[96:99], 0 offen offset:32
    v_mfma_f32_16x16x32_bf16 v[144:147], a[40:43], a[8:11], v[144:147]
    ds_read_b64_tr_b16 a[84:85], v36 offset:14336
    v_mfma_f32_16x16x32_bf16 v[148:151], a[16:19], a[12:15], v[148:151]
    ds_read_b64_tr_b16 a[86:87], v36 offset:16128
    buffer_load_dwordx2 a[108:109], v37, s[96:99], 0 offen offset:64
    v_mfma_f32_16x16x32_bf16 v[152:155], a[20:23], a[12:15], v[152:155]
    v_mfma_f32_16x16x32_bf16 v[156:159], a[24:27], a[12:15], v[156:159]
    v_mfma_f32_16x16x32_bf16 v[160:163], a[28:31], a[12:15], v[160:163]
    buffer_load_dwordx2 a[110:111], v37, s[96:99], 0 offen offset:96
    v_mfma_f32_16x16x32_bf16 v[164:167], a[32:35], a[12:15], v[164:167]
    v_mfma_f32_16x16x32_bf16 v[168:171], a[36:39], a[12:15], v[168:171]
    buffer_load_ushort v57, v42, s[44:47], 0 offen
    v_mfma_f32_16x16x32_bf16 v[172:175], a[40:43], a[12:15], v[172:175]
    s_waitcnt vmcnt(18) lgkmcnt(0)
    s_barrier
    v_mfma_f32_16x16x32_bf16 v[64:67], a[60:63], a[44:47], v[64:67]
    ds_read_b64_tr_b16 a[16:17], v28 offset:0
    v_mfma_f32_16x16x32_bf16 v[68:71], a[64:67], a[44:47], v[68:71]
    ds_read_b64_tr_b16 a[18:19], v28 offset:1792
    v_mfma_f32_16x16x32_bf16 v[72:75], a[68:71], a[44:47], v[72:75]
    v_mfma_f32_16x16x32_bf16 v[76:79], a[72:75], a[44:47], v[76:79]
    ds_read_b128 a[0:3], v22 offset:0
    s_mov_b32 s70, 640
    s_mov_b32 s71, 1146880
    s_add_u32 m0, s72, 90112
    v_mfma_f32_16x16x32_bf16 v[80:83], a[76:79], a[44:47], v[80:83]
    buffer_load_dwordx4 v10, s[28:31], s70 offen lds
    ds_read_b64_tr_b16 a[20:21], v29 offset:32
    v_mfma_f32_16x16x32_bf16 v[84:87], a[80:83], a[44:47], v[84:87]
    ds_read_b64_tr_b16 a[22:23], v29 offset:1824
    v_mfma_f32_16x16x32_bf16 v[88:91], a[84:87], a[44:47], v[88:91]
    ds_read_b64_tr_b16 a[24:25], v28 offset:64
    v_mfma_f32_16x16x32_bf16 v[92:95], a[60:63], a[48:51], v[92:95]
    v_mfma_f32_16x16x32_bf16 v[96:99], a[64:67], a[48:51], v[96:99]
    s_add_u32 m0, s72, 94208
    v_mfma_f32_16x16x32_bf16 v[100:103], a[68:71], a[48:51], v[100:103]
    buffer_load_dwordx4 v11, s[28:31], s70 offen lds
    ds_read_b128 a[4:7], v22 offset:2048
    ds_read_b64_tr_b16 a[26:27], v28 offset:1856
    v_mfma_f32_16x16x32_bf16 v[104:107], a[72:75], a[48:51], v[104:107]
    ds_read_b64_tr_b16 a[28:29], v29 offset:96
    v_mfma_f32_16x16x32_bf16 v[108:111], a[76:79], a[48:51], v[108:111]
    ds_read_b64_tr_b16 a[30:31], v29 offset:1888
    v_mfma_f32_16x16x32_bf16 v[112:115], a[80:83], a[48:51], v[112:115]
    s_add_u32 m0, s72, 98304
    v_mfma_f32_16x16x32_bf16 v[116:119], a[84:87], a[48:51], v[116:119]
    buffer_load_dwordx4 v12, s[28:31], s70 offen lds
    ds_read_b64_tr_b16 a[32:33], v28 offset:128
    v_mfma_f32_16x16x32_bf16 v[120:123], a[60:63], a[52:55], v[120:123]
    ds_read_b128 a[8:11], v22 offset:4096
    v_mfma_f32_16x16x32_bf16 v[124:127], a[64:67], a[52:55], v[124:127]
    ds_read_b64_tr_b16 a[34:35], v28 offset:1920
    v_mfma_f32_16x16x32_bf16 v[128:131], a[68:71], a[52:55], v[128:131]
    ds_read_b64_tr_b16 a[36:37], v29 offset:160
    s_add_u32 m0, s72, 102400
    v_mfma_f32_16x16x32_bf16 v[132:135], a[72:75], a[52:55], v[132:135]
    buffer_load_dwordx4 v13, s[28:31], s70 offen lds
    v_mfma_f32_16x16x32_bf16 v[136:139], a[76:79], a[52:55], v[136:139]
    ds_read_b64_tr_b16 a[38:39], v29 offset:1952
    v_mfma_f32_16x16x32_bf16 v[140:143], a[80:83], a[52:55], v[140:143]
    ds_read_b128 a[12:15], v22 offset:6144
    v_mfma_f32_16x16x32_bf16 v[144:147], a[84:87], a[52:55], v[144:147]
    ds_read_b64_tr_b16 a[40:41], v30 offset:0
    v_mfma_f32_16x16x32_bf16 v[148:151], a[60:63], a[56:59], v[148:151]
    s_add_u32 m0, s73, 90112
    v_mfma_f32_16x16x32_bf16 v[152:155], a[64:67], a[56:59], v[152:155]
    buffer_load_dwordx4 v15, s[32:35], s71 offen  lds
    ds_read_b64_tr_b16 a[42:43], v30 offset:1792
    v_mfma_f32_16x16x32_bf16 v[156:159], a[68:71], a[56:59], v[156:159]
    v_mfma_f32_16x16x32_bf16 v[160:163], a[72:75], a[56:59], v[160:163]
    v_mfma_f32_16x16x32_bf16 v[164:167], a[76:79], a[56:59], v[164:167]
    s_add_u32 m0, s73, 91136
    v_mfma_f32_16x16x32_bf16 v[168:171], a[80:83], a[56:59], v[168:171]
    buffer_load_dwordx4 v16, s[32:35], s71 offen  lds
    v_mfma_f32_16x16x32_bf16 v[172:175], a[84:87], a[56:59], v[172:175]
    s_waitcnt lgkmcnt(0)
    v_mfma_f32_16x16x32_bf16 v[64:67], a[16:19], a[0:3], v[64:67]
    ds_read_b64_tr_b16 a[60:61], v28 offset:14336
    v_mfma_f32_16x16x32_bf16 v[68:71], a[20:23], a[0:3], v[68:71]
    ds_read_b64_tr_b16 a[62:63], v28 offset:16128
    v_mfma_f32_16x16x32_bf16 v[72:75], a[24:27], a[0:3], v[72:75]
    v_mfma_f32_16x16x32_bf16 v[76:79], a[28:31], a[0:3], v[76:79]
    ds_read_b128 a[44:47], v23 offset:0
    s_add_u32 m0, s73, 92160
    v_mfma_f32_16x16x32_bf16 v[80:83], a[32:35], a[0:3], v[80:83]
    buffer_load_dwordx4 v17, s[32:35], s71 offen  lds
    ds_read_b64_tr_b16 a[64:65], v29 offset:14368
    v_mfma_f32_16x16x32_bf16 v[84:87], a[36:39], a[0:3], v[84:87]
    ds_read_b64_tr_b16 a[66:67], v29 offset:16160
    v_mfma_f32_16x16x32_bf16 v[88:91], a[40:43], a[0:3], v[88:91]
    ds_read_b64_tr_b16 a[68:69], v28 offset:14400
    v_mfma_f32_16x16x32_bf16 v[92:95], a[16:19], a[4:7], v[92:95]
    s_add_u32 m0, s73, 93184
    v_mfma_f32_16x16x32_bf16 v[96:99], a[20:23], a[4:7], v[96:99]
    buffer_load_dwordx4 v18, s[32:35], s71 offen  lds
    ds_read_b128 a[48:51], v23 offset:2048
    v_mfma_f32_16x16x32_bf16 v[100:103], a[24:27], a[4:7], v[100:103]
    ds_read_b64_tr_b16 a[70:71], v28 offset:16192
    v_mfma_f32_16x16x32_bf16 v[104:107], a[28:31], a[4:7], v[104:107]
    ds_read_b64_tr_b16 a[72:73], v29 offset:14432
    s_add_u32 m0, s73, 94208
    v_mfma_f32_16x16x32_bf16 v[108:111], a[32:35], a[4:7], v[108:111]
    buffer_load_dwordx4 v19, s[32:35], s71 offen  lds
    ds_read_b64_tr_b16 a[74:75], v29 offset:16224
    v_mfma_f32_16x16x32_bf16 v[112:115], a[36:39], a[4:7], v[112:115]
    v_mfma_f32_16x16x32_bf16 v[116:119], a[40:43], a[4:7], v[116:119]
    ds_read_b64_tr_b16 a[76:77], v28 offset:14464
    v_mfma_f32_16x16x32_bf16 v[120:123], a[16:19], a[8:11], v[120:123]
    ds_read_b128 a[52:55], v23 offset:4096
    s_add_u32 m0, s73, 95232
    v_mfma_f32_16x16x32_bf16 v[124:127], a[20:23], a[8:11], v[124:127]
    buffer_load_dwordx4 v20, s[32:35], s71 offen  lds
    ds_read_b64_tr_b16 a[78:79], v28 offset:16256
    v_mfma_f32_16x16x32_bf16 v[128:131], a[24:27], a[8:11], v[128:131]
    ds_read_b64_tr_b16 a[80:81], v29 offset:14496
    v_mfma_f32_16x16x32_bf16 v[132:135], a[28:31], a[8:11], v[132:135]
    v_mfma_f32_16x16x32_bf16 v[136:139], a[32:35], a[8:11], v[136:139]
    ds_read_b64_tr_b16 a[82:83], v29 offset:16288
    s_add_u32 m0, s73, 96256
    v_mfma_f32_16x16x32_bf16 v[140:143], a[36:39], a[8:11], v[140:143]
    buffer_load_dwordx4 v21, s[32:35], s71 offen  lds
    ds_read_b128 a[56:59], v23 offset:6144
    v_mfma_f32_16x16x32_bf16 v[144:147], a[40:43], a[8:11], v[144:147]
    ds_read_b64_tr_b16 a[84:85], v30 offset:14336
    v_mfma_f32_16x16x32_bf16 v[148:151], a[16:19], a[12:15], v[148:151]
    ds_read_b64_tr_b16 a[86:87], v30 offset:16128
    v_mfma_f32_16x16x32_bf16 v[152:155], a[20:23], a[12:15], v[152:155]
    s_lshl_b32 s90, s60, 11
    s_add_u32 m0, s90, 135168
    s_movk_i32 s90, 0
    v_mfma_f32_16x16x32_bf16 v[156:159], a[24:27], a[12:15], v[156:159]
    buffer_load_dwordx4 v228, s[28:31], s90 offen lds
    v_mfma_f32_16x16x32_bf16 v[160:163], a[28:31], a[12:15], v[160:163]
    v_mfma_f32_16x16x32_bf16 v[164:167], a[32:35], a[12:15], v[164:167]
    v_mfma_f32_16x16x32_bf16 v[168:171], a[36:39], a[12:15], v[168:171]
    s_lshl_b32 s90, s60, 11
    s_add_u32 m0, s90, 136192
    s_movk_i32 s90, 16384
    v_mfma_f32_16x16x32_bf16 v[172:175], a[40:43], a[12:15], v[172:175]
    buffer_load_dwordx4 v228, s[28:31], s90 offen lds
    s_waitcnt vmcnt(19) lgkmcnt(0)
    s_barrier
    v_mfma_f32_16x16x32_bf16 v[64:67], a[60:63], a[44:47], v[64:67]
    ds_read_b64_tr_b16 a[16:17], v31 offset:0
    v_mfma_f32_16x16x32_bf16 v[68:71], a[64:67], a[44:47], v[68:71]
    ds_read_b64_tr_b16 a[18:19], v31 offset:1792
    v_mfma_f32_16x16x32_bf16 v[72:75], a[68:71], a[44:47], v[72:75]
    v_mfma_f32_16x16x32_bf16 v[76:79], a[72:75], a[44:47], v[76:79]
    ds_read_b128 a[0:3], v24 offset:0
    s_mov_b32 s70, 768
    s_mov_b32 s71, 1376256
    s_add_u32 m0, s72, 0
    v_mfma_f32_16x16x32_bf16 v[80:83], a[76:79], a[44:47], v[80:83]
    buffer_load_dwordx4 v10, s[28:31], s70 offen lds
    ds_read_b64_tr_b16 a[20:21], v32 offset:32
    v_mfma_f32_16x16x32_bf16 v[84:87], a[80:83], a[44:47], v[84:87]
    ds_read_b64_tr_b16 a[22:23], v32 offset:1824
    v_mfma_f32_16x16x32_bf16 v[88:91], a[84:87], a[44:47], v[88:91]
    ds_read_b64_tr_b16 a[24:25], v31 offset:64
    v_mfma_f32_16x16x32_bf16 v[92:95], a[60:63], a[48:51], v[92:95]
    v_mfma_f32_16x16x32_bf16 v[96:99], a[64:67], a[48:51], v[96:99]
    s_add_u32 m0, s72, 4096
    v_mfma_f32_16x16x32_bf16 v[100:103], a[68:71], a[48:51], v[100:103]
    buffer_load_dwordx4 v11, s[28:31], s70 offen lds
    ds_read_b128 a[4:7], v24 offset:2048
    ds_read_b64_tr_b16 a[26:27], v31 offset:1856
    v_mfma_f32_16x16x32_bf16 v[104:107], a[72:75], a[48:51], v[104:107]
    ds_read_b64_tr_b16 a[28:29], v32 offset:96
    v_mfma_f32_16x16x32_bf16 v[108:111], a[76:79], a[48:51], v[108:111]
    ds_read_b64_tr_b16 a[30:31], v32 offset:1888
    v_mfma_f32_16x16x32_bf16 v[112:115], a[80:83], a[48:51], v[112:115]
    s_add_u32 m0, s72, 8192
    v_mfma_f32_16x16x32_bf16 v[116:119], a[84:87], a[48:51], v[116:119]
    buffer_load_dwordx4 v12, s[28:31], s70 offen lds
    ds_read_b64_tr_b16 a[32:33], v31 offset:128
    v_mfma_f32_16x16x32_bf16 v[120:123], a[60:63], a[52:55], v[120:123]
    ds_read_b128 a[8:11], v24 offset:4096
    v_mfma_f32_16x16x32_bf16 v[124:127], a[64:67], a[52:55], v[124:127]
    ds_read_b64_tr_b16 a[34:35], v31 offset:1920
    v_mfma_f32_16x16x32_bf16 v[128:131], a[68:71], a[52:55], v[128:131]
    ds_read_b64_tr_b16 a[36:37], v32 offset:160
    s_add_u32 m0, s72, 12288
    v_mfma_f32_16x16x32_bf16 v[132:135], a[72:75], a[52:55], v[132:135]
    buffer_load_dwordx4 v13, s[28:31], s70 offen lds
    v_mfma_f32_16x16x32_bf16 v[136:139], a[76:79], a[52:55], v[136:139]
    ds_read_b64_tr_b16 a[38:39], v32 offset:1952
    v_mfma_f32_16x16x32_bf16 v[140:143], a[80:83], a[52:55], v[140:143]
    ds_read_b128 a[12:15], v24 offset:6144
    v_mfma_f32_16x16x32_bf16 v[144:147], a[84:87], a[52:55], v[144:147]
    ds_read_b64_tr_b16 a[40:41], v33 offset:0
    v_mfma_f32_16x16x32_bf16 v[148:151], a[60:63], a[56:59], v[148:151]
    s_add_u32 m0, s73, 0
    v_mfma_f32_16x16x32_bf16 v[152:155], a[64:67], a[56:59], v[152:155]
    buffer_load_dwordx4 v15, s[32:35], s71 offen  lds
    ds_read_b64_tr_b16 a[42:43], v33 offset:1792
    v_mfma_f32_16x16x32_bf16 v[156:159], a[68:71], a[56:59], v[156:159]
    v_mfma_f32_16x16x32_bf16 v[160:163], a[72:75], a[56:59], v[160:163]
    v_mfma_f32_16x16x32_bf16 v[164:167], a[76:79], a[56:59], v[164:167]
    s_add_u32 m0, s73, 1024
    v_mfma_f32_16x16x32_bf16 v[168:171], a[80:83], a[56:59], v[168:171]
    buffer_load_dwordx4 v16, s[32:35], s71 offen  lds
    v_mfma_f32_16x16x32_bf16 v[172:175], a[84:87], a[56:59], v[172:175]
    s_waitcnt lgkmcnt(0)
    v_mfma_f32_16x16x32_bf16 v[64:67], a[16:19], a[0:3], v[64:67]
    ds_read_b64_tr_b16 a[60:61], v31 offset:14336
    buffer_load_dwordx2 v[44:45], v40, s[36:39], 0 offen sc1
    v_mfma_f32_16x16x32_bf16 v[68:71], a[20:23], a[0:3], v[68:71]
    ds_read_b64_tr_b16 a[62:63], v31 offset:16128
    v_mfma_f32_16x16x32_bf16 v[72:75], a[24:27], a[0:3], v[72:75]
    v_mfma_f32_16x16x32_bf16 v[76:79], a[28:31], a[0:3], v[76:79]
    ds_read_b128 a[44:47], v25 offset:0
    v_mfma_f32_16x16x32_bf16 v[80:83], a[32:35], a[0:3], v[80:83]
    s_add_u32 m0, s73, 2048
    v_mfma_f32_16x16x32_bf16 v[84:87], a[36:39], a[0:3], v[84:87]
    buffer_load_dwordx4 v17, s[32:35], s71 offen  lds
    ds_read_b64_tr_b16 a[64:65], v32 offset:14368
    ds_read_b64_tr_b16 a[66:67], v32 offset:16160
    v_mfma_f32_16x16x32_bf16 v[88:91], a[40:43], a[0:3], v[88:91]
    ds_read_b64_tr_b16 a[68:69], v31 offset:14400
    v_mfma_f32_16x16x32_bf16 v[92:95], a[16:19], a[4:7], v[92:95]
    v_mfma_f32_16x16x32_bf16 v[96:99], a[20:23], a[4:7], v[96:99]
    ds_read_b128 a[48:51], v25 offset:2048
    v_mfma_f32_16x16x32_bf16 v[100:103], a[24:27], a[4:7], v[100:103]
    ds_read_b64_tr_b16 a[70:71], v31 offset:16192
    s_add_u32 m0, s73, 3072
    v_mfma_f32_16x16x32_bf16 v[104:107], a[28:31], a[4:7], v[104:107]
    buffer_load_dwordx4 v18, s[32:35], s71 offen  lds
    ds_read_b64_tr_b16 a[72:73], v32 offset:14432
    v_mfma_f32_16x16x32_bf16 v[108:111], a[32:35], a[4:7], v[108:111]
    ds_read_b64_tr_b16 a[74:75], v32 offset:16224
    v_mfma_f32_16x16x32_bf16 v[112:115], a[36:39], a[4:7], v[112:115]
    v_mfma_f32_16x16x32_bf16 v[116:119], a[40:43], a[4:7], v[116:119]
    ds_read_b64_tr_b16 a[76:77], v31 offset:14464
    v_mfma_f32_16x16x32_bf16 v[120:123], a[16:19], a[8:11], v[120:123]
    ds_read_b128 a[52:55], v25 offset:4096
    s_add_u32 m0, s73, 4096
    v_mfma_f32_16x16x32_bf16 v[124:127], a[20:23], a[8:11], v[124:127]
    buffer_load_dwordx4 v19, s[32:35], s71 offen  lds
    ds_read_b64_tr_b16 a[78:79], v31 offset:16256
    v_mfma_f32_16x16x32_bf16 v[128:131], a[24:27], a[8:11], v[128:131]
    ds_read_b64_tr_b16 a[80:81], v32 offset:14496
    v_mfma_f32_16x16x32_bf16 v[132:135], a[28:31], a[8:11], v[132:135]
    v_mfma_f32_16x16x32_bf16 v[136:139], a[32:35], a[8:11], v[136:139]
    ds_read_b64_tr_b16 a[82:83], v32 offset:16288
    v_mfma_f32_16x16x32_bf16 v[140:143], a[36:39], a[8:11], v[140:143]
    ds_read_b128 a[56:59], v25 offset:6144
    v_mfma_f32_16x16x32_bf16 v[144:147], a[40:43], a[8:11], v[144:147]
    s_add_u32 m0, s73, 5120
    v_mfma_f32_16x16x32_bf16 v[148:151], a[16:19], a[12:15], v[148:151]
    buffer_load_dwordx4 v20, s[32:35], s71 offen  lds
    ds_read_b64_tr_b16 a[84:85], v33 offset:14336
    ds_read_b64_tr_b16 a[86:87], v33 offset:16128
    v_mfma_f32_16x16x32_bf16 v[152:155], a[20:23], a[12:15], v[152:155]
    v_mfma_f32_16x16x32_bf16 v[156:159], a[24:27], a[12:15], v[156:159]
    v_mfma_f32_16x16x32_bf16 v[160:163], a[28:31], a[12:15], v[160:163]
    v_mfma_f32_16x16x32_bf16 v[164:167], a[32:35], a[12:15], v[164:167]
    s_add_u32 m0, s73, 6144
    v_mfma_f32_16x16x32_bf16 v[168:171], a[36:39], a[12:15], v[168:171]
    buffer_load_dwordx4 v21, s[32:35], s71 offen  lds
    v_mfma_f32_16x16x32_bf16 v[172:175], a[40:43], a[12:15], v[172:175]
    s_waitcnt vmcnt(14) lgkmcnt(0)
    s_barrier
    v_mfma_f32_16x16x32_bf16 v[64:67], a[60:63], a[44:47], v[64:67]
    ds_read_b64_tr_b16 a[16:17], v34 offset:0
    s_waitcnt vmcnt(12)
    v_mfma_f32_16x16x32_bf16 v[68:71], a[64:67], a[44:47], v[68:71]
    ds_read_b64_tr_b16 a[18:19], v34 offset:1792
    v_mfma_f32_16x16x32_bf16 v[72:75], a[68:71], a[44:47], v[72:75]
    ds_read_b64 a[96:97], v229 offset:0
    v_mfma_f32_16x16x32_bf16 v[76:79], a[72:75], a[44:47], v[76:79]
    ds_read_b128 a[0:3], v26 offset:0
    s_mov_b32 s70, 896
    s_mov_b32 s71, 1605632
    s_add_u32 m0, s72, 45056
    v_mfma_f32_16x16x32_bf16 v[80:83], a[76:79], a[44:47], v[80:83]
    buffer_load_dwordx4 v10, s[28:31], s70 offen lds
    ds_read_b64 a[98:99], v229 offset:32
    ds_read_b64_tr_b16 a[20:21], v35 offset:32
    v_mfma_f32_16x16x32_bf16 v[84:87], a[80:83], a[44:47], v[84:87]
    ds_read_b64_tr_b16 a[22:23], v35 offset:1824
    ds_read_b64 a[100:101], v229 offset:64
    v_mfma_f32_16x16x32_bf16 v[88:91], a[84:87], a[44:47], v[88:91]
    ds_read_b64_tr_b16 a[24:25], v34 offset:64
    v_mfma_f32_16x16x32_bf16 v[92:95], a[60:63], a[48:51], v[92:95]
    ds_read_b64 a[102:103], v229 offset:96
    v_mfma_f32_16x16x32_bf16 v[96:99], a[64:67], a[48:51], v[96:99]
    s_add_u32 m0, s72, 49152
    v_mfma_f32_16x16x32_bf16 v[100:103], a[68:71], a[48:51], v[100:103]
    buffer_load_dwordx4 v11, s[28:31], s70 offen lds
    ds_read_b128 a[4:7], v26 offset:2048
    ds_read_b64_tr_b16 a[26:27], v34 offset:1856
    v_mfma_f32_16x16x32_bf16 v[104:107], a[72:75], a[48:51], v[104:107]
    ds_read_b64_tr_b16 a[28:29], v35 offset:96
    v_mfma_f32_16x16x32_bf16 v[108:111], a[76:79], a[48:51], v[108:111]
    ds_read_b64_tr_b16 a[30:31], v35 offset:1888
    v_mfma_f32_16x16x32_bf16 v[112:115], a[80:83], a[48:51], v[112:115]
    s_add_u32 m0, s72, 53248
    v_mfma_f32_16x16x32_bf16 v[116:119], a[84:87], a[48:51], v[116:119]
    buffer_load_dwordx4 v12, s[28:31], s70 offen lds
    ds_read_b64_tr_b16 a[32:33], v34 offset:128
    v_mfma_f32_16x16x32_bf16 v[120:123], a[60:63], a[52:55], v[120:123]
    ds_read_b128 a[8:11], v26 offset:4096
    v_mfma_f32_16x16x32_bf16 v[124:127], a[64:67], a[52:55], v[124:127]
    ds_read_b64_tr_b16 a[34:35], v34 offset:1920
    v_mfma_f32_16x16x32_bf16 v[128:131], a[68:71], a[52:55], v[128:131]
    ds_read_b64_tr_b16 a[36:37], v35 offset:160
    s_add_u32 m0, s72, 57344
    v_mfma_f32_16x16x32_bf16 v[132:135], a[72:75], a[52:55], v[132:135]
    buffer_load_dwordx4 v13, s[28:31], s70 offen lds
    v_mfma_f32_16x16x32_bf16 v[136:139], a[76:79], a[52:55], v[136:139]
    ds_read_b64_tr_b16 a[38:39], v35 offset:1952
    v_mfma_f32_16x16x32_bf16 v[140:143], a[80:83], a[52:55], v[140:143]
    ds_read_b128 a[12:15], v26 offset:6144
    v_mfma_f32_16x16x32_bf16 v[144:147], a[84:87], a[52:55], v[144:147]
    ds_read_b64_tr_b16 a[40:41], v36 offset:0
    v_mfma_f32_16x16x32_bf16 v[148:151], a[60:63], a[56:59], v[148:151]
    s_add_u32 m0, s73, 45056
    v_mfma_f32_16x16x32_bf16 v[152:155], a[64:67], a[56:59], v[152:155]
    buffer_load_dwordx4 v15, s[32:35], s71 offen  lds
    ds_read_b64_tr_b16 a[42:43], v36 offset:1792
    v_mfma_f32_16x16x32_bf16 v[156:159], a[68:71], a[56:59], v[156:159]
    v_mfma_f32_16x16x32_bf16 v[160:163], a[72:75], a[56:59], v[160:163]
    v_mfma_f32_16x16x32_bf16 v[164:167], a[76:79], a[56:59], v[164:167]
    s_add_u32 m0, s73, 46080
    v_mfma_f32_16x16x32_bf16 v[168:171], a[80:83], a[56:59], v[168:171]
    buffer_load_dwordx4 v16, s[32:35], s71 offen  lds
    v_mfma_f32_16x16x32_bf16 v[172:175], a[84:87], a[56:59], v[172:175]
    s_waitcnt lgkmcnt(0)
    v_mfma_f32_16x16x32_bf16 v[64:67], a[16:19], a[0:3], v[64:67]
    ds_read_b64_tr_b16 a[60:61], v34 offset:14336
    v_mfma_f32_16x16x32_bf16 v[68:71], a[20:23], a[0:3], v[68:71]
    ds_read_b64_tr_b16 a[62:63], v34 offset:16128
    v_mfma_f32_16x16x32_bf16 v[72:75], a[24:27], a[0:3], v[72:75]
    v_mfma_f32_16x16x32_bf16 v[76:79], a[28:31], a[0:3], v[76:79]
    ds_read_b128 a[44:47], v27 offset:0
    v_mfma_f32_16x16x32_bf16 v[80:83], a[32:35], a[0:3], v[80:83]
    s_add_u32 m0, s73, 47104
    v_mfma_f32_16x16x32_bf16 v[84:87], a[36:39], a[0:3], v[84:87]
    buffer_load_dwordx4 v17, s[32:35], s71 offen  lds
    ds_read_b64_tr_b16 a[64:65], v35 offset:14368
    ds_read_b64_tr_b16 a[66:67], v35 offset:16160
    v_mfma_f32_16x16x32_bf16 v[88:91], a[40:43], a[0:3], v[88:91]
    ds_read_b64_tr_b16 a[68:69], v34 offset:14400
    v_mfma_f32_16x16x32_bf16 v[92:95], a[16:19], a[4:7], v[92:95]
    v_mfma_f32_16x16x32_bf16 v[96:99], a[20:23], a[4:7], v[96:99]
    ds_read_b128 a[48:51], v27 offset:2048
    v_mfma_f32_16x16x32_bf16 v[100:103], a[24:27], a[4:7], v[100:103]
    ds_read_b64_tr_b16 a[70:71], v34 offset:16192
    s_add_u32 m0, s73, 48128
    v_mfma_f32_16x16x32_bf16 v[104:107], a[28:31], a[4:7], v[104:107]
    buffer_load_dwordx4 v18, s[32:35], s71 offen  lds
    ds_read_b64_tr_b16 a[72:73], v35 offset:14432
    v_mfma_f32_16x16x32_bf16 v[108:111], a[32:35], a[4:7], v[108:111]
    ds_read_b64_tr_b16 a[74:75], v35 offset:16224
    v_mfma_f32_16x16x32_bf16 v[112:115], a[36:39], a[4:7], v[112:115]
    v_mfma_f32_16x16x32_bf16 v[116:119], a[40:43], a[4:7], v[116:119]
    ds_read_b64_tr_b16 a[76:77], v34 offset:14464
    v_mfma_f32_16x16x32_bf16 v[120:123], a[16:19], a[8:11], v[120:123]
    ds_read_b128 a[52:55], v27 offset:4096
    s_add_u32 m0, s73, 49152
    v_mfma_f32_16x16x32_bf16 v[124:127], a[20:23], a[8:11], v[124:127]
    buffer_load_dwordx4 v19, s[32:35], s71 offen  lds
    ds_read_b64_tr_b16 a[78:79], v34 offset:16256
    v_mfma_f32_16x16x32_bf16 v[128:131], a[24:27], a[8:11], v[128:131]
    ds_read_b64_tr_b16 a[80:81], v35 offset:14496
    v_mfma_f32_16x16x32_bf16 v[132:135], a[28:31], a[8:11], v[132:135]
    v_mfma_f32_16x16x32_bf16 v[136:139], a[32:35], a[8:11], v[136:139]
    ds_read_b64_tr_b16 a[82:83], v35 offset:16288
    v_mfma_f32_16x16x32_bf16 v[140:143], a[36:39], a[8:11], v[140:143]
    ds_read_b128 a[56:59], v27 offset:6144
    v_mfma_f32_16x16x32_bf16 v[144:147], a[40:43], a[8:11], v[144:147]
    s_add_u32 m0, s73, 50176
    v_mfma_f32_16x16x32_bf16 v[148:151], a[16:19], a[12:15], v[148:151]
    buffer_load_dwordx4 v20, s[32:35], s71 offen  lds
    ds_read_b64_tr_b16 a[84:85], v36 offset:14336
    ds_read_b64_tr_b16 a[86:87], v36 offset:16128
    v_mfma_f32_16x16x32_bf16 v[152:155], a[20:23], a[12:15], v[152:155]
    v_mfma_f32_16x16x32_bf16 v[156:159], a[24:27], a[12:15], v[156:159]
    v_mfma_f32_16x16x32_bf16 v[160:163], a[28:31], a[12:15], v[160:163]
    v_mfma_f32_16x16x32_bf16 v[164:167], a[32:35], a[12:15], v[164:167]
    s_add_u32 m0, s73, 51200
    v_mfma_f32_16x16x32_bf16 v[168:171], a[36:39], a[12:15], v[168:171]
    buffer_load_dwordx4 v21, s[32:35], s71 offen  lds
    v_mfma_f32_16x16x32_bf16 v[172:175], a[40:43], a[12:15], v[172:175]
    s_waitcnt vmcnt(11) lgkmcnt(0)
SP1_2:
    v_cmp_ne_u64 vcc, s[66:67], v[44:45]
    s_and_b64 vcc, vcc, s[84:85]
    s_cbranch_vccz SP1_2_ok
    s_sleep 1
    buffer_load_dwordx2 v[44:45], v40, s[36:39], 0 offen sc1
    s_waitcnt vmcnt(0)
    s_branch SP1_2
SP1_2_ok:
    s_barrier
    v_mfma_f32_16x16x32_bf16 v[64:67], a[60:63], a[44:47], v[64:67]
    ds_read_b64_tr_b16 a[16:17], v28 offset:0
    buffer_load_dwordx2 v[58:59], v41, s[36:39], 0 offen sc1
    v_mfma_f32_16x16x32_bf16 v[68:71], a[64:67], a[44:47], v[68:71]
    ds_read_b64_tr_b16 a[18:19], v28 offset:1792
    v_mfma_f32_16x16x32_bf16 v[72:75], a[68:71], a[44:47], v[72:75]
    s_movk_i32 s90, 0
    buffer_load_dword v204, v226, s[36:39], s90 offen offset:0 sc1
    v_mfma_f32_16x16x32_bf16 v[76:79], a[72:75], a[44:47], v[76:79]
    ds_read_b128 a[0:3], v22 offset:0
    buffer_load_dword v205, v226, s[36:39], s90 offen offset:1024 sc1
    v_mfma_f32_16x16x32_bf16 v[80:83], a[76:79], a[44:47], v[80:83]
    ds_read_b64_tr_b16 a[20:21], v29 offset:32
    buffer_load_dword v206, v226, s[36:39], s90 offen offset:2048 sc1
    v_mfma_f32_16x16x32_bf16 v[84:87], a[80:83], a[44:47], v[84:87]
    ds_read_b64_tr_b16 a[22:23], v29 offset:1824
    buffer_load_dword v207, v226, s[36:39], s90 offen offset:3072 sc1
    v_mfma_f32_16x16x32_bf16 v[88:91], a[84:87], a[44:47], v[88:91]
    s_movk_i32 s90, 4096
    buffer_load_dword v208, v226, s[36:39], s90 offen offset:0 sc1
    ds_read_b64_tr_b16 a[24:25], v28 offset:64
    v_mfma_f32_16x16x32_bf16 v[92:95], a[60:63], a[48:51], v[92:95]
    v_mfma_f32_16x16x32_bf16 v[96:99], a[64:67], a[48:51], v[96:99]
    buffer_load_dword v209, v226, s[36:39], s90 offen offset:1024 sc1
    ds_read_b128 a[4:7], v22 offset:2048
    v_mfma_f32_16x16x32_bf16 v[100:103], a[68:71], a[48:51], v[100:103]
    buffer_load_dword v210, v226, s[36:39], s90 offen offset:2048 sc1
    ds_read_b64_tr_b16 a[26:27], v28 offset:1856
    v_mfma_f32_16x16x32_bf16 v[104:107], a[72:75], a[48:51], v[104:107]
    buffer_load_dword v211, v226, s[36:39], s90 offen offset:3072 sc1
    ds_read_b64_tr_b16 a[28:29], v29 offset:96
    v_mfma_f32_16x16x32_bf16 v[108:111], a[76:79], a[48:51], v[108:111]
    s_movk_i32 s90, 8192
    buffer_load_dword v212, v226, s[36:39], s90 offen offset:0 sc1
    ds_read_b64_tr_b16 a[30:31], v29 offset:1888
    v_mfma_f32_16x16x32_bf16 v[112:115], a[80:83], a[48:51], v[112:115]
    buffer_load_dword v213, v226, s[36:39], s90 offen offset:1024 sc1
    v_mfma_f32_16x16x32_bf16 v[116:119], a[84:87], a[48:51], v[116:119]
    ds_read_b64_tr_b16 a[32:33], v28 offset:128
    v_mfma_f32_16x16x32_bf16 v[120:123], a[60:63], a[52:55], v[120:123]
    buffer_load_dword v214, v226, s[36:39], s90 offen offset:2048 sc1
    ds_read_b128 a[8:11], v22 offset:4096
    v_mfma_f32_16x16x32_bf16 v[124:127], a[64:67], a[52:55], v[124:127]
    buffer_load_dword v215, v226, s[36:39], s90 offen offset:3072 sc1
    ds_read_b64_tr_b16 a[34:35], v28 offset:1920
    v_mfma_f32_16x16x32_bf16 v[128:131], a[68:71], a[52:55], v[128:131]
    s_movk_i32 s90, 12288
    buffer_load_dword v216, v226, s[36:39], s90 offen offset:0 sc1
    ds_read_b64_tr_b16 a[36:37], v29 offset:160
    v_mfma_f32_16x16x32_bf16 v[132:135], a[72:75], a[52:55], v[132:135]
    buffer_load_dword v217, v226, s[36:39], s90 offen offset:1024 sc1
    v_mfma_f32_16x16x32_bf16 v[136:139], a[76:79], a[52:55], v[136:139]
    ds_read_b64_tr_b16 a[38:39], v29 offset:1952
    buffer_load_dword v218, v226, s[36:39], s90 offen offset:2048 sc1
    v_mfma_f32_16x16x32_bf16 v[140:143], a[80:83], a[52:55], v[140:143]
    ds_read_b128 a[12:15], v22 offset:6144
    v_mfma_f32_16x16x32_bf16 v[144:147], a[84:87], a[52:55], v[144:147]
    buffer_load_dword v219, v226, s[36:39], s90 offen offset:3072 sc1
    ds_read_b64_tr_b16 a[40:41], v30 offset:0
    v_mfma_f32_16x16x32_bf16 v[148:151], a[60:63], a[56:59], v[148:151]
    s_add_u32 s91, s80, 0
    s_add_u32 m0, s82, 98304
    v_mfma_f32_16x16x32_bf16 v[152:155], a[64:67], a[56:59], v[152:155]
    buffer_load_dwordx4 v61, s[48:51], s91 offen offset:0 lds
    ds_read_b64_tr_b16 a[42:43], v30 offset:1792
    buffer_load_dwordx4 v62, s[48:51], s91 offen offset:1024 lds
    v_mfma_f32_16x16x32_bf16 v[156:159], a[68:71], a[56:59], v[156:159]
    buffer_load_dwordx4 v252, s[48:51], s91 offen offset:2048 lds
    v_mfma_f32_16x16x32_bf16 v[160:163], a[72:75], a[56:59], v[160:163]
    buffer_load_dwordx4 v254, s[48:51], s91 offen offset:3072 lds
    v_mfma_f32_16x16x32_bf16 v[164:167], a[76:79], a[56:59], v[164:167]
    v_mfma_f32_16x16x32_bf16 v[168:171], a[80:83], a[56:59], v[168:171]
    s_add_u32 s91, s80, 32768
    s_add_u32 m0, s82, 114688
    v_mfma_f32_16x16x32_bf16 v[172:175], a[84:87], a[56:59], v[172:175]
    buffer_load_dwordx4 v61, s[48:51], s91 offen offset:0 lds
    buffer_load_dwordx4 v62, s[48:51], s91 offen offset:1024 lds
    s_waitcnt lgkmcnt(0)
    v_mfma_f32_16x16x32_bf16 v[64:67], a[16:19], a[0:3], v[64:67]
    ds_read_b64_tr_b16 a[60:61], v28 offset:14336
    v_mfma_f32_16x16x32_bf16 v[68:71], a[20:23], a[0:3], v[68:71]
    ds_read_b64_tr_b16 a[62:63], v28 offset:16128
    v_mfma_f32_16x16x32_bf16 v[72:75], a[24:27], a[0:3], v[72:75]
    v_mfma_f32_16x16x32_bf16 v[76:79], a[28:31], a[0:3], v[76:79]
    ds_read_b128 a[44:47], v23 offset:0
    buffer_load_dwordx4 v252, s[48:51], s91 offen offset:2048 lds
    v_mfma_f32_16x16x32_bf16 v[80:83], a[32:35], a[0:3], v[80:83]
    ds_read_b64_tr_b16 a[64:65], v29 offset:14368
    v_mfma_f32_16x16x32_bf16 v[84:87], a[36:39], a[0:3], v[84:87]
    ds_read_b64_tr_b16 a[66:67], v29 offset:16160
    v_mfma_f32_16x16x32_bf16 v[88:91], a[40:43], a[0:3], v[88:91]
    ds_read_b64_tr_b16 a[68:69], v28 offset:14400
    v_mfma_f32_16x16x32_bf16 v[92:95], a[16:19], a[4:7], v[92:95]
    v_mfma_f32_16x16x32_bf16 v[96:99], a[20:23], a[4:7], v[96:99]
    buffer_load_dwordx4 v254, s[48:51], s91 offen offset:3072 lds
    ds_read_b128 a[48:51], v23 offset:2048
    v_mfma_f32_16x16x32_bf16 v[100:103], a[24:27], a[4:7], v[100:103]
    ds_read_b64_tr_b16 a[70:71], v28 offset:16192
    v_mfma_f32_16x16x32_bf16 v[104:107], a[28:31], a[4:7], v[104:107]
    ds_read_b64_tr_b16 a[72:73], v29 offset:14432
    v_mfma_f32_16x16x32_bf16 v[108:111], a[32:35], a[4:7], v[108:111]
    ds_read_b64_tr_b16 a[74:75], v29 offset:16224
    v_mfma_f32_16x16x32_bf16 v[112:115], a[36:39], a[4:7], v[112:115]
    s_add_u32 s91, s80, 65536
    s_add_u32 m0, s82, 131072
    v_mfma_f32_16x16x32_bf16 v[116:119], a[40:43], a[4:7], v[116:119]
    buffer_load_dwordx4 v61, s[48:51], s91 offen offset:0 lds
    ds_read_b64_tr_b16 a[76:77], v28 offset:14464
    v_mfma_f32_16x16x32_bf16 v[120:123], a[16:19], a[8:11], v[120:123]
    ds_read_b128 a[52:55], v23 offset:4096
    v_mfma_f32_16x16x32_bf16 v[124:127], a[20:23], a[8:11], v[124:127]
    ds_read_b64_tr_b16 a[78:79], v28 offset:16256
    v_mfma_f32_16x16x32_bf16 v[128:131], a[24:27], a[8:11], v[128:131]
    ds_read_b64_tr_b16 a[80:81], v29 offset:14496
    buffer_load_dwordx4 v62, s[48:51], s91 offen offset:1024 lds
    v_mfma_f32_16x16x32_bf16 v[132:135], a[28:31], a[8:11], v[132:135]
    v_mfma_f32_16x16x32_bf16 v[136:139], a[32:35], a[8:11], v[136:139]
    ds_read_b64_tr_b16 a[82:83], v29 offset:16288
    v_mfma_f32_16x16x32_bf16 v[140:143], a[36:39], a[8:11], v[140:143]
    ds_read_b128 a[56:59], v23 offset:6144
    v_mfma_f32_16x16x32_bf16 v[144:147], a[40:43], a[8:11], v[144:147]
    ds_read_b64_tr_b16 a[84:85], v30 offset:14336
    v_mfma_f32_16x16x32_bf16 v[148:151], a[16:19], a[12:15], v[148:151]
    buffer_load_dwordx4 v252, s[48:51], s91 offen offset:2048 lds
    ds_read_b64_tr_b16 a[86:87], v30 offset:16128
    v_mfma_f32_16x16x32_bf16 v[152:155], a[20:23], a[12:15], v[152:155]
    v_mfma_f32_16x16x32_bf16 v[156:159], a[24:27], a[12:15], v[156:159]
    v_mfma_f32_16x16x32_bf16 v[160:163], a[28:31], a[12:15], v[160:163]
    v_mfma_f32_16x16x32_bf16 v[164:167], a[32:35], a[12:15], v[164:167]
    buffer_load_dwordx4 v254, s[48:51], s91 offen offset:3072 lds
    v_mfma_f32_16x16x32_bf16 v[168:171], a[36:39], a[12:15], v[168:171]
    v_mfma_f32_16x16x32_bf16 v[172:175], a[40:43], a[12:15], v[172:175]
    s_waitcnt vmcnt(12) lgkmcnt(0)
    s_barrier
    v_mfma_f32_16x16x32_bf16 v[64:67], a[60:63], a[44:47], v[64:67]
    v_lshlrev_b32 v2, 1, v60
    v_add_u32 v2, 147456, v2
    v_add_u32 v3, 147456, v60
    ds_read_b64_tr_b16 a[16:17], v31 offset:0
    ds_write_b64 v2, v[58:59]
    v_mfma_f32_16x16x32_bf16 v[68:71], a[64:67], a[44:47], v[68:71]
    v_lshlrev_b32 v57, 16, v57
    ds_write_b32 v3, v57 offset:4096
    ds_read_b64_tr_b16 a[18:19], v31 offset:1792
    v_mfma_f32_16x16x32_bf16 v[72:75], a[68:71], a[44:47], v[72:75]
    v_add_f32 v204, v204, v212
    v_mfma_f32_16x16x32_bf16 v[76:79], a[72:75], a[44:47], v[76:79]
    ds_read_b128 a[0:3], v24 offset:0
    v_mfma_f32_16x16x32_bf16 v[80:83], a[76:79], a[44:47], v[80:83]
    v_add_f32 v205, v205, v213
    ds_read_b64_tr_b16 a[20:21], v32 offset:32
    s_add_u32 s91, s80, 98304
    s_add_u32 m0, s82, 0
    v_mfma_f32_16x16x32_bf16 v[84:87], a[80:83], a[44:47], v[84:87]
    buffer_load_dwordx4 v61, s[48:51], s91 offen offset:0 lds
    v_add_f32 v206, v206, v214
    ds_read_b64_tr_b16 a[22:23], v32 offset:1824
    v_mfma_f32_16x16x32_bf16 v[88:91], a[84:87], a[44:47], v[88:91]
    v_add_f32 v207, v207, v215
    ds_read_b64_tr_b16 a[24:25], v31 offset:64
    v_mfma_f32_16x16x32_bf16 v[92:95], a[60:63], a[48:51], v[92:95]
    v_add_f32 v208, v208, v216
    v_mfma_f32_16x16x32_bf16 v[96:99], a[64:67], a[48:51], v[96:99]
    ds_read_b128 a[4:7], v24 offset:2048
    v_mfma_f32_16x16x32_bf16 v[100:103], a[68:71], a[48:51], v[100:103]
    v_add_f32 v209, v209, v217
    ds_read_b64_tr_b16 a[26:27], v31 offset:1856
    v_mfma_f32_16x16x32_bf16 v[104:107], a[72:75], a[48:51], v[104:107]
    v_add_f32 v210, v210, v218
    ds_read_b64_tr_b16 a[28:29], v32 offset:96
    v_mfma_f32_16x16x32_bf16 v[108:111], a[76:79], a[48:51], v[108:111]
    buffer_load_dwordx4 v62, s[48:51], s91 offen offset:1024 lds
    v_add_f32 v211, v211, v219
    ds_read_b64_tr_b16 a[30:31], v32 offset:1888
    v_mfma_f32_16x16x32_bf16 v[112:115], a[80:83], a[48:51], v[112:115]
    v_add_f32 v204, v204, v208
    v_mfma_f32_16x16x32_bf16 v[116:119], a[84:87], a[48:51], v[116:119]
    ds_read_b64_tr_b16 a[32:33], v31 offset:128
    v_mfma_f32_16x16x32_bf16 v[120:123], a[60:63], a[52:55], v[120:123]
    v_add_f32 v205, v205, v209
    ds_read_b128 a[8:11], v24 offset:4096
    v_mfma_f32_16x16x32_bf16 v[124:127], a[64:67], a[52:55], v[124:127]
    v_add_f32 v206, v206, v210
    ds_read_b64_tr_b16 a[34:35], v31 offset:1920
    v_mfma_f32_16x16x32_bf16 v[128:131], a[68:71], a[52:55], v[128:131]
    v_add_f32 v207, v207, v211
    ds_read_b64_tr_b16 a[36:37], v32 offset:160
    v_mfma_f32_16x16x32_bf16 v[132:135], a[72:75], a[52:55], v[132:135]
    v_add_f32 v204, v204, v206
    v_mfma_f32_16x16x32_bf16 v[136:139], a[76:79], a[52:55], v[136:139]
    buffer_load_dwordx4 v252, s[48:51], s91 offen offset:2048 lds
    ds_read_b64_tr_b16 a[38:39], v32 offset:1952
    v_mfma_f32_16x16x32_bf16 v[140:143], a[80:83], a[52:55], v[140:143]
    v_add_f32 v205, v205, v207
    ds_read_b128 a[12:15], v24 offset:6144
    v_mfma_f32_16x16x32_bf16 v[144:147], a[84:87], a[52:55], v[144:147]
    v_add_f32 v204, v204, v205
    ds_read_b64_tr_b16 a[40:41], v33 offset:0
    v_mfma_f32_16x16x32_bf16 v[148:151], a[60:63], a[56:59], v[148:151]
    ds_write_b32 v3, v204 offset:5120
    ds_read_b64_tr_b16 a[42:43], v33 offset:1792
    v_mfma_f32_16x16x32_bf16 v[152:155], a[64:67], a[56:59], v[152:155]
    v_mfma_f32_16x16x32_bf16 v[156:159], a[68:71], a[56:59], v[156:159]
    v_mfma_f32_16x16x32_bf16 v[160:163], a[72:75], a[56:59], v[160:163]
    buffer_load_dwordx4 v254, s[48:51], s91 offen offset:3072 lds
    v_mfma_f32_16x16x32_bf16 v[164:167], a[76:79], a[56:59], v[164:167]
    v_mfma_f32_16x16x32_bf16 v[168:171], a[80:83], a[56:59], v[168:171]
    v_mfma_f32_16x16x32_bf16 v[172:175], a[84:87], a[56:59], v[172:175]
    s_waitcnt lgkmcnt(0)
    v_mfma_f32_16x16x32_bf16 v[64:67], a[16:19], a[0:3], v[64:67]
    ds_read_b64_tr_b16 a[60:61], v31 offset:14336
    v_mfma_f32_16x16x32_bf16 v[68:71], a[20:23], a[0:3], v[68:71]
    ds_read_b64_tr_b16 a[62:63], v31 offset:16128
    v_mfma_f32_16x16x32_bf16 v[72:75], a[24:27], a[0:3], v[72:75]
    v_mfma_f32_16x16x32_bf16 v[76:79], a[28:31], a[0:3], v[76:79]
    ds_read_b128 a[44:47], v25 offset:0
    v_mfma_f32_16x16x32_bf16 v[80:83], a[32:35], a[0:3], v[80:83]
    ds_read_b64_tr_b16 a[64:65], v32 offset:14368
    s_add_u32 s91, s80, 131072
    s_add_u32 m0, s82, 16384
    v_mfma_f32_16x16x32_bf16 v[84:87], a[36:39], a[0:3], v[84:87]
    buffer_load_dwordx4 v61, s[48:51], s91 offen offset:0 lds
    ds_read_b64_tr_b16 a[66:67], v32 offset:16160
    v_mfma_f32_16x16x32_bf16 v[88:91], a[40:43], a[0:3], v[88:91]
    ds_read_b64_tr_b16 a[68:69], v31 offset:14400
    v_mfma_f32_16x16x32_bf16 v[92:95], a[16:19], a[4:7], v[92:95]
    v_mfma_f32_16x16x32_bf16 v[96:99], a[20:23], a[4:7], v[96:99]
    ds_read_b128 a[48:51], v25 offset:2048
    v_mfma_f32_16x16x32_bf16 v[100:103], a[24:27], a[4:7], v[100:103]
    ds_read_b64_tr_b16 a[70:71], v31 offset:16192
    v_mfma_f32_16x16x32_bf16 v[104:107], a[28:31], a[4:7], v[104:107]
    ds_read_b64_tr_b16 a[72:73], v32 offset:14432
    v_mfma_f32_16x16x32_bf16 v[108:111], a[32:35], a[4:7], v[108:111]
    buffer_load_dwordx4 v62, s[48:51], s91 offen offset:1024 lds
    ds_read_b64_tr_b16 a[74:75], v32 offset:16224
    v_mfma_f32_16x16x32_bf16 v[112:115], a[36:39], a[4:7], v[112:115]
    v_mfma_f32_16x16x32_bf16 v[116:119], a[40:43], a[4:7], v[116:119]
    ds_read_b64_tr_b16 a[76:77], v31 offset:14464
    v_mfma_f32_16x16x32_bf16 v[120:123], a[16:19], a[8:11], v[120:123]
    ds_read_b128 a[52:55], v25 offset:4096
    v_mfma_f32_16x16x32_bf16 v[124:127], a[20:23], a[8:11], v[124:127]
    ds_read_b64_tr_b16 a[78:79], v31 offset:16256
    v_mfma_f32_16x16x32_bf16 v[128:131], a[24:27], a[8:11], v[128:131]
    ds_read_b64_tr_b16 a[80:81], v32 offset:14496
    v_mfma_f32_16x16x32_bf16 v[132:135], a[28:31], a[8:11], v[132:135]
    v_mfma_f32_16x16x32_bf16 v[136:139], a[32:35], a[8:11], v[136:139]
    buffer_load_dwordx4 v252, s[48:51], s91 offen offset:2048 lds
    ds_read_b64_tr_b16 a[82:83], v32 offset:16288
    v_mfma_f32_16x16x32_bf16 v[140:143], a[36:39], a[8:11], v[140:143]
    ds_read_b128 a[56:59], v25 offset:6144
    v_mfma_f32_16x16x32_bf16 v[144:147], a[40:43], a[8:11], v[144:147]
    ds_read_b64_tr_b16 a[84:85], v33 offset:14336
    v_mfma_f32_16x16x32_bf16 v[148:151], a[16:19], a[12:15], v[148:151]
    ds_read_b64_tr_b16 a[86:87], v33 offset:16128
    v_mfma_f32_16x16x32_bf16 v[152:155], a[20:23], a[12:15], v[152:155]
    v_mfma_f32_16x16x32_bf16 v[156:159], a[24:27], a[12:15], v[156:159]
    v_mfma_f32_16x16x32_bf16 v[160:163], a[28:31], a[12:15], v[160:163]
    buffer_load_dwordx4 v254, s[48:51], s91 offen offset:3072 lds
    v_mfma_f32_16x16x32_bf16 v[164:167], a[32:35], a[12:15], v[164:167]
    v_mfma_f32_16x16x32_bf16 v[168:171], a[36:39], a[12:15], v[168:171]
    v_mfma_f32_16x16x32_bf16 v[172:175], a[40:43], a[12:15], v[172:175]
    s_waitcnt vmcnt(20) lgkmcnt(0)
    s_barrier
    v_mfma_f32_16x16x32_bf16 v[64:67], a[60:63], a[44:47], v[64:67]
    ds_read_b64 v[2:3], v237 offset:0
    v_mfma_f32_16x16x32_bf16 v[68:71], a[64:67], a[44:47], v[68:71]
    ds_read_b64 v[4:5], v237 offset:128
    ds_read_b64 v[6:7], v237 offset:256
    v_mfma_f32_16x16x32_bf16 v[72:75], a[68:71], a[44:47], v[72:75]
    ds_read_b64 v[8:9], v237 offset:384
    v_mfma_f32_16x16x32_bf16 v[76:79], a[72:75], a[44:47], v[76:79]
    ds_read_b128 v[176:179], v235 offset:1024
    s_add_u32 s91, s80, 163840
    s_add_u32 m0, s82, 32768
    v_mfma_f32_16x16x32_bf16 v[80:83], a[76:79], a[44:47], v[80:83]
    buffer_load_dwordx4 v61, s[48:51], s91 offen offset:0 lds
    ds_read_b128 v[204:207], v235 offset:0
    v_mfma_f32_16x16x32_bf16 v[84:87], a[80:83], a[44:47], v[84:87]
    ds_read_b128 v[180:183], v235 offset:1088
    ds_read_b128 v[208:211], v235 offset:64
    v_mfma_f32_16x16x32_bf16 v[88:91], a[84:87], a[44:47], v[88:91]
    ds_read_b128 v[184:187], v235 offset:1152
    v_mfma_f32_16x16x32_bf16 v[92:95], a[60:63], a[48:51], v[92:95]
    ds_read_b128 v[212:215], v235 offset:128
    v_mfma_f32_16x16x32_bf16 v[96:99], a[64:67], a[48:51], v[96:99]
    buffer_load_dwordx4 v62, s[48:51], s91 offen offset:1024 lds
    ds_read_b128 v[188:191], v235 offset:1216
    ds_read_b128 v[216:219], v235 offset:192
    v_mfma_f32_16x16x32_bf16 v[100:103], a[68:71], a[48:51], v[100:103]
    ds_read_b128 v[192:195], v235 offset:1280
    v_mfma_f32_16x16x32_bf16 v[104:107], a[72:75], a[48:51], v[104:107]
    ds_read_b128 v[220:223], v235 offset:256
    v_mfma_f32_16x16x32_bf16 v[108:111], a[76:79], a[48:51], v[108:111]
    ds_read_b128 v[196:199], v235 offset:1344
    s_waitcnt vmcnt(10)
    v_mfma_f32_16x16x32_bf16 v[112:115], a[80:83], a[48:51], v[112:115]
    ds_read_b128 v[224:227], v235 offset:320
    ds_read_b64_tr_b16 a[128:129], v244 offset:32768
    buffer_load_dwordx4 v252, s[48:51], s91 offen offset:2048 lds
    ds_read_b64_tr_b16 a[130:131], v244 offset:34816
    ds_read_b128 v[200:203], v236 offset:1024
    v_mfma_f32_16x16x32_bf16 v[116:119], a[84:87], a[48:51], v[116:119]
    ds_read_b64_tr_b16 a[132:133], v245 offset:32768
    ds_read_b128 v[228:231], v236 offset:0
    ds_read_b64_tr_b16 a[134:135], v245 offset:34816
    v_mfma_f32_16x16x32_bf16 v[120:123], a[60:63], a[52:55], v[120:123]
    ds_read_b64_tr_b16 a[136:137], v246 offset:32768
    v_mfma_f32_16x16x32_bf16 v[124:127], a[64:67], a[52:55], v[124:127]
    ds_read_b64_tr_b16 a[138:139], v246 offset:34816
    ds_read_b64_tr_b16 a[140:141], v247 offset:32768
    v_mfma_f32_16x16x32_bf16 v[128:131], a[68:71], a[52:55], v[128:131]
    ds_read_b64_tr_b16 a[142:143], v247 offset:34816
    buffer_load_dwordx4 v254, s[48:51], s91 offen offset:3072 lds
    v_mfma_f32_16x16x32_bf16 v[132:135], a[72:75], a[52:55], v[132:135]
    ds_read_b64_tr_b16 a[144:145], v244 offset:49152
    ds_read_b64_tr_b16 a[146:147], v244 offset:51200
    v_mfma_f32_16x16x32_bf16 v[136:139], a[76:79], a[52:55], v[136:139]
    ds_read_b64_tr_b16 a[148:149], v245 offset:49152
    ds_read_b64_tr_b16 a[150:151], v245 offset:51200
    v_mfma_f32_16x16x32_bf16 v[140:143], a[80:83], a[52:55], v[140:143]
    ds_read_b64_tr_b16 a[152:153], v246 offset:49152
    v_mfma_f32_16x16x32_bf16 v[144:147], a[84:87], a[52:55], v[144:147]
    ds_read_b64_tr_b16 a[154:155], v246 offset:51200
    ds_read_b64_tr_b16 a[156:157], v247 offset:49152
    v_mfma_f32_16x16x32_bf16 v[148:151], a[60:63], a[56:59], v[148:151]
    s_add_u32 s91, s80, 196608
    s_add_u32 m0, s82, 49152
    v_mfma_f32_16x16x32_bf16 v[152:155], a[64:67], a[56:59], v[152:155]
    buffer_load_dwordx4 v61, s[48:51], s91 offen offset:0 lds
    ds_read_b64_tr_b16 a[158:159], v247 offset:51200
    ds_read_b64_tr_b16 a[160:161], v248 offset:0
    ds_read_b64_tr_b16 a[162:163], v248 offset:2048
    v_mfma_f32_16x16x32_bf16 v[156:159], a[68:71], a[56:59], v[156:159]
    ds_read_b64_tr_b16 a[164:165], v249 offset:0
    ds_read_b64_tr_b16 a[166:167], v249 offset:2048
    v_mfma_f32_16x16x32_bf16 v[160:163], a[72:75], a[56:59], v[160:163]
    ds_read_b64_tr_b16 a[168:169], v250 offset:0
    v_mfma_f32_16x16x32_bf16 v[164:167], a[76:79], a[56:59], v[164:167]
    ds_read_b64_tr_b16 a[170:171], v250 offset:2048
    ds_read_b64_tr_b16 a[172:173], v251 offset:0
    buffer_load_dwordx4 v62, s[48:51], s91 offen offset:1024 lds
    v_mfma_f32_16x16x32_bf16 v[168:171], a[80:83], a[56:59], v[168:171]
    ds_read_b64_tr_b16 a[174:175], v251 offset:2048
    v_mfma_f32_16x16x32_bf16 v[172:175], a[84:87], a[56:59], v[172:175]
    buffer_load_dwordx4 v252, s[48:51], s91 offen offset:2048 lds
    buffer_load_dwordx4 v254, s[48:51], s91 offen offset:3072 lds
    s_waitcnt lgkmcnt(0)
    s_barrier
    s_add_u32 s90, s10, 0
    s_nop 0
    v_pk_fma_f32 v[64:65], v[176:177], v[2:3], v[64:65] op_sel:[0,0,0] op_sel_hi:[1,0,1]
    v_pk_fma_f32 v[68:69], v[180:181], v[2:3], v[68:69] op_sel:[0,0,0] op_sel_hi:[1,0,1]
    v_pk_fma_f32 v[66:67], v[178:179], v[2:3], v[66:67] op_sel:[0,0,0] op_sel_hi:[1,0,1]
    v_pk_fma_f32 v[70:71], v[182:183], v[2:3], v[70:71] op_sel:[0,0,0] op_sel_hi:[1,0,1]
    v_pk_fma_f32 v[64:65], v[64:65], v[2:3], v[204:205] op_sel:[0,1,0] op_sel_hi:[1,1,1]
    v_pk_fma_f32 v[68:69], v[68:69], v[2:3], v[208:209] op_sel:[0,1,0] op_sel_hi:[1,1,1]
    v_pk_fma_f32 v[66:67], v[66:67], v[2:3], v[206:207] op_sel:[0,1,0] op_sel_hi:[1,1,1]
    v_pk_fma_f32 v[70:71], v[70:71], v[2:3], v[210:211] op_sel:[0,1,0] op_sel_hi:[1,1,1]
    v_max_f32 v64, 0, v64
    v_max_f32 v68, 0, v68
    v_max_f32 v65, 0, v65
    v_max_f32 v69, 0, v69
    v_max_f32 v66, 0, v66
    v_max_f32 v70, 0, v70
    v_max_f32 v67, 0, v67
    v_max_f32 v71, 0, v71
    v_pk_mul_f32 v[64:65], v[64:65], v[64:65]
    v_pk_mul_f32 v[68:69], v[68:69], v[68:69]
    v_pk_mul_f32 v[66:67], v[66:67], v[66:67]
    v_pk_mul_f32 v[70:71], v[70:71], v[70:71]
    v_cvt_pk_bf16_f32 v38, v64, v65
    v_cvt_pk_bf16_f32 v40, v68, v69
    v_cvt_pk_bf16_f32 v39, v66, v67
    v_cvt_pk_bf16_f32 v41, v70, v71
    buffer_store_dwordx4 v[38:41], v63, s[36:39], s90 offen sc1
    s_add_u32 s90, s10, 4096
    v_pk_fma_f32 v[72:73], v[184:185], v[2:3], v[72:73] op_sel:[0,0,0] op_sel_hi:[1,0,1]
    v_pk_fma_f32 v[76:77], v[188:189], v[2:3], v[76:77] op_sel:[0,0,0] op_sel_hi:[1,0,1]
    v_pk_fma_f32 v[74:75], v[186:187], v[2:3], v[74:75] op_sel:[0,0,0] op_sel_hi:[1,0,1]
    v_pk_fma_f32 v[78:79], v[190:191], v[2:3], v[78:79] op_sel:[0,0,0] op_sel_hi:[1,0,1]
    v_pk_fma_f32 v[72:73], v[72:73], v[2:3], v[212:213] op_sel:[0,1,0] op_sel_hi:[1,1,1]
    v_pk_fma_f32 v[76:77], v[76:77], v[2:3], v[216:217] op_sel:[0,1,0] op_sel_hi:[1,1,1]
    v_pk_fma_f32 v[74:75], v[74:75], v[2:3], v[214:215] op_sel:[0,1,0] op_sel_hi:[1,1,1]
    v_pk_fma_f32 v[78:79], v[78:79], v[2:3], v[218:219] op_sel:[0,1,0] op_sel_hi:[1,1,1]
    v_max_f32 v72, 0, v72
    v_max_f32 v76, 0, v76
    v_max_f32 v73, 0, v73
    v_max_f32 v77, 0, v77
    v_max_f32 v74, 0, v74
    v_max_f32 v78, 0, v78
    v_max_f32 v75, 0, v75
    v_max_f32 v79, 0, v79
    v_pk_mul_f32 v[72:73], v[72:73], v[72:73]
    v_pk_mul_f32 v[76:77], v[76:77], v[76:77]
    v_pk_mul_f32 v[74:75], v[74:75], v[74:75]
    v_pk_mul_f32 v[78:79], v[78:79], v[78:79]
    v_cvt_pk_bf16_f32 v42, v72, v73
    v_cvt_pk_bf16_f32 v44, v76, v77
    v_cvt_pk_bf16_f32 v43, v74, v75
    v_cvt_pk_bf16_f32 v45, v78, v79
    buffer_store_dwordx4 v[42:45], v63, s[36:39], s90 offen sc1
    s_add_u32 s90, s10, 8192
    v_pk_fma_f32 v[80:81], v[192:193], v[2:3], v[80:81] op_sel:[0,0,0] op_sel_hi:[1,0,1]
    v_pk_fma_f32 v[84:85], v[196:197], v[2:3], v[84:85] op_sel:[0,0,0] op_sel_hi:[1,0,1]
    v_pk_fma_f32 v[82:83], v[194:195], v[2:3], v[82:83] op_sel:[0,0,0] op_sel_hi:[1,0,1]
    v_pk_fma_f32 v[86:87], v[198:199], v[2:3], v[86:87] op_sel:[0,0,0] op_sel_hi:[1,0,1]
    v_pk_fma_f32 v[80:81], v[80:81], v[2:3], v[220:221] op_sel:[0,1,0] op_sel_hi:[1,1,1]
    v_pk_fma_f32 v[84:85], v[84:85], v[2:3], v[224:225] op_sel:[0,1,0] op_sel_hi:[1,1,1]
    v_pk_fma_f32 v[82:83], v[82:83], v[2:3], v[222:223] op_sel:[0,1,0] op_sel_hi:[1,1,1]
    v_pk_fma_f32 v[86:87], v[86:87], v[2:3], v[226:227] op_sel:[0,1,0] op_sel_hi:[1,1,1]
    v_max_f32 v80, 0, v80
    v_max_f32 v84, 0, v84
    v_max_f32 v81, 0, v81
    v_max_f32 v85, 0, v85
    v_max_f32 v82, 0, v82
    v_max_f32 v86, 0, v86
    v_max_f32 v83, 0, v83
    v_max_f32 v87, 0, v87
    v_pk_mul_f32 v[80:81], v[80:81], v[80:81]
    v_pk_mul_f32 v[84:85], v[84:85], v[84:85]
    v_pk_mul_f32 v[82:83], v[82:83], v[82:83]
    v_pk_mul_f32 v[86:87], v[86:87], v[86:87]
    v_cvt_pk_bf16_f32 v46, v80, v81
    v_cvt_pk_bf16_f32 v48, v84, v85
    v_cvt_pk_bf16_f32 v47, v82, v83
    v_cvt_pk_bf16_f32 v49, v86, v87
    buffer_store_dwordx4 v[46:49], v63, s[36:39], s90 offen sc1
    v_pk_fma_f32 v[88:89], v[200:201], v[2:3], v[88:89] op_sel:[0,0,0] op_sel_hi:[1,0,1]
    v_pk_fma_f32 v[90:91], v[202:203], v[2:3], v[90:91] op_sel:[0,0,0] op_sel_hi:[1,0,1]
    v_pk_fma_f32 v[88:89], v[88:89], v[2:3], v[228:229] op_sel:[0,1,0] op_sel_hi:[1,1,1]
    v_pk_fma_f32 v[90:91], v[90:91], v[2:3], v[230:231] op_sel:[0,1,0] op_sel_hi:[1,1,1]
    v_max_f32 v88, 0, v88
    v_max_f32 v89, 0, v89
    v_max_f32 v90, 0, v90
    v_max_f32 v91, 0, v91
    v_pk_mul_f32 v[88:89], v[88:89], v[88:89]
    v_pk_mul_f32 v[90:91], v[90:91], v[90:91]
    v_cvt_pk_bf16_f32 v50, v88, v89
    v_cvt_pk_bf16_f32 v51, v90, v91
    s_add_u32 s90, s10, 1024
    v_pk_fma_f32 v[92:93], v[176:177], v[4:5], v[92:93] op_sel:[0,0,0] op_sel_hi:[1,0,1]
    v_pk_fma_f32 v[96:97], v[180:181], v[4:5], v[96:97] op_sel:[0,0,0] op_sel_hi:[1,0,1]
    v_pk_fma_f32 v[94:95], v[178:179], v[4:5], v[94:95] op_sel:[0,0,0] op_sel_hi:[1,0,1]
    v_pk_fma_f32 v[98:99], v[182:183], v[4:5], v[98:99] op_sel:[0,0,0] op_sel_hi:[1,0,1]
    v_pk_fma_f32 v[92:93], v[92:93], v[4:5], v[204:205] op_sel:[0,1,0] op_sel_hi:[1,1,1]
    v_pk_fma_f32 v[96:97], v[96:97], v[4:5], v[208:209] op_sel:[0,1,0] op_sel_hi:[1,1,1]
    v_pk_fma_f32 v[94:95], v[94:95], v[4:5], v[206:207] op_sel:[0,1,0] op_sel_hi:[1,1,1]
    v_pk_fma_f32 v[98:99], v[98:99], v[4:5], v[210:211] op_sel:[0,1,0] op_sel_hi:[1,1,1]
    v_max_f32 v92, 0, v92
    v_max_f32 v96, 0, v96
    v_max_f32 v93, 0, v93
    v_max_f32 v97, 0, v97
    v_max_f32 v94, 0, v94
    v_max_f32 v98, 0, v98
    v_max_f32 v95, 0, v95
    v_max_f32 v99, 0, v99
    v_pk_mul_f32 v[92:93], v[92:93], v[92:93]
    v_pk_mul_f32 v[96:97], v[96:97], v[96:97]
    v_pk_mul_f32 v[94:95], v[94:95], v[94:95]
    v_pk_mul_f32 v[98:99], v[98:99], v[98:99]
    v_cvt_pk_bf16_f32 v38, v92, v93
    v_cvt_pk_bf16_f32 v40, v96, v97
    v_cvt_pk_bf16_f32 v39, v94, v95
    v_cvt_pk_bf16_f32 v41, v98, v99
    buffer_store_dwordx4 v[38:41], v63, s[36:39], s90 offen sc1
    s_add_u32 s90, s10, 5120
    v_pk_fma_f32 v[100:101], v[184:185], v[4:5], v[100:101] op_sel:[0,0,0] op_sel_hi:[1,0,1]
    v_pk_fma_f32 v[104:105], v[188:189], v[4:5], v[104:105] op_sel:[0,0,0] op_sel_hi:[1,0,1]
    v_pk_fma_f32 v[102:103], v[186:187], v[4:5], v[102:103] op_sel:[0,0,0] op_sel_hi:[1,0,1]
    v_pk_fma_f32 v[106:107], v[190:191], v[4:5], v[106:107] op_sel:[0,0,0] op_sel_hi:[1,0,1]
    v_pk_fma_f32 v[100:101], v[100:101], v[4:5], v[212:213] op_sel:[0,1,0] op_sel_hi:[1,1,1]
    v_pk_fma_f32 v[104:105], v[104:105], v[4:5], v[216:217] op_sel:[0,1,0] op_sel_hi:[1,1,1]
    v_pk_fma_f32 v[102:103], v[102:103], v[4:5], v[214:215] op_sel:[0,1,0] op_sel_hi:[1,1,1]
    v_pk_fma_f32 v[106:107], v[106:107], v[4:5], v[218:219] op_sel:[0,1,0] op_sel_hi:[1,1,1]
    v_max_f32 v100, 0, v100
    v_max_f32 v104, 0, v104
    v_max_f32 v101, 0, v101
    v_max_f32 v105, 0, v105
    v_max_f32 v102, 0, v102
    v_max_f32 v106, 0, v106
    v_max_f32 v103, 0, v103
    v_max_f32 v107, 0, v107
    v_pk_mul_f32 v[100:101], v[100:101], v[100:101]
    v_pk_mul_f32 v[104:105], v[104:105], v[104:105]
    v_pk_mul_f32 v[102:103], v[102:103], v[102:103]
    v_pk_mul_f32 v[106:107], v[106:107], v[106:107]
    v_cvt_pk_bf16_f32 v42, v100, v101
    v_cvt_pk_bf16_f32 v44, v104, v105
    v_cvt_pk_bf16_f32 v43, v102, v103
    v_cvt_pk_bf16_f32 v45, v106, v107
    buffer_store_dwordx4 v[42:45], v63, s[36:39], s90 offen sc1
    s_add_u32 s90, s10, 9216
    v_pk_fma_f32 v[108:109], v[192:193], v[4:5], v[108:109] op_sel:[0,0,0] op_sel_hi:[1,0,1]
    v_pk_fma_f32 v[112:113], v[196:197], v[4:5], v[112:113] op_sel:[0,0,0] op_sel_hi:[1,0,1]
    v_pk_fma_f32 v[110:111], v[194:195], v[4:5], v[110:111] op_sel:[0,0,0] op_sel_hi:[1,0,1]
    v_pk_fma_f32 v[114:115], v[198:199], v[4:5], v[114:115] op_sel:[0,0,0] op_sel_hi:[1,0,1]
    v_pk_fma_f32 v[108:109], v[108:109], v[4:5], v[220:221] op_sel:[0,1,0] op_sel_hi:[1,1,1]
    v_pk_fma_f32 v[112:113], v[112:113], v[4:5], v[224:225] op_sel:[0,1,0] op_sel_hi:[1,1,1]
    v_pk_fma_f32 v[110:111], v[110:111], v[4:5], v[222:223] op_sel:[0,1,0] op_sel_hi:[1,1,1]
    v_pk_fma_f32 v[114:115], v[114:115], v[4:5], v[226:227] op_sel:[0,1,0] op_sel_hi:[1,1,1]
    v_max_f32 v108, 0, v108
    v_max_f32 v112, 0, v112
    v_max_f32 v109, 0, v109
    v_max_f32 v113, 0, v113
    v_max_f32 v110, 0, v110
    v_max_f32 v114, 0, v114
    v_max_f32 v111, 0, v111
    v_max_f32 v115, 0, v115
    v_pk_mul_f32 v[108:109], v[108:109], v[108:109]
    v_pk_mul_f32 v[112:113], v[112:113], v[112:113]
    v_pk_mul_f32 v[110:111], v[110:111], v[110:111]
    v_pk_mul_f32 v[114:115], v[114:115], v[114:115]
    v_cvt_pk_bf16_f32 v46, v108, v109
    v_cvt_pk_bf16_f32 v48, v112, v113
    v_cvt_pk_bf16_f32 v47, v110, v111
    v_cvt_pk_bf16_f32 v49, v114, v115
    buffer_store_dwordx4 v[46:49], v63, s[36:39], s90 offen sc1
    s_add_u32 s90, s11, 0
    s_nop 0
    v_pk_fma_f32 v[116:117], v[200:201], v[4:5], v[116:117] op_sel:[0,0,0] op_sel_hi:[1,0,1]
    v_pk_fma_f32 v[118:119], v[202:203], v[4:5], v[118:119] op_sel:[0,0,0] op_sel_hi:[1,0,1]
    v_pk_fma_f32 v[116:117], v[116:117], v[4:5], v[228:229] op_sel:[0,1,0] op_sel_hi:[1,1,1]
    v_pk_fma_f32 v[118:119], v[118:119], v[4:5], v[230:231] op_sel:[0,1,0] op_sel_hi:[1,1,1]
    v_max_f32 v116, 0, v116
    v_max_f32 v117, 0, v117
    v_max_f32 v118, 0, v118
    v_max_f32 v119, 0, v119
    v_pk_mul_f32 v[116:117], v[116:117], v[116:117]
    v_pk_mul_f32 v[118:119], v[118:119], v[118:119]
    v_cvt_pk_bf16_f32 v52, v116, v117
    v_cvt_pk_bf16_f32 v53, v118, v119
    buffer_store_dwordx4 v[50:53], v63, s[36:39], s90 offen sc1
    s_add_u32 s90, s10, 2048
    v_pk_fma_f32 v[120:121], v[176:177], v[6:7], v[120:121] op_sel:[0,0,0] op_sel_hi:[1,0,1]
    v_pk_fma_f32 v[124:125], v[180:181], v[6:7], v[124:125] op_sel:[0,0,0] op_sel_hi:[1,0,1]
    v_pk_fma_f32 v[122:123], v[178:179], v[6:7], v[122:123] op_sel:[0,0,0] op_sel_hi:[1,0,1]
    v_pk_fma_f32 v[126:127], v[182:183], v[6:7], v[126:127] op_sel:[0,0,0] op_sel_hi:[1,0,1]
    v_pk_fma_f32 v[120:121], v[120:121], v[6:7], v[204:205] op_sel:[0,1,0] op_sel_hi:[1,1,1]
    v_pk_fma_f32 v[124:125], v[124:125], v[6:7], v[208:209] op_sel:[0,1,0] op_sel_hi:[1,1,1]
    v_pk_fma_f32 v[122:123], v[122:123], v[6:7], v[206:207] op_sel:[0,1,0] op_sel_hi:[1,1,1]
    v_pk_fma_f32 v[126:127], v[126:127], v[6:7], v[210:211] op_sel:[0,1,0] op_sel_hi:[1,1,1]
    v_max_f32 v120, 0, v120
    v_max_f32 v124, 0, v124
    v_max_f32 v121, 0, v121
    v_max_f32 v125, 0, v125
    v_max_f32 v122, 0, v122
    v_max_f32 v126, 0, v126
    v_max_f32 v123, 0, v123
    v_max_f32 v127, 0, v127
    v_pk_mul_f32 v[120:121], v[120:121], v[120:121]
    v_pk_mul_f32 v[124:125], v[124:125], v[124:125]
    v_pk_mul_f32 v[122:123], v[122:123], v[122:123]
    v_pk_mul_f32 v[126:127], v[126:127], v[126:127]
    v_cvt_pk_bf16_f32 v38, v120, v121
    v_cvt_pk_bf16_f32 v40, v124, v125
    v_cvt_pk_bf16_f32 v39, v122, v123
    v_cvt_pk_bf16_f32 v41, v126, v127
    buffer_store_dwordx4 v[38:41], v63, s[36:39], s90 offen sc1
    s_add_u32 s90, s10, 6144
    v_pk_fma_f32 v[128:129], v[184:185], v[6:7], v[128:129] op_sel:[0,0,0] op_sel_hi:[1,0,1]
    v_pk_fma_f32 v[132:133], v[188:189], v[6:7], v[132:133] op_sel:[0,0,0] op_sel_hi:[1,0,1]
    v_pk_fma_f32 v[130:131], v[186:187], v[6:7], v[130:131] op_sel:[0,0,0] op_sel_hi:[1,0,1]
    v_pk_fma_f32 v[134:135], v[190:191], v[6:7], v[134:135] op_sel:[0,0,0] op_sel_hi:[1,0,1]
    v_pk_fma_f32 v[128:129], v[128:129], v[6:7], v[212:213] op_sel:[0,1,0] op_sel_hi:[1,1,1]
    v_pk_fma_f32 v[132:133], v[132:133], v[6:7], v[216:217] op_sel:[0,1,0] op_sel_hi:[1,1,1]
    v_pk_fma_f32 v[130:131], v[130:131], v[6:7], v[214:215] op_sel:[0,1,0] op_sel_hi:[1,1,1]
    v_pk_fma_f32 v[134:135], v[134:135], v[6:7], v[218:219] op_sel:[0,1,0] op_sel_hi:[1,1,1]
    v_max_f32 v128, 0, v128
    v_max_f32 v132, 0, v132
    v_max_f32 v129, 0, v129
    v_max_f32 v133, 0, v133
    v_max_f32 v130, 0, v130
    v_max_f32 v134, 0, v134
    v_max_f32 v131, 0, v131
    v_max_f32 v135, 0, v135
    v_pk_mul_f32 v[128:129], v[128:129], v[128:129]
    v_pk_mul_f32 v[132:133], v[132:133], v[132:133]
    v_pk_mul_f32 v[130:131], v[130:131], v[130:131]
    v_pk_mul_f32 v[134:135], v[134:135], v[134:135]
    v_cvt_pk_bf16_f32 v42, v128, v129
    v_cvt_pk_bf16_f32 v44, v132, v133
    v_cvt_pk_bf16_f32 v43, v130, v131
    v_cvt_pk_bf16_f32 v45, v134, v135
    buffer_store_dwordx4 v[42:45], v63, s[36:39], s90 offen sc1
    s_add_u32 s90, s10, 10240
    v_pk_fma_f32 v[136:137], v[192:193], v[6:7], v[136:137] op_sel:[0,0,0] op_sel_hi:[1,0,1]
    v_pk_fma_f32 v[140:141], v[196:197], v[6:7], v[140:141] op_sel:[0,0,0] op_sel_hi:[1,0,1]
    v_pk_fma_f32 v[138:139], v[194:195], v[6:7], v[138:139] op_sel:[0,0,0] op_sel_hi:[1,0,1]
    v_pk_fma_f32 v[142:143], v[198:199], v[6:7], v[142:143] op_sel:[0,0,0] op_sel_hi:[1,0,1]
    v_pk_fma_f32 v[136:137], v[136:137], v[6:7], v[220:221] op_sel:[0,1,0] op_sel_hi:[1,1,1]
    v_pk_fma_f32 v[140:141], v[140:141], v[6:7], v[224:225] op_sel:[0,1,0] op_sel_hi:[1,1,1]
    v_pk_fma_f32 v[138:139], v[138:139], v[6:7], v[222:223] op_sel:[0,1,0] op_sel_hi:[1,1,1]
    v_pk_fma_f32 v[142:143], v[142:143], v[6:7], v[226:227] op_sel:[0,1,0] op_sel_hi:[1,1,1]
    v_max_f32 v136, 0, v136
    v_max_f32 v140, 0, v140
    v_max_f32 v137, 0, v137
    v_max_f32 v141, 0, v141
    v_max_f32 v138, 0, v138
    v_max_f32 v142, 0, v142
    v_max_f32 v139, 0, v139
    v_max_f32 v143, 0, v143
    v_pk_mul_f32 v[136:137], v[136:137], v[136:137]
    v_pk_mul_f32 v[140:141], v[140:141], v[140:141]
    v_pk_mul_f32 v[138:139], v[138:139], v[138:139]
    v_pk_mul_f32 v[142:143], v[142:143], v[142:143]
    v_cvt_pk_bf16_f32 v46, v136, v137
    v_cvt_pk_bf16_f32 v48, v140, v141
    v_cvt_pk_bf16_f32 v47, v138, v139
    v_cvt_pk_bf16_f32 v49, v142, v143
    buffer_store_dwordx4 v[46:49], v63, s[36:39], s90 offen sc1
    v_pk_fma_f32 v[144:145], v[200:201], v[6:7], v[144:145] op_sel:[0,0,0] op_sel_hi:[1,0,1]
    v_pk_fma_f32 v[146:147], v[202:203], v[6:7], v[146:147] op_sel:[0,0,0] op_sel_hi:[1,0,1]
    v_pk_fma_f32 v[144:145], v[144:145], v[6:7], v[228:229] op_sel:[0,1,0] op_sel_hi:[1,1,1]
    v_pk_fma_f32 v[146:147], v[146:147], v[6:7], v[230:231] op_sel:[0,1,0] op_sel_hi:[1,1,1]
    v_max_f32 v144, 0, v144
    v_max_f32 v145, 0, v145
    v_max_f32 v146, 0, v146
    v_max_f32 v147, 0, v147
    v_pk_mul_f32 v[144:145], v[144:145], v[144:145]
    v_pk_mul_f32 v[146:147], v[146:147], v[146:147]
    v_cvt_pk_bf16_f32 v54, v144, v145
    v_cvt_pk_bf16_f32 v55, v146, v147
    s_add_u32 s90, s10, 3072
    v_pk_fma_f32 v[148:149], v[176:177], v[8:9], v[148:149] op_sel:[0,0,0] op_sel_hi:[1,0,1]
    v_pk_fma_f32 v[152:153], v[180:181], v[8:9], v[152:153] op_sel:[0,0,0] op_sel_hi:[1,0,1]
    v_pk_fma_f32 v[150:151], v[178:179], v[8:9], v[150:151] op_sel:[0,0,0] op_sel_hi:[1,0,1]
    v_pk_fma_f32 v[154:155], v[182:183], v[8:9], v[154:155] op_sel:[0,0,0] op_sel_hi:[1,0,1]
    v_pk_fma_f32 v[148:149], v[148:149], v[8:9], v[204:205] op_sel:[0,1,0] op_sel_hi:[1,1,1]
    v_pk_fma_f32 v[152:153], v[152:153], v[8:9], v[208:209] op_sel:[0,1,0] op_sel_hi:[1,1,1]
    v_pk_fma_f32 v[150:151], v[150:151], v[8:9], v[206:207] op_sel:[0,1,0] op_sel_hi:[1,1,1]
    v_pk_fma_f32 v[154:155], v[154:155], v[8:9], v[210:211] op_sel:[0,1,0] op_sel_hi:[1,1,1]
    v_max_f32 v148, 0, v148
    v_max_f32 v152, 0, v152
    v_max_f32 v149, 0, v149
    v_max_f32 v153, 0, v153
    v_max_f32 v150, 0, v150
    v_max_f32 v154, 0, v154
    v_max_f32 v151, 0, v151
    v_max_f32 v155, 0, v155
    v_pk_mul_f32 v[148:149], v[148:149], v[148:149]
    v_pk_mul_f32 v[152:153], v[152:153], v[152:153]
    v_pk_mul_f32 v[150:151], v[150:151], v[150:151]
    v_pk_mul_f32 v[154:155], v[154:155], v[154:155]
    v_cvt_pk_bf16_f32 v38, v148, v149
    v_cvt_pk_bf16_f32 v40, v152, v153
    v_cvt_pk_bf16_f32 v39, v150, v151
    v_cvt_pk_bf16_f32 v41, v154, v155
    buffer_store_dwordx4 v[38:41], v63, s[36:39], s90 offen sc1
    s_add_u32 s90, s10, 7168
    v_pk_fma_f32 v[156:157], v[184:185], v[8:9], v[156:157] op_sel:[0,0,0] op_sel_hi:[1,0,1]
    v_pk_fma_f32 v[160:161], v[188:189], v[8:9], v[160:161] op_sel:[0,0,0] op_sel_hi:[1,0,1]
    v_pk_fma_f32 v[158:159], v[186:187], v[8:9], v[158:159] op_sel:[0,0,0] op_sel_hi:[1,0,1]
    v_pk_fma_f32 v[162:163], v[190:191], v[8:9], v[162:163] op_sel:[0,0,0] op_sel_hi:[1,0,1]
    v_pk_fma_f32 v[156:157], v[156:157], v[8:9], v[212:213] op_sel:[0,1,0] op_sel_hi:[1,1,1]
    v_pk_fma_f32 v[160:161], v[160:161], v[8:9], v[216:217] op_sel:[0,1,0] op_sel_hi:[1,1,1]
    v_pk_fma_f32 v[158:159], v[158:159], v[8:9], v[214:215] op_sel:[0,1,0] op_sel_hi:[1,1,1]
    v_pk_fma_f32 v[162:163], v[162:163], v[8:9], v[218:219] op_sel:[0,1,0] op_sel_hi:[1,1,1]
    v_max_f32 v156, 0, v156
    v_max_f32 v160, 0, v160
    v_max_f32 v157, 0, v157
    v_max_f32 v161, 0, v161
    v_max_f32 v158, 0, v158
    v_max_f32 v162, 0, v162
    v_max_f32 v159, 0, v159
    v_max_f32 v163, 0, v163
    v_pk_mul_f32 v[156:157], v[156:157], v[156:157]
    v_pk_mul_f32 v[160:161], v[160:161], v[160:161]
    v_pk_mul_f32 v[158:159], v[158:159], v[158:159]
    v_pk_mul_f32 v[162:163], v[162:163], v[162:163]
    v_cvt_pk_bf16_f32 v42, v156, v157
    v_cvt_pk_bf16_f32 v44, v160, v161
    v_cvt_pk_bf16_f32 v43, v158, v159
    v_cvt_pk_bf16_f32 v45, v162, v163
    buffer_store_dwordx4 v[42:45], v63, s[36:39], s90 offen sc1
    s_add_u32 s90, s10, 11264
    v_pk_fma_f32 v[164:165], v[192:193], v[8:9], v[164:165] op_sel:[0,0,0] op_sel_hi:[1,0,1]
    v_pk_fma_f32 v[168:169], v[196:197], v[8:9], v[168:169] op_sel:[0,0,0] op_sel_hi:[1,0,1]
    v_pk_fma_f32 v[166:167], v[194:195], v[8:9], v[166:167] op_sel:[0,0,0] op_sel_hi:[1,0,1]
    v_pk_fma_f32 v[170:171], v[198:199], v[8:9], v[170:171] op_sel:[0,0,0] op_sel_hi:[1,0,1]
    v_pk_fma_f32 v[164:165], v[164:165], v[8:9], v[220:221] op_sel:[0,1,0] op_sel_hi:[1,1,1]
    v_pk_fma_f32 v[168:169], v[168:169], v[8:9], v[224:225] op_sel:[0,1,0] op_sel_hi:[1,1,1]
    v_pk_fma_f32 v[166:167], v[166:167], v[8:9], v[222:223] op_sel:[0,1,0] op_sel_hi:[1,1,1]
    v_pk_fma_f32 v[170:171], v[170:171], v[8:9], v[226:227] op_sel:[0,1,0] op_sel_hi:[1,1,1]
    v_max_f32 v164, 0, v164
    v_max_f32 v168, 0, v168
    v_max_f32 v165, 0, v165
    v_max_f32 v169, 0, v169
    v_max_f32 v166, 0, v166
    v_max_f32 v170, 0, v170
    v_max_f32 v167, 0, v167
    v_max_f32 v171, 0, v171
    v_pk_mul_f32 v[164:165], v[164:165], v[164:165]
    v_pk_mul_f32 v[168:169], v[168:169], v[168:169]
    v_pk_mul_f32 v[166:167], v[166:167], v[166:167]
    v_pk_mul_f32 v[170:171], v[170:171], v[170:171]
    v_cvt_pk_bf16_f32 v46, v164, v165
    v_cvt_pk_bf16_f32 v48, v168, v169
    v_cvt_pk_bf16_f32 v47, v166, v167
    v_cvt_pk_bf16_f32 v49, v170, v171
    buffer_store_dwordx4 v[46:49], v63, s[36:39], s90 offen sc1
    s_add_u32 s90, s11, 2048
    v_pk_fma_f32 v[172:173], v[200:201], v[8:9], v[172:173] op_sel:[0,0,0] op_sel_hi:[1,0,1]
    v_pk_fma_f32 v[174:175], v[202:203], v[8:9], v[174:175] op_sel:[0,0,0] op_sel_hi:[1,0,1]
    v_pk_fma_f32 v[172:173], v[172:173], v[8:9], v[228:229] op_sel:[0,1,0] op_sel_hi:[1,1,1]
    v_pk_fma_f32 v[174:175], v[174:175], v[8:9], v[230:231] op_sel:[0,1,0] op_sel_hi:[1,1,1]
    v_max_f32 v172, 0, v172
    v_max_f32 v173, 0, v173
    v_max_f32 v174, 0, v174
    v_max_f32 v175, 0, v175
    v_pk_mul_f32 v[172:173], v[172:173], v[172:173]
    v_pk_mul_f32 v[174:175], v[174:175], v[174:175]
    v_cvt_pk_bf16_f32 v56, v172, v173
    v_cvt_pk_bf16_f32 v57, v174, v175
    buffer_store_dwordx4 v[54:57], v63, s[36:39], s90 offen sc1
    v_mov_b32 v2, s66
    v_mov_b32 v3, s67
    s_add_u32 s91, s80, 229376
    s_add_u32 m0, s82, 65536
    v_accvgpr_read_b32 v42, a104
    buffer_load_dwordx4 v61, s[48:51], s91 offen offset:0 lds
    v_accvgpr_read_b32 v43, a105
    v_accvgpr_read_b32 v44, a106
    v_accvgpr_read_b32 v45, a107
    v_accvgpr_read_b32 v46, a108
    v_accvgpr_read_b32 v47, a109
    v_accvgpr_read_b32 v48, a110
    v_accvgpr_read_b32 v49, a111
    v_accvgpr_read_b32 v50, a96
    v_accvgpr_read_b32 v51, a97
    v_accvgpr_read_b32 v52, a98
    v_accvgpr_read_b32 v53, a99
    buffer_load_dwordx4 v62, s[48:51], s91 offen offset:1024 lds
    v_accvgpr_read_b32 v54, a100
    v_accvgpr_read_b32 v55, a101
    v_accvgpr_read_b32 v56, a102
    v_accvgpr_read_b32 v57, a103
    v_mov_b32_e64 v58, v239
    s_lshr_b32 s74, s64, 1
    s_lshl_b32 s74, s74, 13
    s_add_u32 s74, s74, 9568256
    v_lshlrev_b32_e64 v4, 7, v1
    v_add_u32 v4, s74, v4
    s_and_b32 s74, s64, 1
    s_lshl_b32 s74, s74, 1
    s_lshl_b32 s75, s60, 3
    buffer_load_dwordx4 v252, s[48:51], s91 offen offset:2048 lds
    s_add_u32 s74, s74, s75
    s_lshl_b32 s85, 0x33, s74
    s_mov_b32 s84, 0
    s_nop 0
    s_lshl_b32 s88, 0x55555555, s69
    s_mov_b32 s89, 0
    s_nop 0
    v_mov_b32 v5, 2146435072
    v_cndmask_b32 v59, v5, v4, s[84:85]
    v_cndmask_b32 v60, v5, v4, s[88:89]
    s_mul_i32 s10, s64, 294912
    s_mul_i32 s74, s60, 57344
    s_add_u32 s86, s10, s74
    s_lshl_b32 s74, s60, 10
    s_add_u32 s10, s10, s74
    s_nop 0
    buffer_load_dwordx4 v254, s[48:51], s91 offen offset:3072 lds
    s_add_u32 s10, s10, 229376
    v_subrev_u32_e64 v224, s82, v240
    v_add_u32 v228, 0x10000, v224
    v_add_u32 v232, 0x20000, v224
    v_subrev_u32_e64 v225, s82, v241
    v_add_u32 v229, 0x10000, v225
    v_add_u32 v233, 0x20000, v225
    v_subrev_u32_e64 v226, s82, v242
    v_add_u32 v230, 0x10000, v226
    v_add_u32 v234, 0x20000, v226
    v_subrev_u32_e64 v227, s82, v243
    v_add_u32 v231, 0x10000, v227
    v_add_u32 v235, 0x20000, v227
    s_waitcnt vmcnt(4)
    s_nop 0
    buffer_store_dwordx2 v[2:3], v238, s[36:39], 0 offen sc1
    s_add_u32 s91, s80, 262144
    s_add_u32 m0, s82, 81920
    s_nop 0
    s_nop 0
    buffer_load_dwordx4 v61, s[48:51], s91 offen offset:0 lds
    buffer_load_dwordx4 v62, s[48:51], s91 offen offset:1024 lds
    buffer_load_dwordx4 v252, s[48:51], s91 offen offset:2048 lds
    buffer_load_dwordx4 v254, s[48:51], s91 offen offset:3072 lds
    s_add_u32 s91, s80, 294912
    s_add_u32 m0, s82, 98304
    s_nop 0
    s_nop 0
    buffer_load_dwordx4 v61, s[48:51], s91 offen offset:0 lds
    buffer_load_dwordx4 v62, s[48:51], s91 offen offset:1024 lds
    buffer_load_dwordx4 v252, s[48:51], s91 offen offset:2048 lds
    buffer_load_dwordx4 v254, s[48:51], s91 offen offset:3072 lds
    s_add_u32 s91, s80, 327680
    s_add_u32 m0, s82, 114688
    s_nop 0
    s_nop 0
    buffer_load_dwordx4 v61, s[48:51], s91 offen offset:0 lds
    buffer_load_dwordx4 v62, s[48:51], s91 offen offset:1024 lds
    buffer_load_dwordx4 v252, s[48:51], s91 offen offset:2048 lds
    buffer_load_dwordx4 v254, s[48:51], s91 offen offset:3072 lds
    s_add_u32 s91, s80, 360448
    s_add_u32 m0, s82, 131072
    s_nop 0
    s_nop 0
    buffer_load_dwordx4 v61, s[48:51], s91 offen offset:0 lds
    buffer_load_dwordx4 v62, s[48:51], s91 offen offset:1024 lds
    buffer_load_dwordx4 v252, s[48:51], s91 offen offset:2048 lds
    buffer_load_dwordx4 v254, s[48:51], s91 offen offset:3072 lds
    s_waitcnt vmcnt(43)
    s_nop 0
    ds_read_b64_tr_b16 a[176:177], v240 offset:0
    ds_read_b64_tr_b16 a[178:179], v240 offset:2048
    ds_read_b64_tr_b16 a[180:181], v241 offset:0
    ds_read_b64_tr_b16 a[182:183], v241 offset:2048
    ds_read_b64_tr_b16 a[184:185], v242 offset:0
    ds_read_b64_tr_b16 a[186:187], v242 offset:2048
    ds_read_b64_tr_b16 a[188:189], v243 offset:0
    ds_read_b64_tr_b16 a[190:191], v243 offset:2048
    ds_read_b64_tr_b16 a[192:193], v240 offset:16384
    ds_read_b64_tr_b16 a[194:195], v240 offset:18432
    ds_read_b64_tr_b16 a[196:197], v241 offset:16384
    ds_read_b64_tr_b16 a[198:199], v241 offset:18432
    ds_read_b64_tr_b16 a[200:201], v242 offset:16384
    ds_read_b64_tr_b16 a[202:203], v242 offset:18432
    ds_read_b64_tr_b16 a[204:205], v243 offset:16384
    ds_read_b64_tr_b16 a[206:207], v243 offset:18432
    s_waitcnt lgkmcnt(0)
    s_nop 0
    s_add_u32 s91, s80, 393216
    s_add_u32 m0, s82, 0
    s_nop 0
    buffer_load_dwordx4 v61, s[48:51], s91 offen offset:0 lds
    buffer_load_dwordx4 v62, s[48:51], s91 offen offset:1024 lds
    buffer_load_dwordx4 v252, s[48:51], s91 offen offset:2048 lds
    buffer_load_dwordx4 v254, s[48:51], s91 offen offset:3072 lds
    s_add_u32 s91, s80, 425984
    s_add_u32 m0, s82, 16384
    s_nop 0
    s_nop 0
    buffer_load_dwordx4 v61, s[48:51], s91 offen offset:0 lds
    buffer_load_dwordx4 v62, s[48:51], s91 offen offset:1024 lds
    buffer_load_dwordx4 v252, s[48:51], s91 offen offset:2048 lds
    buffer_load_dwordx4 v254, s[48:51], s91 offen offset:3072 lds
    s_waitcnt vmcnt(25)
    s_nop 0
    ds_read_b64_tr_b16 a[208:209], v240 offset:32768
    ds_read_b64_tr_b16 a[210:211], v240 offset:34816
    ds_read_b64_tr_b16 a[212:213], v241 offset:32768
    ds_read_b64_tr_b16 a[214:215], v241 offset:34816
    ds_read_b64_tr_b16 a[216:217], v242 offset:32768
    ds_read_b64_tr_b16 a[218:219], v242 offset:34816
    ds_read_b64_tr_b16 a[220:221], v243 offset:32768
    ds_read_b64_tr_b16 a[222:223], v243 offset:34816
    ds_read_b64_tr_b16 a[224:225], v240 offset:49152
    ds_read_b64_tr_b16 a[226:227], v240 offset:51200
    ds_read_b64_tr_b16 a[228:229], v241 offset:49152
    ds_read_b64_tr_b16 a[230:231], v241 offset:51200
    ds_read_b64_tr_b16 a[232:233], v242 offset:49152
    ds_read_b64_tr_b16 a[234:235], v242 offset:51200
    ds_read_b64_tr_b16 a[236:237], v243 offset:49152
    ds_read_b64_tr_b16 a[238:239], v243 offset:51200
    ds_read_b64_tr_b16 a[240:241], v244 offset:0
    ds_read_b64_tr_b16 a[242:243], v244 offset:2048
    ds_read_b64_tr_b16 a[244:245], v245 offset:0
    ds_read_b64_tr_b16 a[246:247], v245 offset:2048
    ds_read_b64_tr_b16 a[248:249], v246 offset:0
    ds_read_b64_tr_b16 a[250:251], v246 offset:2048
    ds_read_b64_tr_b16 a[252:253], v247 offset:0
    ds_read_b64_tr_b16 a[254:255], v247 offset:2048
    s_waitcnt lgkmcnt(0)
    s_nop 0
    s_add_u32 s91, s81, 458752
    s_add_u32 m0, s82, 32768
    s_nop 0
    s_nop 0
    buffer_load_dwordx4 v61, s[52:55], s91 offen offset:0 lds
    buffer_load_dwordx4 v62, s[52:55], s91 offen offset:1024 lds
    buffer_load_dwordx4 v252, s[52:55], s91 offen offset:2048 lds
    buffer_load_dwordx4 v254, s[52:55], s91 offen offset:3072 lds
    s_add_u32 s91, s81, 491520
    s_add_u32 m0, s82, 49152
    s_nop 0
    s_nop 0
    buffer_load_dwordx4 v61, s[52:55], s91 offen offset:0 lds
    buffer_load_dwordx4 v62, s[52:55], s91 offen offset:1024 lds
    buffer_load_dwordx4 v252, s[52:55], s91 offen offset:2048 lds
    buffer_load_dwordx4 v254, s[52:55], s91 offen offset:3072 lds
    s_add_u32 s91, s81, 524288
    s_add_u32 m0, s82, 65536
    s_nop 0
    s_nop 0
    buffer_load_dwordx4 v61, s[52:55], s91 offen offset:0 lds
    buffer_load_dwordx4 v62, s[52:55], s91 offen offset:1024 lds
    s_branch L_P2
L_QLOOP:
    s_waitcnt vmcnt(18)
    s_barrier
    ds_read_b128 v[50:53], v22 offset:0
    ds_read_b64_tr_b16 a[32:33], v28 offset:0
    ds_read_b128 a[0:3], v22 offset:2048
    ds_read_b64_tr_b16 a[34:35], v28 offset:1536
    ds_read_b128 a[4:7], v22 offset:4096
    ds_read_b128 a[8:11], v22 offset:6144
    ds_read_b64_tr_b16 a[36:37], v28 offset:128
    ds_read_b128 a[12:15], v22 offset:8192
    ds_read_b64_tr_b16 a[38:39], v28 offset:1664
    ds_read_b128 a[16:19], v22 offset:10240
    ds_read_b128 a[20:23], v22 offset:12288
    ds_read_b64_tr_b16 a[40:41], v28 offset:256
    ds_read_b128 a[24:27], v22 offset:14336
    ds_read_b64_tr_b16 a[42:43], v28 offset:1792
    ds_read_b128 a[28:31], v22 offset:16384
    s_waitcnt lgkmcnt(0)
    v_mfma_f32_16x16x32_bf16 v[68:71], a[32:35], a[0:3], 0
    ds_read_b128 v[54:57], v23 offset:0
    v_mfma_f32_16x16x32_bf16 v[104:107], a[36:39], a[0:3], 0
    v_mfma_f32_16x16x32_bf16 v[140:143], a[0:3], a[40:43], 0
    ds_read_b64_tr_b16 a[80:81], v28 offset:12288
    s_add_u32 m0, s73, 90112
    v_mfma_f32_16x16x32_bf16 v[72:75], a[32:35], a[4:7], 0
    buffer_load_dwordx4 v15, s[32:35], s71 offen  lds
    ds_read_b128 a[48:51], v23 offset:2048
    v_mfma_f32_16x16x32_bf16 v[108:111], a[36:39], a[4:7], 0
    v_cndmask_b32 v50, v50, v46, s[88:89]
    s_add_u32 m0, s73, 91136
    v_mfma_f32_16x16x32_bf16 v[144:147], a[4:7], a[40:43], 0
    buffer_load_dwordx4 v16, s[32:35], s71 offen  lds
    ds_read_b64_tr_b16 a[82:83], v28 offset:13824
    v_mfma_f32_16x16x32_bf16 v[76:79], a[32:35], a[8:11], 0
    ds_read_b128 a[52:55], v23 offset:4096
    v_cndmask_b32 v51, v51, v46, s[88:89]
    v_mfma_f32_16x16x32_bf16 v[112:115], a[36:39], a[8:11], 0
    s_add_u32 m0, s73, 92160
    v_mfma_f32_16x16x32_bf16 v[148:151], a[8:11], a[40:43], 0
    buffer_load_dwordx4 v17, s[32:35], s71 offen  lds
    ds_read_b128 a[56:59], v23 offset:6144
    v_mfma_f32_16x16x32_bf16 v[80:83], a[32:35], a[12:15], 0
    ds_read_b64_tr_b16 a[84:85], v28 offset:12416
    v_cndmask_b32 v52, v52, v46, s[88:89]
    s_add_u32 m0, s73, 93184
    v_mfma_f32_16x16x32_bf16 v[116:119], a[36:39], a[12:15], 0
    buffer_load_dwordx4 v18, s[32:35], s71 offen  lds
    ds_read_b128 a[60:63], v23 offset:8192
    v_mfma_f32_16x16x32_bf16 v[152:155], a[12:15], a[40:43], 0
    s_add_u32 m0, s73, 94208
    v_mfma_f32_16x16x32_bf16 v[84:87], a[32:35], a[16:19], 0
    buffer_load_dwordx4 v19, s[32:35], s71 offen  lds
    v_cndmask_b32 v53, v53, v46, s[88:89]
    ds_read_b64_tr_b16 a[86:87], v28 offset:13952
    v_mfma_f32_16x16x32_bf16 v[120:123], a[36:39], a[16:19], 0
    ds_read_b128 a[64:67], v23 offset:10240
    v_mfma_f32_16x16x32_bf16 v[156:159], a[16:19], a[40:43], 0
    s_add_u32 m0, s73, 95232
    v_mfma_f32_16x16x32_bf16 v[88:91], a[32:35], a[20:23], 0
    buffer_load_dwordx4 v20, s[32:35], s71 offen  lds
    ds_read_b128 a[68:71], v23 offset:12288
    v_mfma_f32_16x16x32_bf16 v[124:127], a[36:39], a[20:23], 0
    s_mul_i32 s90, s2, 3
    s_lshr_b32 s90, s90, 8
    s_cmp_eq_u32 s90, 0
    s_cselect_b32 s90, 0, 2146435072
    buffer_load_dword v253, v43, s[12:15], s90 offen
    ds_read_b64_tr_b16 a[88:89], v28 offset:12544
    v_mfma_f32_16x16x32_bf16 v[160:163], a[20:23], a[40:43], 0
    v_mfma_f32_16x16x32_bf16 v[92:95], a[32:35], a[24:27], 0
    ds_read_b128 a[72:75], v23 offset:14336
    s_lshl_b32 s90, s60, 12
    s_add_u32 m0, s90, 135168
    s_movk_i32 s90, 0
    v_mfma_f32_16x16x32_bf16 v[128:131], a[36:39], a[24:27], 0
    buffer_load_dwordx4 v226, s[44:47], s90 offen lds
    ds_read_b64_tr_b16 a[90:91], v28 offset:14080
    v_mfma_f32_16x16x32_bf16 v[164:167], a[24:27], a[40:43], 0
    ds_read_b128 a[76:79], v23 offset:16384
    v_mfma_f32_16x16x32_bf16 v[96:99], a[32:35], a[28:31], 0
    s_lshl_b32 s90, s60, 12
    s_add_u32 m0, s90, 136192
    s_movk_i32 s90, 7168
    v_mfma_f32_16x16x32_bf16 v[132:135], a[36:39], a[28:31], 0
    buffer_load_dwordx4 v226, s[44:47], s90 offen lds
    v_mfma_f32_16x16x32_bf16 v[168:171], a[28:31], a[40:43], 0
    s_lshl_b32 s90, s60, 12
    s_add_u32 m0, s90, 137216
    s_movk_i32 s90, 14336
    v_mfma_f32_16x16x32_bf16 v[64:67], a[32:35], v[50:53], 0
    buffer_load_dwordx4 v226, s[44:47], s90 offen lds
    v_mfma_f32_16x16x32_bf16 v[100:103], a[36:39], v[50:53], 0
    s_lshl_b32 s90, s60, 12
    s_add_u32 m0, s90, 138240
    s_movk_i32 s90, 21504
    v_mfma_f32_16x16x32_bf16 v[136:139], v[50:53], a[40:43], 0
    buffer_load_dwordx4 v226, s[44:47], s90 offen lds
    s_waitcnt vmcnt(11) lgkmcnt(0)
NON_3:
    v_readfirstlane_b32 s66, v44
    v_readfirstlane_b32 s67, v45
    s_nop 3
    s_cmp_lg_u32 s66, 0
    s_cbranch_scc1 NON_3_ok
    s_mov_b32 s48, s22
    s_mov_b32 s49, s23
    s_mov_b32 s50, 256
    s_mov_b32 s51, 0x00020000
    v_mov_b32 v8, 0
    buffer_load_dwordx2 v[44:45], v8, s[48:51], 0 offen sc1
    s_waitcnt vmcnt(0)
    s_mov_b32 s48, s16
    s_mov_b32 s49, s17
    s_mov_b32 s50, 1835008
    s_mov_b32 s51, 0x00020000
    s_branch NON_3
NON_3_ok:
    s_barrier
    v_mfma_f32_16x16x32_bf16 v[68:71], a[80:83], a[48:51], v[68:71]
    v_mov_b32 v8, s66
    v_mov_b32 v9, s67
    buffer_store_dwordx2 v[8:9], v39, s[36:39], 0 offen sc1
    ds_read_b128 v[50:53], v24 offset:0
    v_mfma_f32_16x16x32_bf16 v[104:107], a[84:87], a[48:51], v[104:107]
    v_mfma_f32_16x16x32_bf16 v[140:143], a[48:51], a[88:91], v[140:143]
    ds_read_b64_tr_b16 a[32:33], v31 offset:0
    v_mfma_f32_16x16x32_bf16 v[72:75], a[80:83], a[52:55], v[72:75]
    s_mov_b32 s70, 384
    s_mov_b32 s71, 589824
    s_add_u32 m0, s72, 0
    v_mfma_f32_16x16x32_bf16 v[108:111], a[84:87], a[52:55], v[108:111]
    buffer_load_dwordx4 v10, s[28:31], s70 offen lds
    ds_read_b128 a[0:3], v24 offset:2048
    v_cndmask_b32 v54, v54, v46, s[88:89]
    v_mfma_f32_16x16x32_bf16 v[144:147], a[52:55], a[88:91], v[144:147]
    ds_read_b64_tr_b16 a[34:35], v31 offset:1536
    v_mfma_f32_16x16x32_bf16 v[76:79], a[80:83], a[56:59], v[76:79]
    ds_read_b128 a[4:7], v24 offset:4096
    v_cndmask_b32 v55, v55, v46, s[88:89]
    v_mfma_f32_16x16x32_bf16 v[112:115], a[84:87], a[56:59], v[112:115]
    s_add_u32 m0, s72, 4096
    v_mfma_f32_16x16x32_bf16 v[148:151], a[56:59], a[88:91], v[148:151]
    buffer_load_dwordx4 v11, s[28:31], s70 offen lds
    ds_read_b128 a[8:11], v24 offset:6144
    v_mfma_f32_16x16x32_bf16 v[80:83], a[80:83], a[60:63], v[80:83]
    ds_read_b64_tr_b16 a[36:37], v31 offset:128
    v_cndmask_b32 v56, v56, v46, s[88:89]
    v_mfma_f32_16x16x32_bf16 v[116:119], a[84:87], a[60:63], v[116:119]
    ds_read_b128 a[12:15], v24 offset:8192
    v_mfma_f32_16x16x32_bf16 v[152:155], a[60:63], a[88:91], v[152:155]
    v_mfma_f32_16x16x32_bf16 v[84:87], a[80:83], a[64:67], v[84:87]
    s_add_u32 m0, s72, 8192
    v_mfma_f32_16x16x32_bf16 v[120:123], a[84:87], a[64:67], v[120:123]
    buffer_load_dwordx4 v12, s[28:31], s70 offen lds
    v_cndmask_b32 v57, v57, v46, s[88:89]
    ds_read_b64_tr_b16 a[38:39], v31 offset:1664
    ds_read_b128 a[16:19], v24 offset:10240
    v_mfma_f32_16x16x32_bf16 v[156:159], a[64:67], a[88:91], v[156:159]
    v_mfma_f32_16x16x32_bf16 v[88:91], a[80:83], a[68:71], v[88:91]
    ds_read_b128 a[20:23], v24 offset:12288
    v_mfma_f32_16x16x32_bf16 v[124:127], a[84:87], a[68:71], v[124:127]
    s_add_u32 m0, s72, 12288
    v_mfma_f32_16x16x32_bf16 v[160:163], a[68:71], a[88:91], v[160:163]
    buffer_load_dwordx4 v13, s[28:31], s70 offen lds
    ds_read_b64_tr_b16 a[40:41], v31 offset:256
    v_mfma_f32_16x16x32_bf16 v[92:95], a[80:83], a[72:75], v[92:95]
    ds_read_b128 a[24:27], v24 offset:14336
    v_mfma_f32_16x16x32_bf16 v[128:131], a[84:87], a[72:75], v[128:131]
    ds_read_b64_tr_b16 a[42:43], v31 offset:1792
    v_mfma_f32_16x16x32_bf16 v[164:167], a[72:75], a[88:91], v[164:167]
    s_mul_i32 m0, s26, 0
    s_add_u32 m0, m0, s27
    v_mfma_f32_16x16x32_bf16 v[96:99], a[80:83], a[76:79], v[96:99]
    buffer_load_dwordx4 v14, s[28:31], s70 offen lds
    ds_read_b128 a[28:31], v24 offset:16384
    v_mfma_f32_16x16x32_bf16 v[132:135], a[84:87], a[76:79], v[132:135]
    v_mfma_f32_16x16x32_bf16 v[168:171], a[76:79], a[88:91], v[168:171]
    v_mfma_f32_16x16x32_bf16 v[64:67], a[80:83], v[54:57], v[64:67]
    s_add_u32 m0, s73, 0
    v_mfma_f32_16x16x32_bf16 v[100:103], a[84:87], v[54:57], v[100:103]
    buffer_load_dwordx4 v15, s[32:35], s71 offen  lds
    v_mfma_f32_16x16x32_bf16 v[136:139], v[54:57], a[88:91], v[136:139]
    s_waitcnt lgkmcnt(0)
    v_mfma_f32_16x16x32_bf16 v[68:71], a[32:35], a[0:3], v[68:71]
    ds_read_b128 v[54:57], v25 offset:0
    v_mfma_f32_16x16x32_bf16 v[104:107], a[36:39], a[0:3], v[104:107]
    v_mfma_f32_16x16x32_bf16 v[140:143], a[0:3], a[40:43], v[140:143]
    ds_read_b64_tr_b16 a[80:81], v31 offset:12288
    v_mfma_f32_16x16x32_bf16 v[72:75], a[32:35], a[4:7], v[72:75]
    s_add_u32 m0, s73, 1024
    v_mfma_f32_16x16x32_bf16 v[108:111], a[36:39], a[4:7], v[108:111]
    buffer_load_dwordx4 v16, s[32:35], s71 offen  lds
    ds_read_b128 a[48:51], v25 offset:2048
    v_cndmask_b32 v50, v50, v46, s[88:89]
    v_mfma_f32_16x16x32_bf16 v[144:147], a[4:7], a[40:43], v[144:147]
    ds_read_b64_tr_b16 a[82:83], v31 offset:13824
    v_mfma_f32_16x16x32_bf16 v[76:79], a[32:35], a[8:11], v[76:79]
    ds_read_b128 a[52:55], v25 offset:4096
    v_cndmask_b32 v51, v51, v46, s[88:89]
    v_mfma_f32_16x16x32_bf16 v[112:115], a[36:39], a[8:11], v[112:115]
    s_add_u32 m0, s73, 2048
    v_mfma_f32_16x16x32_bf16 v[148:151], a[8:11], a[40:43], v[148:151]
    buffer_load_dwordx4 v17, s[32:35], s71 offen  lds
    ds_read_b128 a[56:59], v25 offset:6144
    v_mfma_f32_16x16x32_bf16 v[80:83], a[32:35], a[12:15], v[80:83]
    ds_read_b64_tr_b16 a[84:85], v31 offset:12416
    v_cndmask_b32 v52, v52, v46, s[88:89]
    v_mfma_f32_16x16x32_bf16 v[116:119], a[36:39], a[12:15], v[116:119]
    ds_read_b128 a[60:63], v25 offset:8192
    v_mfma_f32_16x16x32_bf16 v[152:155], a[12:15], a[40:43], v[152:155]
    v_mfma_f32_16x16x32_bf16 v[84:87], a[32:35], a[16:19], v[84:87]
    s_add_u32 m0, s73, 3072
    v_mfma_f32_16x16x32_bf16 v[120:123], a[36:39], a[16:19], v[120:123]
    buffer_load_dwordx4 v18, s[32:35], s71 offen  lds
    v_cndmask_b32 v53, v53, v46, s[88:89]
    ds_read_b64_tr_b16 a[86:87], v31 offset:13952
    ds_read_b128 a[64:67], v25 offset:10240
    v_mfma_f32_16x16x32_bf16 v[156:159], a[16:19], a[40:43], v[156:159]
    v_mfma_f32_16x16x32_bf16 v[88:91], a[32:35], a[20:23], v[88:91]
    ds_read_b128 a[68:71], v25 offset:12288
    v_mfma_f32_16x16x32_bf16 v[124:127], a[36:39], a[20:23], v[124:127]
    s_add_u32 m0, s73, 4096
    v_mfma_f32_16x16x32_bf16 v[160:163], a[20:23], a[40:43], v[160:163]
    buffer_load_dwordx4 v19, s[32:35], s71 offen  lds
    ds_read_b64_tr_b16 a[88:89], v31 offset:12544
    v_mfma_f32_16x16x32_bf16 v[92:95], a[32:35], a[24:27], v[92:95]
    ds_read_b128 a[72:75], v25 offset:14336
    v_mfma_f32_16x16x32_bf16 v[128:131], a[36:39], a[24:27], v[128:131]
    ds_read_b64_tr_b16 a[90:91], v31 offset:14080
    v_mfma_f32_16x16x32_bf16 v[164:167], a[24:27], a[40:43], v[164:167]
    s_add_u32 m0, s73, 5120
    v_mfma_f32_16x16x32_bf16 v[96:99], a[32:35], a[28:31], v[96:99]
    buffer_load_dwordx4 v20, s[32:35], s71 offen  lds
    ds_read_b128 a[76:79], v25 offset:16384
    v_mfma_f32_16x16x32_bf16 v[132:135], a[36:39], a[28:31], v[132:135]
    v_mfma_f32_16x16x32_bf16 v[168:171], a[28:31], a[40:43], v[168:171]
    v_mfma_f32_16x16x32_bf16 v[64:67], a[32:35], v[50:53], v[64:67]
    s_mul_i32 s90, s2, 3
    s_lshr_b32 s90, s90, 8
    s_cmp_eq_u32 s90, 1
    s_cselect_b32 s90, 0, 2146435072
    buffer_load_dword v253, v43, s[12:15], s90 offen
    v_mfma_f32_16x16x32_bf16 v[100:103], a[36:39], v[50:53], v[100:103]
    v_mfma_f32_16x16x32_bf16 v[136:139], v[50:53], a[40:43], v[136:139]
    s_waitcnt vmcnt(13) lgkmcnt(0)
    s_barrier
    v_mfma_f32_16x16x32_bf16 v[68:71], a[80:83], a[48:51], v[68:71]
    ds_read_b64_tr_b16 a[128:129], v227 offset:0
    ds_read_b128 v[50:53], v26 offset:0
    v_mfma_f32_16x16x32_bf16 v[104:107], a[84:87], a[48:51], v[104:107]
    ds_read_b64_tr_b16 a[130:131], v227 offset:2048
    v_mfma_f32_16x16x32_bf16 v[140:143], a[48:51], a[88:91], v[140:143]
    ds_read_b64_tr_b16 a[132:133], v227 offset:128
    ds_read_b64_tr_b16 a[32:33], v34 offset:0
    ds_read_b64_tr_b16 a[134:135], v227 offset:2176
    v_mfma_f32_16x16x32_bf16 v[72:75], a[80:83], a[52:55], v[72:75]
    s_mov_b32 s70, 512
    s_mov_b32 s71, 786432
    s_add_u32 m0, s72, 45056
    v_mfma_f32_16x16x32_bf16 v[108:111], a[84:87], a[52:55], v[108:111]
    buffer_load_dwordx4 v10, s[28:31], s70 offen lds
    ds_read_b128 a[0:3], v26 offset:2048
    ds_read_b64_tr_b16 a[136:137], v227 offset:256
    v_cndmask_b32 v54, v54, v46, s[88:89]
    ds_read_b64_tr_b16 a[138:139], v227 offset:2304
    v_mfma_f32_16x16x32_bf16 v[144:147], a[52:55], a[88:91], v[144:147]
    ds_read_b64_tr_b16 a[34:35], v34 offset:1536
    ds_read_b64_tr_b16 a[140:141], v227 offset:384
    v_mfma_f32_16x16x32_bf16 v[76:79], a[80:83], a[56:59], v[76:79]
    ds_read_b64_tr_b16 a[142:143], v227 offset:2432
    ds_read_b128 a[4:7], v26 offset:4096
    v_cndmask_b32 v55, v55, v46, s[88:89]
    v_mfma_f32_16x16x32_bf16 v[112:115], a[84:87], a[56:59], v[112:115]
    s_add_u32 m0, s72, 49152
    v_mfma_f32_16x16x32_bf16 v[148:151], a[56:59], a[88:91], v[148:151]
    buffer_load_dwordx4 v11, s[28:31], s70 offen lds
    ds_read_b128 a[8:11], v26 offset:6144
    v_mfma_f32_16x16x32_bf16 v[80:83], a[80:83], a[60:63], v[80:83]
    ds_read_b64_tr_b16 a[36:37], v34 offset:128
    v_cndmask_b32 v56, v56, v46, s[88:89]
    v_mfma_f32_16x16x32_bf16 v[116:119], a[84:87], a[60:63], v[116:119]
    ds_read_b128 a[12:15], v26 offset:8192
    v_mfma_f32_16x16x32_bf16 v[152:155], a[60:63], a[88:91], v[152:155]
    s_waitcnt lgkmcnt(0)
    v_mfma_f32_16x16x32_bf16 v[84:87], a[80:83], a[64:67], v[84:87]
    v_mfma_f32_16x16x32_bf16 a[144:147], a[128:131], v[46:49], 0
    s_add_u32 m0, s72, 53248
    v_mfma_f32_16x16x32_bf16 v[120:123], a[84:87], a[64:67], v[120:123]
    buffer_load_dwordx4 v12, s[28:31], s70 offen lds
    v_cndmask_b32 v57, v57, v46, s[88:89]
    ds_read_b64_tr_b16 a[38:39], v34 offset:1664
    v_mfma_f32_16x16x32_bf16 a[148:151], a[132:135], v[46:49], 0
    v_mfma_f32_16x16x32_bf16 a[152:155], a[136:139], v[46:49], 0
    ds_read_b128 a[16:19], v26 offset:10240
    v_mfma_f32_16x16x32_bf16 v[156:159], a[64:67], a[88:91], v[156:159]
    v_mfma_f32_16x16x32_bf16 a[156:159], a[140:143], v[46:49], 0
    v_mfma_f32_16x16x32_bf16 v[88:91], a[80:83], a[68:71], v[88:91]
    ds_read_b128 a[20:23], v26 offset:12288
    v_mfma_f32_16x16x32_bf16 v[124:127], a[84:87], a[68:71], v[124:127]
    s_add_u32 m0, s72, 57344
    v_mfma_f32_16x16x32_bf16 v[160:163], a[68:71], a[88:91], v[160:163]
    buffer_load_dwordx4 v13, s[28:31], s70 offen lds
    ds_read_b64_tr_b16 a[40:41], v34 offset:256
    v_mfma_f32_16x16x32_bf16 v[92:95], a[80:83], a[72:75], v[92:95]
    ds_read_b128 a[24:27], v26 offset:14336
    v_mfma_f32_16x16x32_bf16 v[128:131], a[84:87], a[72:75], v[128:131]
    ds_read_b64_tr_b16 a[42:43], v34 offset:1792
    v_mfma_f32_16x16x32_bf16 v[164:167], a[72:75], a[88:91], v[164:167]
    s_mul_i32 m0, s26, 45056
    s_add_u32 m0, m0, s27
    v_mfma_f32_16x16x32_bf16 v[96:99], a[80:83], a[76:79], v[96:99]
    buffer_load_dwordx4 v14, s[28:31], s70 offen lds
    ds_read_b128 a[28:31], v26 offset:16384
    v_mfma_f32_16x16x32_bf16 v[132:135], a[84:87], a[76:79], v[132:135]
    v_mfma_f32_16x16x32_bf16 v[168:171], a[76:79], a[88:91], v[168:171]
    buffer_store_dwordx4 a[144:147], v230, s[36:39], 0 offen offset:0 sc1
    v_mfma_f32_16x16x32_bf16 v[64:67], a[80:83], v[54:57], v[64:67]
    buffer_store_dwordx4 a[148:151], v230, s[36:39], 0 offen offset:256 sc1
    s_add_u32 m0, s73, 45056
    v_mfma_f32_16x16x32_bf16 v[100:103], a[84:87], v[54:57], v[100:103]
    buffer_load_dwordx4 v15, s[32:35], s71 offen  lds
    buffer_store_dwordx4 a[152:155], v230, s[36:39], 0 offen offset:512 sc1
    v_mfma_f32_16x16x32_bf16 v[136:139], v[54:57], a[88:91], v[136:139]
    buffer_store_dwordx4 a[156:159], v230, s[36:39], 0 offen offset:768 sc1
    s_waitcnt lgkmcnt(0)
    v_mfma_f32_16x16x32_bf16 v[68:71], a[32:35], a[0:3], v[68:71]
    ds_read_b128 v[54:57], v27 offset:0
    v_mfma_f32_16x16x32_bf16 v[104:107], a[36:39], a[0:3], v[104:107]
    v_mfma_f32_16x16x32_bf16 v[140:143], a[0:3], a[40:43], v[140:143]
    ds_read_b64_tr_b16 a[80:81], v34 offset:12288
    s_add_u32 m0, s73, 46080
    v_mfma_f32_16x16x32_bf16 v[72:75], a[32:35], a[4:7], v[72:75]
    buffer_load_dwordx4 v16, s[32:35], s71 offen  lds
    ds_read_b128 a[48:51], v27 offset:2048
    v_mfma_f32_16x16x32_bf16 v[108:111], a[36:39], a[4:7], v[108:111]
    v_cndmask_b32 v50, v50, v46, s[88:89]
    v_mfma_f32_16x16x32_bf16 v[144:147], a[4:7], a[40:43], v[144:147]
    ds_read_b64_tr_b16 a[82:83], v34 offset:13824
    s_add_u32 m0, s73, 47104
    v_mfma_f32_16x16x32_bf16 v[76:79], a[32:35], a[8:11], v[76:79]
    buffer_load_dwordx4 v17, s[32:35], s71 offen  lds
    ds_read_b128 a[52:55], v27 offset:4096
    v_cndmask_b32 v51, v51, v46, s[88:89]
    v_mfma_f32_16x16x32_bf16 v[112:115], a[36:39], a[8:11], v[112:115]
    s_add_u32 m0, s73, 48128
    v_mfma_f32_16x16x32_bf16 v[148:151], a[8:11], a[40:43], v[148:151]
    buffer_load_dwordx4 v18, s[32:35], s71 offen  lds
    ds_read_b128 a[56:59], v27 offset:6144
    v_mfma_f32_16x16x32_bf16 v[80:83], a[32:35], a[12:15], v[80:83]
    ds_read_b64_tr_b16 a[84:85], v34 offset:12416
    v_cndmask_b32 v52, v52, v46, s[88:89]
    v_mfma_f32_16x16x32_bf16 v[116:119], a[36:39], a[12:15], v[116:119]
    s_add_u32 m0, s73, 49152
    v_mfma_f32_16x16x32_bf16 v[152:155], a[12:15], a[40:43], v[152:155]
    buffer_load_dwordx4 v19, s[32:35], s71 offen  lds
    ds_read_b128 a[60:63], v27 offset:8192
    v_mfma_f32_16x16x32_bf16 v[84:87], a[32:35], a[16:19], v[84:87]
    v_cndmask_b32 v53, v53, v46, s[88:89]
    ds_read_b64_tr_b16 a[86:87], v34 offset:13952
    s_add_u32 m0, s73, 50176
    v_mfma_f32_16x16x32_bf16 v[120:123], a[36:39], a[16:19], v[120:123]
    buffer_load_dwordx4 v20, s[32:35], s71 offen  lds
    ds_read_b128 a[64:67], v27 offset:10240
    v_mfma_f32_16x16x32_bf16 v[156:159], a[16:19], a[40:43], v[156:159]
    v_mfma_f32_16x16x32_bf16 v[88:91], a[32:35], a[20:23], v[88:91]
    ds_read_b128 a[68:71], v27 offset:12288
    s_mul_i32 s90, s2, 3
    s_lshr_b32 s90, s90, 8
    s_cmp_eq_u32 s90, 2
    s_cselect_b32 s90, 0, 2146435072
    buffer_load_dword v253, v43, s[12:15], s90 offen
    v_mfma_f32_16x16x32_bf16 v[124:127], a[36:39], a[20:23], v[124:127]
    ds_read_b64_tr_b16 a[88:89], v34 offset:12544
    v_mfma_f32_16x16x32_bf16 v[160:163], a[20:23], a[40:43], v[160:163]
    v_mfma_f32_16x16x32_bf16 v[92:95], a[32:35], a[24:27], v[92:95]
    ds_read_b128 a[72:75], v27 offset:14336
    buffer_load_dwordx2 a[104:105], v37, s[96:99], 0 offen offset:0
    v_mfma_f32_16x16x32_bf16 v[128:131], a[36:39], a[24:27], v[128:131]
    ds_read_b64_tr_b16 a[90:91], v34 offset:14080
    v_mfma_f32_16x16x32_bf16 v[164:167], a[24:27], a[40:43], v[164:167]
    buffer_load_dwordx2 a[106:107], v37, s[96:99], 0 offen offset:32
    ds_read_b128 a[76:79], v27 offset:16384
    v_mfma_f32_16x16x32_bf16 v[96:99], a[32:35], a[28:31], v[96:99]
    v_mfma_f32_16x16x32_bf16 v[132:135], a[36:39], a[28:31], v[132:135]
    v_mfma_f32_16x16x32_bf16 v[168:171], a[28:31], a[40:43], v[168:171]
    buffer_load_dwordx2 a[108:109], v37, s[96:99], 0 offen offset:64
    v_mfma_f32_16x16x32_bf16 v[64:67], a[32:35], v[50:53], v[64:67]
    v_mfma_f32_16x16x32_bf16 v[100:103], a[36:39], v[50:53], v[100:103]
    buffer_load_dwordx2 a[110:111], v37, s[96:99], 0 offen offset:96
    v_mfma_f32_16x16x32_bf16 v[136:139], v[50:53], a[40:43], v[136:139]
    s_waitcnt vmcnt(10) lgkmcnt(0)
    s_barrier
    v_mfma_f32_16x16x32_bf16 v[68:71], a[80:83], a[48:51], v[68:71]
    buffer_store_dwordx2 v[8:9], v39, s[36:39], 0 offen offset:8 sc1
    ds_read_b128 v[50:53], v22 offset:0
    v_mfma_f32_16x16x32_bf16 v[104:107], a[84:87], a[48:51], v[104:107]
    v_mfma_f32_16x16x32_bf16 v[140:143], a[48:51], a[88:91], v[140:143]
    ds_read_b64_tr_b16 a[32:33], v28 offset:0
    v_mfma_f32_16x16x32_bf16 v[72:75], a[80:83], a[52:55], v[72:75]
    s_mov_b32 s70, 640
    s_mov_b32 s71, 983040
    s_add_u32 m0, s72, 90112
    v_mfma_f32_16x16x32_bf16 v[108:111], a[84:87], a[52:55], v[108:111]
    buffer_load_dwordx4 v10, s[28:31], s70 offen lds
    ds_read_b128 a[0:3], v22 offset:2048
    v_cndmask_b32 v54, v54, v46, s[88:89]
    v_mfma_f32_16x16x32_bf16 v[144:147], a[52:55], a[88:91], v[144:147]
    ds_read_b64_tr_b16 a[34:35], v28 offset:1536
    v_mfma_f32_16x16x32_bf16 v[76:79], a[80:83], a[56:59], v[76:79]
    ds_read_b128 a[4:7], v22 offset:4096
    v_cndmask_b32 v55, v55, v46, s[88:89]
    v_mfma_f32_16x16x32_bf16 v[112:115], a[84:87], a[56:59], v[112:115]
    s_add_u32 m0, s72, 94208
    v_mfma_f32_16x16x32_bf16 v[148:151], a[56:59], a[88:91], v[148:151]
    buffer_load_dwordx4 v11, s[28:31], s70 offen lds
    ds_read_b128 a[8:11], v22 offset:6144
    v_mfma_f32_16x16x32_bf16 v[80:83], a[80:83], a[60:63], v[80:83]
    ds_read_b64_tr_b16 a[36:37], v28 offset:128
    v_cndmask_b32 v56, v56, v46, s[88:89]
    v_mfma_f32_16x16x32_bf16 v[116:119], a[84:87], a[60:63], v[116:119]
    ds_read_b128 a[12:15], v22 offset:8192
    v_mfma_f32_16x16x32_bf16 v[152:155], a[60:63], a[88:91], v[152:155]
    v_mfma_f32_16x16x32_bf16 v[84:87], a[80:83], a[64:67], v[84:87]
    s_add_u32 m0, s72, 98304
    v_mfma_f32_16x16x32_bf16 v[120:123], a[84:87], a[64:67], v[120:123]
    buffer_load_dwordx4 v12, s[28:31], s70 offen lds
    v_cndmask_b32 v57, v57, v46, s[88:89]
    ds_read_b64_tr_b16 a[38:39], v28 offset:1664
    ds_read_b128 a[16:19], v22 offset:10240
    v_mfma_f32_16x16x32_bf16 v[156:159], a[64:67], a[88:91], v[156:159]
    v_mfma_f32_16x16x32_bf16 v[88:91], a[80:83], a[68:71], v[88:91]
    ds_read_b128 a[20:23], v22 offset:12288
    v_mfma_f32_16x16x32_bf16 v[124:127], a[84:87], a[68:71], v[124:127]
    s_add_u32 m0, s72, 102400
    v_mfma_f32_16x16x32_bf16 v[160:163], a[68:71], a[88:91], v[160:163]
    buffer_load_dwordx4 v13, s[28:31], s70 offen lds
    ds_read_b64_tr_b16 a[40:41], v28 offset:256
    v_mfma_f32_16x16x32_bf16 v[92:95], a[80:83], a[72:75], v[92:95]
    ds_read_b128 a[24:27], v22 offset:14336
    v_mfma_f32_16x16x32_bf16 v[128:131], a[84:87], a[72:75], v[128:131]
    ds_read_b64_tr_b16 a[42:43], v28 offset:1792
    v_mfma_f32_16x16x32_bf16 v[164:167], a[72:75], a[88:91], v[164:167]
    s_mul_i32 m0, s26, 90112
    s_add_u32 m0, m0, s27
    v_mfma_f32_16x16x32_bf16 v[96:99], a[80:83], a[76:79], v[96:99]
    buffer_load_dwordx4 v14, s[28:31], s70 offen lds
    ds_read_b128 a[28:31], v22 offset:16384
    v_mfma_f32_16x16x32_bf16 v[132:135], a[84:87], a[76:79], v[132:135]
    v_mfma_f32_16x16x32_bf16 v[168:171], a[76:79], a[88:91], v[168:171]
    v_mfma_f32_16x16x32_bf16 v[64:67], a[80:83], v[54:57], v[64:67]
    s_add_u32 m0, s73, 90112
    v_mfma_f32_16x16x32_bf16 v[100:103], a[84:87], v[54:57], v[100:103]
    buffer_load_dwordx4 v15, s[32:35], s71 offen  lds
    v_mfma_f32_16x16x32_bf16 v[136:139], v[54:57], a[88:91], v[136:139]
    s_waitcnt lgkmcnt(0)
    v_mfma_f32_16x16x32_bf16 v[68:71], a[32:35], a[0:3], v[68:71]
    ds_read_b128 v[54:57], v23 offset:0
    v_mfma_f32_16x16x32_bf16 v[104:107], a[36:39], a[0:3], v[104:107]
    v_mfma_f32_16x16x32_bf16 v[140:143], a[0:3], a[40:43], v[140:143]
    ds_read_b64_tr_b16 a[80:81], v28 offset:12288
    v_mfma_f32_16x16x32_bf16 v[72:75], a[32:35], a[4:7], v[72:75]
    s_add_u32 m0, s73, 91136
    v_mfma_f32_16x16x32_bf16 v[108:111], a[36:39], a[4:7], v[108:111]
    buffer_load_dwordx4 v16, s[32:35], s71 offen  lds
    ds_read_b128 a[48:51], v23 offset:2048
    v_cndmask_b32 v50, v50, v46, s[88:89]
    v_mfma_f32_16x16x32_bf16 v[144:147], a[4:7], a[40:43], v[144:147]
    ds_read_b64_tr_b16 a[82:83], v28 offset:13824
    v_mfma_f32_16x16x32_bf16 v[76:79], a[32:35], a[8:11], v[76:79]
    ds_read_b128 a[52:55], v23 offset:4096
    v_cndmask_b32 v51, v51, v46, s[88:89]
    s_add_u32 m0, s73, 92160
    v_mfma_f32_16x16x32_bf16 v[112:115], a[36:39], a[8:11], v[112:115]
    buffer_load_dwordx4 v17, s[32:35], s71 offen  lds
    ds_read_b128 a[56:59], v23 offset:6144
    v_mfma_f32_16x16x32_bf16 v[148:151], a[8:11], a[40:43], v[148:151]
    v_mfma_f32_16x16x32_bf16 v[80:83], a[32:35], a[12:15], v[80:83]
    ds_read_b64_tr_b16 a[84:85], v28 offset:12416
    v_cndmask_b32 v52, v52, v46, s[88:89]
    v_mfma_f32_16x16x32_bf16 v[116:119], a[36:39], a[12:15], v[116:119]
    s_add_u32 m0, s73, 93184
    v_mfma_f32_16x16x32_bf16 v[152:155], a[12:15], a[40:43], v[152:155]
    buffer_load_dwordx4 v18, s[32:35], s71 offen  lds
    ds_read_b128 a[60:63], v23 offset:8192
    v_mfma_f32_16x16x32_bf16 v[84:87], a[32:35], a[16:19], v[84:87]
    v_cndmask_b32 v53, v53, v46, s[88:89]
    ds_read_b64_tr_b16 a[86:87], v28 offset:13952
    v_mfma_f32_16x16x32_bf16 v[120:123], a[36:39], a[16:19], v[120:123]
    ds_read_b128 a[64:67], v23 offset:10240
    v_mfma_f32_16x16x32_bf16 v[156:159], a[16:19], a[40:43], v[156:159]
    s_add_u32 m0, s73, 94208
    v_mfma_f32_16x16x32_bf16 v[88:91], a[32:35], a[20:23], v[88:91]
    buffer_load_dwordx4 v19, s[32:35], s71 offen  lds
    ds_read_b128 a[68:71], v23 offset:12288
    v_mfma_f32_16x16x32_bf16 v[124:127], a[36:39], a[20:23], v[124:127]
    ds_read_b64_tr_b16 a[88:89], v28 offset:12544
    v_mfma_f32_16x16x32_bf16 v[160:163], a[20:23], a[40:43], v[160:163]
    s_add_u32 m0, s73, 95232
    v_mfma_f32_16x16x32_bf16 v[92:95], a[32:35], a[24:27], v[92:95]
    buffer_load_dwordx4 v20, s[32:35], s71 offen  lds
    ds_read_b128 a[72:75], v23 offset:14336
    v_mfma_f32_16x16x32_bf16 v[128:131], a[36:39], a[24:27], v[128:131]
    ds_read_b64_tr_b16 a[90:91], v28 offset:14080
    v_mfma_f32_16x16x32_bf16 v[164:167], a[24:27], a[40:43], v[164:167]
    ds_read_b128 a[76:79], v23 offset:16384
    v_mfma_f32_16x16x32_bf16 v[96:99], a[32:35], a[28:31], v[96:99]
    s_lshl_b32 s90, s60, 11
    s_add_u32 m0, s90, 135168
    s_movk_i32 s90, 0
    v_mfma_f32_16x16x32_bf16 v[132:135], a[36:39], a[28:31], v[132:135]
    buffer_load_dwordx4 v228, s[28:31], s90 offen lds
    v_mfma_f32_16x16x32_bf16 v[168:171], a[28:31], a[40:43], v[168:171]
    v_mfma_f32_16x16x32_bf16 v[64:67], a[32:35], v[50:53], v[64:67]
    v_mfma_f32_16x16x32_bf16 v[100:103], a[36:39], v[50:53], v[100:103]
    s_lshl_b32 s90, s60, 11
    s_add_u32 m0, s90, 136192
    s_movk_i32 s90, 16384
    v_mfma_f32_16x16x32_bf16 v[136:139], v[50:53], a[40:43], v[136:139]
    buffer_load_dwordx4 v228, s[28:31], s90 offen lds
    s_waitcnt vmcnt(19) lgkmcnt(0)
    s_barrier
    v_mfma_f32_16x16x32_bf16 v[68:71], a[80:83], a[48:51], v[68:71]
    ds_read_b128 v[50:53], v24 offset:0
    v_mfma_f32_16x16x32_bf16 v[104:107], a[84:87], a[48:51], v[104:107]
    v_mfma_f32_16x16x32_bf16 v[140:143], a[48:51], a[88:91], v[140:143]
    ds_read_b64_tr_b16 a[32:33], v31 offset:0
    v_mfma_f32_16x16x32_bf16 v[72:75], a[80:83], a[52:55], v[72:75]
    s_mov_b32 s70, 768
    s_mov_b32 s71, 1179648
    s_add_u32 m0, s72, 0
    v_mfma_f32_16x16x32_bf16 v[108:111], a[84:87], a[52:55], v[108:111]
    buffer_load_dwordx4 v10, s[28:31], s70 offen lds
    ds_read_b128 a[0:3], v24 offset:2048
    v_cndmask_b32 v54, v54, v46, s[88:89]
    v_mfma_f32_16x16x32_bf16 v[144:147], a[52:55], a[88:91], v[144:147]
    ds_read_b64_tr_b16 a[34:35], v31 offset:1536
    v_mfma_f32_16x16x32_bf16 v[76:79], a[80:83], a[56:59], v[76:79]
    ds_read_b128 a[4:7], v24 offset:4096
    v_cndmask_b32 v55, v55, v46, s[88:89]
    v_mfma_f32_16x16x32_bf16 v[112:115], a[84:87], a[56:59], v[112:115]
    s_add_u32 m0, s72, 4096
    v_mfma_f32_16x16x32_bf16 v[148:151], a[56:59], a[88:91], v[148:151]
    buffer_load_dwordx4 v11, s[28:31], s70 offen lds
    ds_read_b128 a[8:11], v24 offset:6144
    v_mfma_f32_16x16x32_bf16 v[80:83], a[80:83], a[60:63], v[80:83]
    ds_read_b64_tr_b16 a[36:37], v31 offset:128
    v_cndmask_b32 v56, v56, v46, s[88:89]
    v_mfma_f32_16x16x32_bf16 v[116:119], a[84:87], a[60:63], v[116:119]
    ds_read_b128 a[12:15], v24 offset:8192
    v_mfma_f32_16x16x32_bf16 v[152:155], a[60:63], a[88:91], v[152:155]
    v_mfma_f32_16x16x32_bf16 v[84:87], a[80:83], a[64:67], v[84:87]
    s_add_u32 m0, s72, 8192
    v_mfma_f32_16x16x32_bf16 v[120:123], a[84:87], a[64:67], v[120:123]
    buffer_load_dwordx4 v12, s[28:31], s70 offen lds
    v_cndmask_b32 v57, v57, v46, s[88:89]
    ds_read_b64_tr_b16 a[38:39], v31 offset:1664
    ds_read_b128 a[16:19], v24 offset:10240
    v_mfma_f32_16x16x32_bf16 v[156:159], a[64:67], a[88:91], v[156:159]
    v_mfma_f32_16x16x32_bf16 v[88:91], a[80:83], a[68:71], v[88:91]
    ds_read_b128 a[20:23], v24 offset:12288
    v_mfma_f32_16x16x32_bf16 v[124:127], a[84:87], a[68:71], v[124:127]
    s_add_u32 m0, s72, 12288
    v_mfma_f32_16x16x32_bf16 v[160:163], a[68:71], a[88:91], v[160:163]
    buffer_load_dwordx4 v13, s[28:31], s70 offen lds
    ds_read_b64_tr_b16 a[40:41], v31 offset:256
    v_mfma_f32_16x16x32_bf16 v[92:95], a[80:83], a[72:75], v[92:95]
    ds_read_b128 a[24:27], v24 offset:14336
    v_mfma_f32_16x16x32_bf16 v[128:131], a[84:87], a[72:75], v[128:131]
    ds_read_b64_tr_b16 a[42:43], v31 offset:1792
    v_mfma_f32_16x16x32_bf16 v[164:167], a[72:75], a[88:91], v[164:167]
    s_mul_i32 m0, s26, 0
    s_add_u32 m0, m0, s27
    v_mfma_f32_16x16x32_bf16 v[96:99], a[80:83], a[76:79], v[96:99]
    buffer_load_dwordx4 v14, s[28:31], s70 offen lds
    ds_read_b128 a[28:31], v24 offset:16384
    v_mfma_f32_16x16x32_bf16 v[132:135], a[84:87], a[76:79], v[132:135]
    v_mfma_f32_16x16x32_bf16 v[168:171], a[76:79], a[88:91], v[168:171]
    v_mfma_f32_16x16x32_bf16 v[64:67], a[80:83], v[54:57], v[64:67]
    s_add_u32 m0, s73, 0
    v_mfma_f32_16x16x32_bf16 v[100:103], a[84:87], v[54:57], v[100:103]
    buffer_load_dwordx4 v15, s[32:35], s71 offen  lds
    v_mfma_f32_16x16x32_bf16 v[136:139], v[54:57], a[88:91], v[136:139]
    s_waitcnt lgkmcnt(0)
    v_mfma_f32_16x16x32_bf16 v[68:71], a[32:35], a[0:3], v[68:71]
    buffer_load_dwordx2 v[44:45], v40, s[36:39], 0 offen sc1
    ds_read_b128 v[54:57], v25 offset:0
    v_mfma_f32_16x16x32_bf16 v[104:107], a[36:39], a[0:3], v[104:107]
    v_mfma_f32_16x16x32_bf16 v[140:143], a[0:3], a[40:43], v[140:143]
    ds_read_b64_tr_b16 a[80:81], v31 offset:12288
    v_mfma_f32_16x16x32_bf16 v[72:75], a[32:35], a[4:7], v[72:75]
    ds_read_b128 a[48:51], v25 offset:2048
    s_add_u32 m0, s73, 1024
    v_mfma_f32_16x16x32_bf16 v[108:111], a[36:39], a[4:7], v[108:111]
    buffer_load_dwordx4 v16, s[32:35], s71 offen  lds
    v_cndmask_b32 v50, v50, v46, s[88:89]
    v_mfma_f32_16x16x32_bf16 v[144:147], a[4:7], a[40:43], v[144:147]
    ds_read_b64_tr_b16 a[82:83], v31 offset:13824
    v_mfma_f32_16x16x32_bf16 v[76:79], a[32:35], a[8:11], v[76:79]
    ds_read_b128 a[52:55], v25 offset:4096
    v_cndmask_b32 v51, v51, v46, s[88:89]
    v_mfma_f32_16x16x32_bf16 v[112:115], a[36:39], a[8:11], v[112:115]
    ds_read_b128 a[56:59], v25 offset:6144
    v_mfma_f32_16x16x32_bf16 v[148:151], a[8:11], a[40:43], v[148:151]
    v_mfma_f32_16x16x32_bf16 v[80:83], a[32:35], a[12:15], v[80:83]
    s_add_u32 m0, s73, 2048
    v_mfma_f32_16x16x32_bf16 v[116:119], a[36:39], a[12:15], v[116:119]
    buffer_load_dwordx4 v17, s[32:35], s71 offen  lds
    ds_read_b64_tr_b16 a[84:85], v31 offset:12416
    v_cndmask_b32 v52, v52, v46, s[88:89]
    ds_read_b128 a[60:63], v25 offset:8192
    v_mfma_f32_16x16x32_bf16 v[152:155], a[12:15], a[40:43], v[152:155]
    v_mfma_f32_16x16x32_bf16 v[84:87], a[32:35], a[16:19], v[84:87]
    v_cndmask_b32 v53, v53, v46, s[88:89]
    ds_read_b64_tr_b16 a[86:87], v31 offset:13952
    v_mfma_f32_16x16x32_bf16 v[120:123], a[36:39], a[16:19], v[120:123]
    ds_read_b128 a[64:67], v25 offset:10240
    v_mfma_f32_16x16x32_bf16 v[156:159], a[16:19], a[40:43], v[156:159]
    s_add_u32 m0, s73, 3072
    v_mfma_f32_16x16x32_bf16 v[88:91], a[32:35], a[20:23], v[88:91]
    buffer_load_dwordx4 v18, s[32:35], s71 offen  lds
    ds_read_b128 a[68:71], v25 offset:12288
    v_mfma_f32_16x16x32_bf16 v[124:127], a[36:39], a[20:23], v[124:127]
    ds_read_b64_tr_b16 a[88:89], v31 offset:12544
    v_mfma_f32_16x16x32_bf16 v[160:163], a[20:23], a[40:43], v[160:163]
    v_mfma_f32_16x16x32_bf16 v[92:95], a[32:35], a[24:27], v[92:95]
    ds_read_b128 a[72:75], v25 offset:14336
    v_mfma_f32_16x16x32_bf16 v[128:131], a[36:39], a[24:27], v[128:131]
    s_add_u32 m0, s73, 4096
    v_mfma_f32_16x16x32_bf16 v[164:167], a[24:27], a[40:43], v[164:167]
    buffer_load_dwordx4 v19, s[32:35], s71 offen  lds
    ds_read_b64_tr_b16 a[90:91], v31 offset:14080
    ds_read_b128 a[76:79], v25 offset:16384
    v_mfma_f32_16x16x32_bf16 v[96:99], a[32:35], a[28:31], v[96:99]
    v_mfma_f32_16x16x32_bf16 v[132:135], a[36:39], a[28:31], v[132:135]
    v_mfma_f32_16x16x32_bf16 v[168:171], a[28:31], a[40:43], v[168:171]
    v_mfma_f32_16x16x32_bf16 v[64:67], a[32:35], v[50:53], v[64:67]
    s_add_u32 m0, s73, 5120
    v_mfma_f32_16x16x32_bf16 v[100:103], a[36:39], v[50:53], v[100:103]
    buffer_load_dwordx4 v20, s[32:35], s71 offen  lds
    v_mfma_f32_16x16x32_bf16 v[136:139], v[50:53], a[40:43], v[136:139]
    s_waitcnt vmcnt(14) lgkmcnt(0)
    s_barrier
    v_mfma_f32_16x16x32_bf16 v[68:71], a[80:83], a[48:51], v[68:71]
    ds_read_b128 v[50:53], v26 offset:0
    s_waitcnt vmcnt(12)
    v_mfma_f32_16x16x32_bf16 v[104:107], a[84:87], a[48:51], v[104:107]
    v_mfma_f32_16x16x32_bf16 v[140:143], a[48:51], a[88:91], v[140:143]
    ds_read_b64_tr_b16 a[32:33], v34 offset:0
    ds_read_b64 a[96:97], v229 offset:0
    v_mfma_f32_16x16x32_bf16 v[72:75], a[80:83], a[52:55], v[72:75]
    s_mov_b32 s70, 896
    s_mov_b32 s71, 1376256
    s_add_u32 m0, s72, 45056
    v_mfma_f32_16x16x32_bf16 v[108:111], a[84:87], a[52:55], v[108:111]
    buffer_load_dwordx4 v10, s[28:31], s70 offen lds
    ds_read_b128 a[0:3], v26 offset:2048
    ds_read_b64 a[98:99], v229 offset:32
    v_cndmask_b32 v54, v54, v46, s[88:89]
    v_mfma_f32_16x16x32_bf16 v[144:147], a[52:55], a[88:91], v[144:147]
    ds_read_b64_tr_b16 a[34:35], v34 offset:1536
    ds_read_b64 a[100:101], v229 offset:64
    v_mfma_f32_16x16x32_bf16 v[76:79], a[80:83], a[56:59], v[76:79]
    ds_read_b128 a[4:7], v26 offset:4096
    v_cndmask_b32 v55, v55, v46, s[88:89]
    v_mfma_f32_16x16x32_bf16 v[112:115], a[84:87], a[56:59], v[112:115]
    ds_read_b64 a[102:103], v229 offset:96
    s_add_u32 m0, s72, 49152
    v_mfma_f32_16x16x32_bf16 v[148:151], a[56:59], a[88:91], v[148:151]
    buffer_load_dwordx4 v11, s[28:31], s70 offen lds
    ds_read_b128 a[8:11], v26 offset:6144
    v_mfma_f32_16x16x32_bf16 v[80:83], a[80:83], a[60:63], v[80:83]
    ds_read_b64_tr_b16 a[36:37], v34 offset:128
    v_cndmask_b32 v56, v56, v46, s[88:89]
    v_mfma_f32_16x16x32_bf16 v[116:119], a[84:87], a[60:63], v[116:119]
    ds_read_b128 a[12:15], v26 offset:8192
    v_mfma_f32_16x16x32_bf16 v[152:155], a[60:63], a[88:91], v[152:155]
    v_mfma_f32_16x16x32_bf16 v[84:87], a[80:83], a[64:67], v[84:87]
    s_add_u32 m0, s72, 53248
    v_mfma_f32_16x16x32_bf16 v[120:123], a[84:87], a[64:67], v[120:123]
    buffer_load_dwordx4 v12, s[28:31], s70 offen lds
    v_cndmask_b32 v57, v57, v46, s[88:89]
    ds_read_b64_tr_b16 a[38:39], v34 offset:1664
    ds_read_b128 a[16:19], v26 offset:10240
    v_mfma_f32_16x16x32_bf16 v[156:159], a[64:67], a[88:91], v[156:159]
    v_mfma_f32_16x16x32_bf16 v[88:91], a[80:83], a[68:71], v[88:91]
    ds_read_b128 a[20:23], v26 offset:12288
    v_mfma_f32_16x16x32_bf16 v[124:127], a[84:87], a[68:71], v[124:127]
    s_add_u32 m0, s72, 57344
    v_mfma_f32_16x16x32_bf16 v[160:163], a[68:71], a[88:91], v[160:163]
    buffer_load_dwordx4 v13, s[28:31], s70 offen lds
    ds_read_b64_tr_b16 a[40:41], v34 offset:256
    v_mfma_f32_16x16x32_bf16 v[92:95], a[80:83], a[72:75], v[92:95]
    ds_read_b128 a[24:27], v26 offset:14336
    v_mfma_f32_16x16x32_bf16 v[128:131], a[84:87], a[72:75], v[128:131]
    ds_read_b64_tr_b16 a[42:43], v34 offset:1792
    v_mfma_f32_16x16x32_bf16 v[164:167], a[72:75], a[88:91], v[164:167]
    s_mul_i32 m0, s26, 45056
    s_add_u32 m0, m0, s27
    v_mfma_f32_16x16x32_bf16 v[96:99], a[80:83], a[76:79], v[96:99]
    buffer_load_dwordx4 v14, s[28:31], s70 offen lds
    ds_read_b128 a[28:31], v26 offset:16384
    v_mfma_f32_16x16x32_bf16 v[132:135], a[84:87], a[76:79], v[132:135]
    v_mfma_f32_16x16x32_bf16 v[168:171], a[76:79], a[88:91], v[168:171]
    v_mfma_f32_16x16x32_bf16 v[64:67], a[80:83], v[54:57], v[64:67]
    s_add_u32 m0, s73, 45056
    v_mfma_f32_16x16x32_bf16 v[100:103], a[84:87], v[54:57], v[100:103]
    buffer_load_dwordx4 v15, s[32:35], s71 offen  lds
    v_mfma_f32_16x16x32_bf16 v[136:139], v[54:57], a[88:91], v[136:139]
    s_waitcnt lgkmcnt(0)
    v_mfma_f32_16x16x32_bf16 v[68:71], a[32:35], a[0:3], v[68:71]
    ds_read_b128 v[54:57], v27 offset:0
    v_mfma_f32_16x16x32_bf16 v[104:107], a[36:39], a[0:3], v[104:107]
    v_mfma_f32_16x16x32_bf16 v[140:143], a[0:3], a[40:43], v[140:143]
    ds_read_b64_tr_b16 a[80:81], v34 offset:12288
    v_mfma_f32_16x16x32_bf16 v[72:75], a[32:35], a[4:7], v[72:75]
    ds_read_b128 a[48:51], v27 offset:2048
    s_add_u32 m0, s73, 46080
    v_mfma_f32_16x16x32_bf16 v[108:111], a[36:39], a[4:7], v[108:111]
    buffer_load_dwordx4 v16, s[32:35], s71 offen  lds
    v_cndmask_b32 v50, v50, v46, s[88:89]
    v_mfma_f32_16x16x32_bf16 v[144:147], a[4:7], a[40:43], v[144:147]
    ds_read_b64_tr_b16 a[82:83], v34 offset:13824
    v_mfma_f32_16x16x32_bf16 v[76:79], a[32:35], a[8:11], v[76:79]
    ds_read_b128 a[52:55], v27 offset:4096
    v_cndmask_b32 v51, v51, v46, s[88:89]
    v_mfma_f32_16x16x32_bf16 v[112:115], a[36:39], a[8:11], v[112:115]
    ds_read_b128 a[56:59], v27 offset:6144
    v_mfma_f32_16x16x32_bf16 v[148:151], a[8:11], a[40:43], v[148:151]
    v_mfma_f32_16x16x32_bf16 v[80:83], a[32:35], a[12:15], v[80:83]
    s_add_u32 m0, s73, 47104
    v_mfma_f32_16x16x32_bf16 v[116:119], a[36:39], a[12:15], v[116:119]
    buffer_load_dwordx4 v17, s[32:35], s71 offen  lds
    ds_read_b64_tr_b16 a[84:85], v34 offset:12416
    v_cndmask_b32 v52, v52, v46, s[88:89]
    ds_read_b128 a[60:63], v27 offset:8192
    v_mfma_f32_16x16x32_bf16 v[152:155], a[12:15], a[40:43], v[152:155]
    v_mfma_f32_16x16x32_bf16 v[84:87], a[32:35], a[16:19], v[84:87]
    v_cndmask_b32 v53, v53, v46, s[88:89]
    ds_read_b64_tr_b16 a[86:87], v34 offset:13952
    v_mfma_f32_16x16x32_bf16 v[120:123], a[36:39], a[16:19], v[120:123]
    ds_read_b128 a[64:67], v27 offset:10240
    v_mfma_f32_16x16x32_bf16 v[156:159], a[16:19], a[40:43], v[156:159]
    s_add_u32 m0, s73, 48128
    v_mfma_f32_16x16x32_bf16 v[88:91], a[32:35], a[20:23], v[88:91]
    buffer_load_dwordx4 v18, s[32:35], s71 offen  lds
    ds_read_b128 a[68:71], v27 offset:12288
    v_mfma_f32_16x16x32_bf16 v[124:127], a[36:39], a[20:23], v[124:127]
    ds_read_b64_tr_b16 a[88:89], v34 offset:12544
    v_mfma_f32_16x16x32_bf16 v[160:163], a[20:23], a[40:43], v[160:163]
    v_mfma_f32_16x16x32_bf16 v[92:95], a[32:35], a[24:27], v[92:95]
    ds_read_b128 a[72:75], v27 offset:14336
    v_mfma_f32_16x16x32_bf16 v[128:131], a[36:39], a[24:27], v[128:131]
    s_add_u32 m0, s73, 49152
    v_mfma_f32_16x16x32_bf16 v[164:167], a[24:27], a[40:43], v[164:167]
    buffer_load_dwordx4 v19, s[32:35], s71 offen  lds
    ds_read_b64_tr_b16 a[90:91], v34 offset:14080
    ds_read_b128 a[76:79], v27 offset:16384
    v_mfma_f32_16x16x32_bf16 v[96:99], a[32:35], a[28:31], v[96:99]
    v_mfma_f32_16x16x32_bf16 v[132:135], a[36:39], a[28:31], v[132:135]
    v_mfma_f32_16x16x32_bf16 v[168:171], a[28:31], a[40:43], v[168:171]
    v_mfma_f32_16x16x32_bf16 v[64:67], a[32:35], v[50:53], v[64:67]
    s_add_u32 m0, s73, 50176
    v_mfma_f32_16x16x32_bf16 v[100:103], a[36:39], v[50:53], v[100:103]
    buffer_load_dwordx4 v20, s[32:35], s71 offen  lds
    v_mfma_f32_16x16x32_bf16 v[136:139], v[50:53], a[40:43], v[136:139]
    s_waitcnt vmcnt(11) lgkmcnt(0)
SP1_4:
    v_cmp_ne_u64 vcc, s[66:67], v[44:45]
    s_and_b64 vcc, vcc, s[84:85]
    s_cbranch_vccz SP1_4_ok
    s_sleep 1
    buffer_load_dwordx2 v[44:45], v40, s[36:39], 0 offen sc1
    s_waitcnt vmcnt(0)
    s_branch SP1_4
SP1_4_ok:
    s_barrier
    v_mfma_f32_16x16x32_bf16 v[68:71], a[80:83], a[48:51], v[68:71]
    buffer_load_dwordx2 v[58:59], v41, s[36:39], 0 offen sc1
    ds_read_b128 v[50:53], v22 offset:0
    v_mfma_f32_16x16x32_bf16 v[104:107], a[84:87], a[48:51], v[104:107]
    v_mfma_f32_16x16x32_bf16 v[140:143], a[48:51], a[88:91], v[140:143]
    ds_read_b64_tr_b16 a[32:33], v28 offset:0
    v_mfma_f32_16x16x32_bf16 v[72:75], a[80:83], a[52:55], v[72:75]
    s_add_u32 s91, s80, 0
    s_add_u32 m0, s82, 98304
    v_mfma_f32_16x16x32_bf16 v[108:111], a[84:87], a[52:55], v[108:111]
    buffer_load_dwordx4 v61, s[48:51], s91 offen offset:0 lds
    ds_read_b128 a[0:3], v22 offset:2048
    v_cndmask_b32 v54, v54, v46, s[88:89]
    v_mfma_f32_16x16x32_bf16 v[144:147], a[52:55], a[88:91], v[144:147]
    ds_read_b64_tr_b16 a[34:35], v28 offset:1536
    v_mfma_f32_16x16x32_bf16 v[76:79], a[80:83], a[56:59], v[76:79]
    ds_read_b128 a[4:7], v22 offset:4096
    v_cndmask_b32 v55, v55, v46, s[88:89]
    v_mfma_f32_16x16x32_bf16 v[112:115], a[84:87], a[56:59], v[112:115]
    buffer_load_dwordx4 v62, s[48:51], s91 offen offset:1024 lds
    ds_read_b128 a[8:11], v22 offset:6144
    v_mfma_f32_16x16x32_bf16 v[148:151], a[56:59], a[88:91], v[148:151]
    v_mfma_f32_16x16x32_bf16 v[80:83], a[80:83], a[60:63], v[80:83]
    ds_read_b64_tr_b16 a[36:37], v28 offset:128
    v_cndmask_b32 v56, v56, v46, s[88:89]
    v_mfma_f32_16x16x32_bf16 v[116:119], a[84:87], a[60:63], v[116:119]
    ds_read_b128 a[12:15], v22 offset:8192
    v_mfma_f32_16x16x32_bf16 v[152:155], a[60:63], a[88:91], v[152:155]
    v_mfma_f32_16x16x32_bf16 v[84:87], a[80:83], a[64:67], v[84:87]
    buffer_load_dwordx4 v252, s[48:51], s91 offen offset:2048 lds
    v_cndmask_b32 v57, v57, v46, s[88:89]
    ds_read_b64_tr_b16 a[38:39], v28 offset:1664
    v_mfma_f32_16x16x32_bf16 v[120:123], a[84:87], a[64:67], v[120:123]
    ds_read_b128 a[16:19], v22 offset:10240
    v_mfma_f32_16x16x32_bf16 v[156:159], a[64:67], a[88:91], v[156:159]
    v_mfma_f32_16x16x32_bf16 v[88:91], a[80:83], a[68:71], v[88:91]
    ds_read_b128 a[20:23], v22 offset:12288
    v_mfma_f32_16x16x32_bf16 v[124:127], a[84:87], a[68:71], v[124:127]
    buffer_load_dwordx4 v254, s[48:51], s91 offen offset:3072 lds
    ds_read_b64_tr_b16 a[40:41], v28 offset:256
    v_mfma_f32_16x16x32_bf16 v[160:163], a[68:71], a[88:91], v[160:163]
    v_mfma_f32_16x16x32_bf16 v[92:95], a[80:83], a[72:75], v[92:95]
    ds_read_b128 a[24:27], v22 offset:14336
    v_mfma_f32_16x16x32_bf16 v[128:131], a[84:87], a[72:75], v[128:131]
    ds_read_b64_tr_b16 a[42:43], v28 offset:1792
    v_mfma_f32_16x16x32_bf16 v[164:167], a[72:75], a[88:91], v[164:167]
    s_add_u32 s91, s80, 32768
    s_add_u32 m0, s82, 114688
    v_mfma_f32_16x16x32_bf16 v[96:99], a[80:83], a[76:79], v[96:99]
    buffer_load_dwordx4 v61, s[48:51], s91 offen offset:0 lds
    ds_read_b128 a[28:31], v22 offset:16384
    v_mfma_f32_16x16x32_bf16 v[132:135], a[84:87], a[76:79], v[132:135]
    v_mfma_f32_16x16x32_bf16 v[168:171], a[76:79], a[88:91], v[168:171]
    v_mfma_f32_16x16x32_bf16 v[64:67], a[80:83], v[54:57], v[64:67]
    buffer_load_dwordx4 v62, s[48:51], s91 offen offset:1024 lds
    v_mfma_f32_16x16x32_bf16 v[100:103], a[84:87], v[54:57], v[100:103]
    v_mfma_f32_16x16x32_bf16 v[136:139], v[54:57], a[88:91], v[136:139]
    s_waitcnt lgkmcnt(0)
    v_mfma_f32_16x16x32_bf16 v[68:71], a[32:35], a[0:3], v[68:71]
    ds_read_b128 v[54:57], v23 offset:0
    v_mfma_f32_16x16x32_bf16 v[104:107], a[36:39], a[0:3], v[104:107]
    v_mfma_f32_16x16x32_bf16 v[140:143], a[0:3], a[40:43], v[140:143]
    ds_read_b64_tr_b16 a[80:81], v28 offset:12288
    v_mfma_f32_16x16x32_bf16 v[72:75], a[32:35], a[4:7], v[72:75]
    buffer_load_dwordx4 v252, s[48:51], s91 offen offset:2048 lds
    ds_read_b128 a[48:51], v23 offset:2048
    v_mfma_f32_16x16x32_bf16 v[108:111], a[36:39], a[4:7], v[108:111]
    v_cndmask_b32 v50, v50, v46, s[88:89]
    v_mfma_f32_16x16x32_bf16 v[144:147], a[4:7], a[40:43], v[144:147]
    ds_read_b64_tr_b16 a[82:83], v28 offset:13824
    v_mfma_f32_16x16x32_bf16 v[76:79], a[32:35], a[8:11], v[76:79]
    ds_read_b128 a[52:55], v23 offset:4096
    v_cndmask_b32 v51, v51, v46, s[88:89]
    v_mfma_f32_16x16x32_bf16 v[112:115], a[36:39], a[8:11], v[112:115]
    buffer_load_dwordx4 v254, s[48:51], s91 offen offset:3072 lds
    ds_read_b128 a[56:59], v23 offset:6144
    v_mfma_f32_16x16x32_bf16 v[148:151], a[8:11], a[40:43], v[148:151]
    v_mfma_f32_16x16x32_bf16 v[80:83], a[32:35], a[12:15], v[80:83]
    ds_read_b64_tr_b16 a[84:85], v28 offset:12416
    v_cndmask_b32 v52, v52, v46, s[88:89]
    v_mfma_f32_16x16x32_bf16 v[116:119], a[36:39], a[12:15], v[116:119]
    ds_read_b128 a[60:63], v23 offset:8192
    v_mfma_f32_16x16x32_bf16 v[152:155], a[12:15], a[40:43], v[152:155]
    v_mfma_f32_16x16x32_bf16 v[84:87], a[32:35], a[16:19], v[84:87]
    s_add_u32 s91, s80, 65536
    s_add_u32 m0, s82, 131072
    v_mfma_f32_16x16x32_bf16 v[120:123], a[36:39], a[16:19], v[120:123]
    buffer_load_dwordx4 v61, s[48:51], s91 offen offset:0 lds
    v_cndmask_b32 v53, v53, v46, s[88:89]
    ds_read_b64_tr_b16 a[86:87], v28 offset:13952
    ds_read_b128 a[64:67], v23 offset:10240
    v_mfma_f32_16x16x32_bf16 v[156:159], a[16:19], a[40:43], v[156:159]
    v_mfma_f32_16x16x32_bf16 v[88:91], a[32:35], a[20:23], v[88:91]
    ds_read_b128 a[68:71], v23 offset:12288
    v_mfma_f32_16x16x32_bf16 v[124:127], a[36:39], a[20:23], v[124:127]
    buffer_load_dwordx4 v62, s[48:51], s91 offen offset:1024 lds
    ds_read_b64_tr_b16 a[88:89], v28 offset:12544
    v_mfma_f32_16x16x32_bf16 v[160:163], a[20:23], a[40:43], v[160:163]
    v_mfma_f32_16x16x32_bf16 v[92:95], a[32:35], a[24:27], v[92:95]
    ds_read_b128 a[72:75], v23 offset:14336
    v_mfma_f32_16x16x32_bf16 v[128:131], a[36:39], a[24:27], v[128:131]
    ds_read_b64_tr_b16 a[90:91], v28 offset:14080
    v_mfma_f32_16x16x32_bf16 v[164:167], a[24:27], a[40:43], v[164:167]
    buffer_load_dwordx4 v252, s[48:51], s91 offen offset:2048 lds
    ds_read_b128 a[76:79], v23 offset:16384
    v_mfma_f32_16x16x32_bf16 v[96:99], a[32:35], a[28:31], v[96:99]
    v_mfma_f32_16x16x32_bf16 v[132:135], a[36:39], a[28:31], v[132:135]
    v_mfma_f32_16x16x32_bf16 v[168:171], a[28:31], a[40:43], v[168:171]
    v_mfma_f32_16x16x32_bf16 v[64:67], a[32:35], v[50:53], v[64:67]
    buffer_load_dwordx4 v254, s[48:51], s91 offen offset:3072 lds
    v_mfma_f32_16x16x32_bf16 v[100:103], a[36:39], v[50:53], v[100:103]
    v_mfma_f32_16x16x32_bf16 v[136:139], v[50:53], a[40:43], v[136:139]
    s_waitcnt vmcnt(12) lgkmcnt(0)
    s_barrier
    v_mfma_f32_16x16x32_bf16 v[68:71], a[80:83], a[48:51], v[68:71]
    v_lshlrev_b32 v2, 1, v60
    v_add_u32 v2, 147456, v2
    v_add_u32 v3, 147456, v60
    ds_read_b128 v[50:53], v24 offset:0
    ds_write_b64 v2, v[58:59]
    v_mfma_f32_16x16x32_bf16 v[104:107], a[84:87], a[48:51], v[104:107]
    ds_write_b32 v3, v58 offset:2048
    ds_write_b32 v3, v59 offset:3072
    v_mfma_f32_16x16x32_bf16 v[140:143], a[48:51], a[88:91], v[140:143]
    ds_read_b64_tr_b16 a[32:33], v31 offset:0
    v_mfma_f32_16x16x32_bf16 v[72:75], a[80:83], a[52:55], v[72:75]
    ds_read_b128 a[0:3], v24 offset:2048
    v_mfma_f32_16x16x32_bf16 v[108:111], a[84:87], a[52:55], v[108:111]
    v_cndmask_b32 v54, v54, v46, s[88:89]
    s_add_u32 s91, s80, 98304
    s_add_u32 m0, s82, 0
    v_mfma_f32_16x16x32_bf16 v[144:147], a[52:55], a[88:91], v[144:147]
    buffer_load_dwordx4 v61, s[48:51], s91 offen offset:0 lds
    ds_read_b64_tr_b16 a[34:35], v31 offset:1536
    v_mfma_f32_16x16x32_bf16 v[76:79], a[80:83], a[56:59], v[76:79]
    ds_read_b128 a[4:7], v24 offset:4096
    v_cndmask_b32 v55, v55, v46, s[88:89]
    v_mfma_f32_16x16x32_bf16 v[112:115], a[84:87], a[56:59], v[112:115]
    ds_read_b128 a[8:11], v24 offset:6144
    v_mfma_f32_16x16x32_bf16 v[148:151], a[56:59], a[88:91], v[148:151]
    v_mfma_f32_16x16x32_bf16 v[80:83], a[80:83], a[60:63], v[80:83]
    ds_read_b64_tr_b16 a[36:37], v31 offset:128
    v_cndmask_b32 v56, v56, v46, s[88:89]
    v_mfma_f32_16x16x32_bf16 v[116:119], a[84:87], a[60:63], v[116:119]
    ds_read_b128 a[12:15], v24 offset:8192
    buffer_load_dwordx4 v62, s[48:51], s91 offen offset:1024 lds
    v_mfma_f32_16x16x32_bf16 v[152:155], a[60:63], a[88:91], v[152:155]
    v_mfma_f32_16x16x32_bf16 v[84:87], a[80:83], a[64:67], v[84:87]
    v_cndmask_b32 v57, v57, v46, s[88:89]
    ds_read_b64_tr_b16 a[38:39], v31 offset:1664
    v_mfma_f32_16x16x32_bf16 v[120:123], a[84:87], a[64:67], v[120:123]
    ds_read_b128 a[16:19], v24 offset:10240
    v_mfma_f32_16x16x32_bf16 v[156:159], a[64:67], a[88:91], v[156:159]
    v_mfma_f32_16x16x32_bf16 v[88:91], a[80:83], a[68:71], v[88:91]
    ds_read_b128 a[20:23], v24 offset:12288
    v_mfma_f32_16x16x32_bf16 v[124:127], a[84:87], a[68:71], v[124:127]
    ds_read_b64_tr_b16 a[40:41], v31 offset:256
    v_mfma_f32_16x16x32_bf16 v[160:163], a[68:71], a[88:91], v[160:163]
    buffer_load_dwordx4 v252, s[48:51], s91 offen offset:2048 lds
    v_mfma_f32_16x16x32_bf16 v[92:95], a[80:83], a[72:75], v[92:95]
    ds_read_b128 a[24:27], v24 offset:14336
    v_mfma_f32_16x16x32_bf16 v[128:131], a[84:87], a[72:75], v[128:131]
    ds_read_b64_tr_b16 a[42:43], v31 offset:1792
    v_mfma_f32_16x16x32_bf16 v[164:167], a[72:75], a[88:91], v[164:167]
    ds_read_b128 a[28:31], v24 offset:16384
    v_mfma_f32_16x16x32_bf16 v[96:99], a[80:83], a[76:79], v[96:99]
    v_mfma_f32_16x16x32_bf16 v[132:135], a[84:87], a[76:79], v[132:135]
    v_mfma_f32_16x16x32_bf16 v[168:171], a[76:79], a[88:91], v[168:171]
    buffer_load_dwordx4 v254, s[48:51], s91 offen offset:3072 lds
    v_mfma_f32_16x16x32_bf16 v[64:67], a[80:83], v[54:57], v[64:67]
    v_mfma_f32_16x16x32_bf16 v[100:103], a[84:87], v[54:57], v[100:103]
    v_mfma_f32_16x16x32_bf16 v[136:139], v[54:57], a[88:91], v[136:139]
    s_waitcnt lgkmcnt(0)
    v_mfma_f32_16x16x32_bf16 v[68:71], a[32:35], a[0:3], v[68:71]
    ds_read_b128 v[54:57], v25 offset:0
    v_mfma_f32_16x16x32_bf16 v[104:107], a[36:39], a[0:3], v[104:107]
    v_mfma_f32_16x16x32_bf16 v[140:143], a[0:3], a[40:43], v[140:143]
    ds_read_b64_tr_b16 a[80:81], v31 offset:12288
    v_mfma_f32_16x16x32_bf16 v[72:75], a[32:35], a[4:7], v[72:75]
    ds_read_b128 a[48:51], v25 offset:2048
    v_mfma_f32_16x16x32_bf16 v[108:111], a[36:39], a[4:7], v[108:111]
    v_cndmask_b32 v50, v50, v46, s[88:89]
    s_add_u32 s91, s80, 131072
    s_add_u32 m0, s82, 16384
    v_mfma_f32_16x16x32_bf16 v[144:147], a[4:7], a[40:43], v[144:147]
    buffer_load_dwordx4 v61, s[48:51], s91 offen offset:0 lds
    ds_read_b64_tr_b16 a[82:83], v31 offset:13824
    v_mfma_f32_16x16x32_bf16 v[76:79], a[32:35], a[8:11], v[76:79]
    ds_read_b128 a[52:55], v25 offset:4096
    v_cndmask_b32 v51, v51, v46, s[88:89]
    v_mfma_f32_16x16x32_bf16 v[112:115], a[36:39], a[8:11], v[112:115]
    ds_read_b128 a[56:59], v25 offset:6144
    v_mfma_f32_16x16x32_bf16 v[148:151], a[8:11], a[40:43], v[148:151]
    v_mfma_f32_16x16x32_bf16 v[80:83], a[32:35], a[12:15], v[80:83]
    ds_read_b64_tr_b16 a[84:85], v31 offset:12416
    v_cndmask_b32 v52, v52, v46, s[88:89]
    v_mfma_f32_16x16x32_bf16 v[116:119], a[36:39], a[12:15], v[116:119]
    ds_read_b128 a[60:63], v25 offset:8192
    buffer_load_dwordx4 v62, s[48:51], s91 offen offset:1024 lds
    v_mfma_f32_16x16x32_bf16 v[152:155], a[12:15], a[40:43], v[152:155]
    v_mfma_f32_16x16x32_bf16 v[84:87], a[32:35], a[16:19], v[84:87]
    v_cndmask_b32 v53, v53, v46, s[88:89]
    ds_read_b64_tr_b16 a[86:87], v31 offset:13952
    v_mfma_f32_16x16x32_bf16 v[120:123], a[36:39], a[16:19], v[120:123]
    ds_read_b128 a[64:67], v25 offset:10240
    v_mfma_f32_16x16x32_bf16 v[156:159], a[16:19], a[40:43], v[156:159]
    v_mfma_f32_16x16x32_bf16 v[88:91], a[32:35], a[20:23], v[88:91]
    ds_read_b128 a[68:71], v25 offset:12288
    v_mfma_f32_16x16x32_bf16 v[124:127], a[36:39], a[20:23], v[124:127]
    ds_read_b64_tr_b16 a[88:89], v31 offset:12544
    v_mfma_f32_16x16x32_bf16 v[160:163], a[20:23], a[40:43], v[160:163]
    buffer_load_dwordx4 v252, s[48:51], s91 offen offset:2048 lds
    v_mfma_f32_16x16x32_bf16 v[92:95], a[32:35], a[24:27], v[92:95]
    ds_read_b128 a[72:75], v25 offset:14336
    v_mfma_f32_16x16x32_bf16 v[128:131], a[36:39], a[24:27], v[128:131]
    ds_read_b64_tr_b16 a[90:91], v31 offset:14080
    v_mfma_f32_16x16x32_bf16 v[164:167], a[24:27], a[40:43], v[164:167]
    ds_read_b128 a[76:79], v25 offset:16384
    v_mfma_f32_16x16x32_bf16 v[96:99], a[32:35], a[28:31], v[96:99]
    v_mfma_f32_16x16x32_bf16 v[132:135], a[36:39], a[28:31], v[132:135]
    v_mfma_f32_16x16x32_bf16 v[168:171], a[28:31], a[40:43], v[168:171]
    buffer_load_dwordx4 v254, s[48:51], s91 offen offset:3072 lds
    v_mfma_f32_16x16x32_bf16 v[64:67], a[32:35], v[50:53], v[64:67]
    v_mfma_f32_16x16x32_bf16 v[100:103], a[36:39], v[50:53], v[100:103]
    v_mfma_f32_16x16x32_bf16 v[136:139], v[50:53], a[40:43], v[136:139]
    s_waitcnt vmcnt(20) lgkmcnt(0)
    s_barrier
    v_mfma_f32_16x16x32_bf16 v[68:71], a[80:83], a[48:51], v[68:71]
    ds_read_b64 v[10:11], v233 offset:0
    v_mfma_f32_16x16x32_bf16 v[104:107], a[84:87], a[48:51], v[104:107]
    ds_read_b64 v[12:13], v233 offset:128
    v_mfma_f32_16x16x32_bf16 v[140:143], a[48:51], a[88:91], v[140:143]
    ds_read_b64 v[14:15], v233 offset:256
    v_mfma_f32_16x16x32_bf16 v[72:75], a[80:83], a[52:55], v[72:75]
    s_add_u32 s91, s80, 163840
    s_add_u32 m0, s82, 32768
    v_mfma_f32_16x16x32_bf16 v[108:111], a[84:87], a[52:55], v[108:111]
    buffer_load_dwordx4 v61, s[48:51], s91 offen offset:0 lds
    ds_read_b64 v[16:17], v233 offset:384
    v_cndmask_b32 v54, v54, v46, s[88:89]
    ds_read_b64 v[18:19], v233 offset:512
    v_mfma_f32_16x16x32_bf16 v[144:147], a[52:55], a[88:91], v[144:147]
    ds_read_b64 v[20:21], v233 offset:640
    v_mfma_f32_16x16x32_bf16 v[76:79], a[80:83], a[56:59], v[76:79]
    v_cndmask_b32 v55, v55, v46, s[88:89]
    ds_read_b64 v[22:23], v233 offset:768
    v_mfma_f32_16x16x32_bf16 v[112:115], a[84:87], a[56:59], v[112:115]
    buffer_load_dwordx4 v62, s[48:51], s91 offen offset:1024 lds
    ds_read_b64 v[24:25], v233 offset:896
    v_mfma_f32_16x16x32_bf16 v[148:151], a[56:59], a[88:91], v[148:151]
    ds_read_b64 v[26:27], v233 offset:1024
    v_mfma_f32_16x16x32_bf16 v[80:83], a[80:83], a[60:63], v[80:83]
    v_cndmask_b32 v56, v56, v46, s[88:89]
    ds_read_b128 v[190:193], v234 offset:0
    v_mfma_f32_16x16x32_bf16 v[116:119], a[84:87], a[60:63], v[116:119]
    ds_read_b128 v[194:197], v234 offset:1024
    v_mfma_f32_16x16x32_bf16 v[152:155], a[60:63], a[88:91], v[152:155]
    s_waitcnt vmcnt(10)
    ds_read_b64_tr_b16 a[128:129], v244 offset:32768
    ds_read_b128 v[198:201], v234 offset:64
    v_mfma_f32_16x16x32_bf16 v[84:87], a[80:83], a[64:67], v[84:87]
    buffer_load_dwordx4 v252, s[48:51], s91 offen offset:2048 lds
    v_cndmask_b32 v57, v57, v46, s[88:89]
    ds_read_b64_tr_b16 a[130:131], v244 offset:34816
    ds_read_b64_tr_b16 a[132:133], v245 offset:32768
    ds_read_b128 v[202:205], v234 offset:1088
    v_mfma_f32_16x16x32_bf16 v[120:123], a[84:87], a[64:67], v[120:123]
    ds_read_b64_tr_b16 a[134:135], v245 offset:34816
    v_mfma_f32_16x16x32_bf16 v[156:159], a[64:67], a[88:91], v[156:159]
    ds_read_b64_tr_b16 a[136:137], v246 offset:32768
    ds_read_b64_tr_b16 a[138:139], v246 offset:34816
    v_mfma_f32_16x16x32_bf16 v[88:91], a[80:83], a[68:71], v[88:91]
    ds_read_b64_tr_b16 a[140:141], v247 offset:32768
    ds_read_b64_tr_b16 a[142:143], v247 offset:34816
    v_mfma_f32_16x16x32_bf16 v[124:127], a[84:87], a[68:71], v[124:127]
    buffer_load_dwordx4 v254, s[48:51], s91 offen offset:3072 lds
    ds_read_b64_tr_b16 a[144:145], v244 offset:49152
    v_mfma_f32_16x16x32_bf16 v[160:163], a[68:71], a[88:91], v[160:163]
    ds_read_b64_tr_b16 a[146:147], v244 offset:51200
    ds_read_b64_tr_b16 a[148:149], v245 offset:49152
    v_mfma_f32_16x16x32_bf16 v[92:95], a[80:83], a[72:75], v[92:95]
    ds_read_b64_tr_b16 a[150:151], v245 offset:51200
    ds_read_b64_tr_b16 a[152:153], v246 offset:49152
    v_mfma_f32_16x16x32_bf16 v[128:131], a[84:87], a[72:75], v[128:131]
    ds_read_b64_tr_b16 a[154:155], v246 offset:51200
    v_mfma_f32_16x16x32_bf16 v[164:167], a[72:75], a[88:91], v[164:167]
    ds_read_b64_tr_b16 a[156:157], v247 offset:49152
    s_add_u32 s91, s80, 196608
    s_add_u32 m0, s82, 49152
    v_mfma_f32_16x16x32_bf16 v[96:99], a[80:83], a[76:79], v[96:99]
    buffer_load_dwordx4 v61, s[48:51], s91 offen offset:0 lds
    ds_read_b64_tr_b16 a[158:159], v247 offset:51200
    ds_read_b64_tr_b16 a[160:161], v248 offset:0
    ds_read_b64_tr_b16 a[162:163], v248 offset:2048
    v_mfma_f32_16x16x32_bf16 v[132:135], a[84:87], a[76:79], v[132:135]
    ds_read_b64_tr_b16 a[164:165], v249 offset:0
    ds_read_b64_tr_b16 a[166:167], v249 offset:2048
    v_mfma_f32_16x16x32_bf16 v[168:171], a[76:79], a[88:91], v[168:171]
    ds_read_b64_tr_b16 a[168:169], v250 offset:0
    v_mfma_f32_16x16x32_bf16 v[64:67], a[80:83], v[54:57], v[64:67]
    ds_read_b64_tr_b16 a[170:171], v250 offset:2048
    ds_read_b64_tr_b16 a[172:173], v251 offset:0
    buffer_load_dwordx4 v62, s[48:51], s91 offen offset:1024 lds
    v_mfma_f32_16x16x32_bf16 v[100:103], a[84:87], v[54:57], v[100:103]
    ds_read_b64_tr_b16 a[174:175], v251 offset:2048
    v_mfma_f32_16x16x32_bf16 v[136:139], v[54:57], a[88:91], v[136:139]
    s_nop 7
    v_mov_b32_dpp v28, v64 row_newbcast:0 row_mask:0xf bank_mask:0xf
    v_mov_b32_dpp v32, v100 row_newbcast:0 row_mask:0xf bank_mask:0xf
    v_mov_b32_dpp v29, v65 row_newbcast:0 row_mask:0xf bank_mask:0xf
    v_mov_b32_dpp v33, v101 row_newbcast:0 row_mask:0xf bank_mask:0xf
    v_mov_b32_dpp v30, v66 row_newbcast:0 row_mask:0xf bank_mask:0xf
    v_mov_b32_dpp v34, v102 row_newbcast:0 row_mask:0xf bank_mask:0xf
    v_mov_b32_dpp v31, v67 row_newbcast:0 row_mask:0xf bank_mask:0xf
    v_mov_b32_dpp v35, v103 row_newbcast:0 row_mask:0xf bank_mask:0xf
    v_mov_b32 v36, v136
    v_mov_b32 v37, v136
    s_mov_b32 s78, 0x3eb8aa3b
    s_waitcnt lgkmcnt(0)
    v_permlane16_swap_b32 v36, v37
    buffer_load_dwordx4 v252, s[48:51], s91 offen offset:2048 lds
    v_pk_fma_f32 v[100:101], v[32:33], v[10:11], v[100:101] op_sel:[0,0,0] op_sel_hi:[1,0,1]
    v_pk_fma_f32 v[102:103], v[34:35], v[10:11], v[102:103] op_sel:[0,0,0] op_sel_hi:[1,0,1]
    v_pk_mul_f32 v[100:101], v[100:101], v[10:11] op_sel:[0,1] op_sel_hi:[1,1]
    v_pk_mul_f32 v[102:103], v[102:103], v[10:11] op_sel:[0,1] op_sel_hi:[1,1]
    v_cvt_pk_bf16_f32 v222, v100, v101
    v_cvt_pk_bf16_f32 v223, v102, v103
    buffer_load_dwordx4 v254, s[48:51], s91 offen offset:3072 lds
    v_pk_fma_f32 v[104:105], v[32:33], v[12:13], v[104:105] op_sel:[0,0,0] op_sel_hi:[1,0,1]
    v_pk_fma_f32 v[68:69], v[28:29], v[12:13], v[68:69] op_sel:[0,0,0] op_sel_hi:[1,0,1]
    v_pk_fma_f32 v[106:107], v[34:35], v[12:13], v[106:107] op_sel:[0,0,0] op_sel_hi:[1,0,1]
    v_pk_fma_f32 v[70:71], v[30:31], v[12:13], v[70:71] op_sel:[0,0,0] op_sel_hi:[1,0,1]
    v_pk_mul_f32 v[104:105], v[104:105], v[12:13] op_sel:[0,1] op_sel_hi:[1,1]
    v_pk_mul_f32 v[68:69], v[68:69], v[12:13] op_sel:[0,1] op_sel_hi:[1,1]
    v_pk_mul_f32 v[106:107], v[106:107], v[12:13] op_sel:[0,1] op_sel_hi:[1,1]
    v_pk_mul_f32 v[70:71], v[70:71], v[12:13] op_sel:[0,1] op_sel_hi:[1,1]
    v_cvt_pk_bf16_f32 v224, v104, v105
    v_cvt_pk_bf16_f32 v206, v68, v69
    v_cvt_pk_bf16_f32 v225, v106, v107
    v_cvt_pk_bf16_f32 v207, v70, v71
    s_add_u32 s91, s80, 229376
    s_add_u32 m0, s82, 65536
    v_pk_fma_f32 v[108:109], v[32:33], v[14:15], v[108:109] op_sel:[0,0,0] op_sel_hi:[1,0,1]
    buffer_load_dwordx4 v61, s[48:51], s91 offen offset:0 lds
    v_pk_fma_f32 v[72:73], v[28:29], v[14:15], v[72:73] op_sel:[0,0,0] op_sel_hi:[1,0,1]
    v_pk_fma_f32 v[110:111], v[34:35], v[14:15], v[110:111] op_sel:[0,0,0] op_sel_hi:[1,0,1]
    v_pk_fma_f32 v[74:75], v[30:31], v[14:15], v[74:75] op_sel:[0,0,0] op_sel_hi:[1,0,1]
    v_pk_mul_f32 v[108:109], v[108:109], v[14:15] op_sel:[0,1] op_sel_hi:[1,1]
    v_pk_mul_f32 v[72:73], v[72:73], v[14:15] op_sel:[0,1] op_sel_hi:[1,1]
    v_pk_mul_f32 v[110:111], v[110:111], v[14:15] op_sel:[0,1] op_sel_hi:[1,1]
    v_pk_mul_f32 v[74:75], v[74:75], v[14:15] op_sel:[0,1] op_sel_hi:[1,1]
    v_cvt_pk_bf16_f32 v226, v108, v109
    v_cvt_pk_bf16_f32 v208, v72, v73
    v_cvt_pk_bf16_f32 v227, v110, v111
    v_cvt_pk_bf16_f32 v209, v74, v75
    buffer_load_dwordx4 v62, s[48:51], s91 offen offset:1024 lds
    v_pk_fma_f32 v[112:113], v[32:33], v[16:17], v[112:113] op_sel:[0,0,0] op_sel_hi:[1,0,1]
    v_pk_fma_f32 v[76:77], v[28:29], v[16:17], v[76:77] op_sel:[0,0,0] op_sel_hi:[1,0,1]
    v_pk_fma_f32 v[114:115], v[34:35], v[16:17], v[114:115] op_sel:[0,0,0] op_sel_hi:[1,0,1]
    v_pk_fma_f32 v[78:79], v[30:31], v[16:17], v[78:79] op_sel:[0,0,0] op_sel_hi:[1,0,1]
    v_pk_mul_f32 v[112:113], v[112:113], v[16:17] op_sel:[0,1] op_sel_hi:[1,1]
    v_pk_mul_f32 v[76:77], v[76:77], v[16:17] op_sel:[0,1] op_sel_hi:[1,1]
    v_pk_mul_f32 v[114:115], v[114:115], v[16:17] op_sel:[0,1] op_sel_hi:[1,1]
    v_pk_mul_f32 v[78:79], v[78:79], v[16:17] op_sel:[0,1] op_sel_hi:[1,1]
    v_cvt_pk_bf16_f32 v228, v112, v113
    v_cvt_pk_bf16_f32 v210, v76, v77
    v_cvt_pk_bf16_f32 v229, v114, v115
    v_cvt_pk_bf16_f32 v211, v78, v79
    buffer_load_dwordx4 v252, s[48:51], s91 offen offset:2048 lds
    v_pk_fma_f32 v[116:117], v[32:33], v[18:19], v[116:117] op_sel:[0,0,0] op_sel_hi:[1,0,1]
    v_pk_fma_f32 v[80:81], v[28:29], v[18:19], v[80:81] op_sel:[0,0,0] op_sel_hi:[1,0,1]
    v_pk_fma_f32 v[118:119], v[34:35], v[18:19], v[118:119] op_sel:[0,0,0] op_sel_hi:[1,0,1]
    v_pk_fma_f32 v[82:83], v[30:31], v[18:19], v[82:83] op_sel:[0,0,0] op_sel_hi:[1,0,1]
    v_pk_mul_f32 v[116:117], v[116:117], v[18:19] op_sel:[0,1] op_sel_hi:[1,1]
    v_pk_mul_f32 v[80:81], v[80:81], v[18:19] op_sel:[0,1] op_sel_hi:[1,1]
    v_pk_mul_f32 v[118:119], v[118:119], v[18:19] op_sel:[0,1] op_sel_hi:[1,1]
    v_pk_mul_f32 v[82:83], v[82:83], v[18:19] op_sel:[0,1] op_sel_hi:[1,1]
    v_cvt_pk_bf16_f32 v230, v116, v117
    v_cvt_pk_bf16_f32 v212, v80, v81
    v_cvt_pk_bf16_f32 v231, v118, v119
    v_cvt_pk_bf16_f32 v213, v82, v83
    buffer_load_dwordx4 v254, s[48:51], s91 offen offset:3072 lds
    v_pk_fma_f32 v[120:121], v[32:33], v[20:21], v[120:121] op_sel:[0,0,0] op_sel_hi:[1,0,1]
    v_pk_fma_f32 v[84:85], v[28:29], v[20:21], v[84:85] op_sel:[0,0,0] op_sel_hi:[1,0,1]
    v_pk_fma_f32 v[122:123], v[34:35], v[20:21], v[122:123] op_sel:[0,0,0] op_sel_hi:[1,0,1]
    v_pk_fma_f32 v[86:87], v[30:31], v[20:21], v[86:87] op_sel:[0,0,0] op_sel_hi:[1,0,1]
    v_pk_mul_f32 v[120:121], v[120:121], v[20:21] op_sel:[0,1] op_sel_hi:[1,1]
    v_pk_mul_f32 v[84:85], v[84:85], v[20:21] op_sel:[0,1] op_sel_hi:[1,1]
    v_pk_mul_f32 v[122:123], v[122:123], v[20:21] op_sel:[0,1] op_sel_hi:[1,1]
    v_pk_mul_f32 v[86:87], v[86:87], v[20:21] op_sel:[0,1] op_sel_hi:[1,1]
    v_cvt_pk_bf16_f32 v2, v120, v121
    v_cvt_pk_bf16_f32 v214, v84, v85
    v_cvt_pk_bf16_f32 v3, v122, v123
    v_cvt_pk_bf16_f32 v215, v86, v87
    s_add_u32 s91, s80, 262144
    s_add_u32 m0, s82, 81920
    v_pk_fma_f32 v[124:125], v[32:33], v[22:23], v[124:125] op_sel:[0,0,0] op_sel_hi:[1,0,1]
    buffer_load_dwordx4 v61, s[48:51], s91 offen offset:0 lds
    v_pk_fma_f32 v[88:89], v[28:29], v[22:23], v[88:89] op_sel:[0,0,0] op_sel_hi:[1,0,1]
    v_pk_fma_f32 v[126:127], v[34:35], v[22:23], v[126:127] op_sel:[0,0,0] op_sel_hi:[1,0,1]
    v_pk_fma_f32 v[90:91], v[30:31], v[22:23], v[90:91] op_sel:[0,0,0] op_sel_hi:[1,0,1]
    v_pk_mul_f32 v[124:125], v[124:125], v[22:23] op_sel:[0,1] op_sel_hi:[1,1]
    v_pk_mul_f32 v[88:89], v[88:89], v[22:23] op_sel:[0,1] op_sel_hi:[1,1]
    v_pk_mul_f32 v[126:127], v[126:127], v[22:23] op_sel:[0,1] op_sel_hi:[1,1]
    v_pk_mul_f32 v[90:91], v[90:91], v[22:23] op_sel:[0,1] op_sel_hi:[1,1]
    v_cvt_pk_bf16_f32 v4, v124, v125
    v_cvt_pk_bf16_f32 v216, v88, v89
    v_cvt_pk_bf16_f32 v5, v126, v127
    v_cvt_pk_bf16_f32 v217, v90, v91
    buffer_load_dwordx4 v62, s[48:51], s91 offen offset:1024 lds
    v_pk_fma_f32 v[128:129], v[32:33], v[24:25], v[128:129] op_sel:[0,0,0] op_sel_hi:[1,0,1]
    v_pk_fma_f32 v[92:93], v[28:29], v[24:25], v[92:93] op_sel:[0,0,0] op_sel_hi:[1,0,1]
    v_pk_fma_f32 v[130:131], v[34:35], v[24:25], v[130:131] op_sel:[0,0,0] op_sel_hi:[1,0,1]
    v_pk_fma_f32 v[94:95], v[30:31], v[24:25], v[94:95] op_sel:[0,0,0] op_sel_hi:[1,0,1]
    v_pk_mul_f32 v[128:129], v[128:129], v[24:25] op_sel:[0,1] op_sel_hi:[1,1]
    v_pk_mul_f32 v[92:93], v[92:93], v[24:25] op_sel:[0,1] op_sel_hi:[1,1]
    v_pk_mul_f32 v[130:131], v[130:131], v[24:25] op_sel:[0,1] op_sel_hi:[1,1]
    v_pk_mul_f32 v[94:95], v[94:95], v[24:25] op_sel:[0,1] op_sel_hi:[1,1]
    v_cvt_pk_bf16_f32 v6, v128, v129
    v_cvt_pk_bf16_f32 v218, v92, v93
    v_cvt_pk_bf16_f32 v7, v130, v131
    v_cvt_pk_bf16_f32 v219, v94, v95
    buffer_load_dwordx4 v252, s[48:51], s91 offen offset:2048 lds
    v_pk_fma_f32 v[132:133], v[32:33], v[26:27], v[132:133] op_sel:[0,0,0] op_sel_hi:[1,0,1]
    v_pk_fma_f32 v[96:97], v[28:29], v[26:27], v[96:97] op_sel:[0,0,0] op_sel_hi:[1,0,1]
    v_pk_fma_f32 v[134:135], v[34:35], v[26:27], v[134:135] op_sel:[0,0,0] op_sel_hi:[1,0,1]
    v_pk_fma_f32 v[98:99], v[30:31], v[26:27], v[98:99] op_sel:[0,0,0] op_sel_hi:[1,0,1]
    v_pk_mul_f32 v[132:133], v[132:133], v[26:27] op_sel:[0,1] op_sel_hi:[1,1]
    v_pk_mul_f32 v[96:97], v[96:97], v[26:27] op_sel:[0,1] op_sel_hi:[1,1]
    v_pk_mul_f32 v[134:135], v[134:135], v[26:27] op_sel:[0,1] op_sel_hi:[1,1]
    v_pk_mul_f32 v[98:99], v[98:99], v[26:27] op_sel:[0,1] op_sel_hi:[1,1]
    v_cvt_pk_bf16_f32 v8, v132, v133
    v_cvt_pk_bf16_f32 v220, v96, v97
    v_cvt_pk_bf16_f32 v9, v134, v135
    v_cvt_pk_bf16_f32 v221, v98, v99
    s_waitcnt lgkmcnt(2)
    s_nop 0
    v_pk_fma_f32 v[136:137], v[190:191], v[36:37], v[136:137] op_sel:[0,0,0] op_sel_hi:[1,0,1]
    v_pk_fma_f32 v[138:139], v[192:193], v[36:37], v[138:139] op_sel:[0,0,0] op_sel_hi:[1,0,1]
    v_pk_mul_f32 v[136:137], v[136:137], v[194:195]
    v_pk_mul_f32 v[138:139], v[138:139], v[196:197]
    ds_read_b128 v[190:193], v234 offset:128
    ds_read_b128 v[194:197], v234 offset:1152
    v_cvt_pk_bf16_f32 v38, v136, v137
    v_cvt_pk_bf16_f32 v39, v138, v139
    s_waitcnt lgkmcnt(2)
    s_nop 0
    v_pk_fma_f32 v[140:141], v[198:199], v[36:37], v[140:141] op_sel:[0,0,0] op_sel_hi:[1,0,1]
    v_pk_fma_f32 v[142:143], v[200:201], v[36:37], v[142:143] op_sel:[0,0,0] op_sel_hi:[1,0,1]
    v_pk_mul_f32 v[140:141], v[140:141], v[202:203]
    v_pk_mul_f32 v[142:143], v[142:143], v[204:205]
    ds_read_b128 v[198:201], v234 offset:192
    ds_read_b128 v[202:205], v234 offset:1216
    buffer_load_dwordx4 v254, s[48:51], s91 offen offset:3072 lds
    v_cvt_pk_bf16_f32 v40, v140, v141
    v_cvt_pk_bf16_f32 v41, v142, v143
    s_waitcnt lgkmcnt(2)
    s_nop 0
    v_pk_fma_f32 v[144:145], v[190:191], v[36:37], v[144:145] op_sel:[0,0,0] op_sel_hi:[1,0,1]
    v_pk_fma_f32 v[146:147], v[192:193], v[36:37], v[146:147] op_sel:[0,0,0] op_sel_hi:[1,0,1]
    v_pk_mul_f32 v[144:145], v[144:145], v[194:195]
    v_pk_mul_f32 v[146:147], v[146:147], v[196:197]
    ds_read_b128 v[190:193], v234 offset:256
    ds_read_b128 v[194:197], v234 offset:1280
    v_cvt_pk_bf16_f32 v50, v144, v145
    v_cvt_pk_bf16_f32 v51, v146, v147
    s_waitcnt lgkmcnt(2)
    s_nop 0
    v_pk_fma_f32 v[148:149], v[198:199], v[36:37], v[148:149] op_sel:[0,0,0] op_sel_hi:[1,0,1]
    v_pk_fma_f32 v[150:151], v[200:201], v[36:37], v[150:151] op_sel:[0,0,0] op_sel_hi:[1,0,1]
    v_pk_mul_f32 v[148:149], v[148:149], v[202:203]
    v_pk_mul_f32 v[150:151], v[150:151], v[204:205]
    ds_read_b128 v[198:201], v234 offset:320
    ds_read_b128 v[202:205], v234 offset:1344
    s_add_u32 s91, s80, 294912
    s_add_u32 m0, s82, 98304
    v_cvt_pk_bf16_f32 v42, v148, v149
    buffer_load_dwordx4 v61, s[48:51], s91 offen offset:0 lds
    v_cvt_pk_bf16_f32 v43, v150, v151
    s_waitcnt lgkmcnt(2)
    s_nop 0
    v_pk_fma_f32 v[152:153], v[190:191], v[36:37], v[152:153] op_sel:[0,0,0] op_sel_hi:[1,0,1]
    v_pk_fma_f32 v[154:155], v[192:193], v[36:37], v[154:155] op_sel:[0,0,0] op_sel_hi:[1,0,1]
    v_pk_mul_f32 v[152:153], v[152:153], v[194:195]
    v_pk_mul_f32 v[154:155], v[154:155], v[196:197]
    ds_read_b128 v[190:193], v234 offset:384
    ds_read_b128 v[194:197], v234 offset:1408
    v_cvt_pk_bf16_f32 v52, v152, v153
    v_cvt_pk_bf16_f32 v53, v154, v155
    s_waitcnt lgkmcnt(2)
    s_nop 0
    v_pk_fma_f32 v[156:157], v[198:199], v[36:37], v[156:157] op_sel:[0,0,0] op_sel_hi:[1,0,1]
    v_pk_fma_f32 v[158:159], v[200:201], v[36:37], v[158:159] op_sel:[0,0,0] op_sel_hi:[1,0,1]
    v_pk_mul_f32 v[156:157], v[156:157], v[202:203]
    v_pk_mul_f32 v[158:159], v[158:159], v[204:205]
    ds_read_b128 v[198:201], v234 offset:448
    ds_read_b128 v[202:205], v234 offset:1472
    buffer_load_dwordx4 v62, s[48:51], s91 offen offset:1024 lds
    v_cvt_pk_bf16_f32 v44, v156, v157
    v_cvt_pk_bf16_f32 v45, v158, v159
    s_waitcnt lgkmcnt(2)
    s_nop 0
    v_pk_fma_f32 v[160:161], v[190:191], v[36:37], v[160:161] op_sel:[0,0,0] op_sel_hi:[1,0,1]
    v_pk_fma_f32 v[162:163], v[192:193], v[36:37], v[162:163] op_sel:[0,0,0] op_sel_hi:[1,0,1]
    v_pk_mul_f32 v[160:161], v[160:161], v[194:195]
    v_pk_mul_f32 v[162:163], v[162:163], v[196:197]
    ds_read_b128 v[190:193], v234 offset:512
    ds_read_b128 v[194:197], v234 offset:1536
    v_cvt_pk_bf16_f32 v54, v160, v161
    v_cvt_pk_bf16_f32 v55, v162, v163
    s_waitcnt lgkmcnt(2)
    s_nop 0
    v_pk_fma_f32 v[164:165], v[198:199], v[36:37], v[164:165] op_sel:[0,0,0] op_sel_hi:[1,0,1]
    v_pk_fma_f32 v[166:167], v[200:201], v[36:37], v[166:167] op_sel:[0,0,0] op_sel_hi:[1,0,1]
    v_pk_mul_f32 v[164:165], v[164:165], v[202:203]
    v_pk_mul_f32 v[166:167], v[166:167], v[204:205]
    buffer_load_dwordx4 v252, s[48:51], s91 offen offset:2048 lds
    v_cvt_pk_bf16_f32 v46, v164, v165
    v_cvt_pk_bf16_f32 v47, v166, v167
    s_waitcnt lgkmcnt(0)
    s_nop 0
    v_pk_fma_f32 v[168:169], v[190:191], v[36:37], v[168:169] op_sel:[0,0,0] op_sel_hi:[1,0,1]
    v_pk_fma_f32 v[170:171], v[192:193], v[36:37], v[170:171] op_sel:[0,0,0] op_sel_hi:[1,0,1]
    v_pk_mul_f32 v[168:169], v[168:169], v[194:195]
    v_pk_mul_f32 v[170:171], v[170:171], v[196:197]
    v_cvt_pk_bf16_f32 v56, v168, v169
    v_cvt_pk_bf16_f32 v57, v170, v171
    s_barrier
    v_mov_b32 v48, v38
    v_mov_b32_e64 v49, v39
    v_mov_b32 v160, 0x3f803f80
    v_mov_b32 v161, 0x3f803f80
    v_mov_b32 v162, 0x3f803f80
    v_mov_b32 v163, 0x3f803f80
    s_nop 0
    s_nop 0
    v_mfma_f32_16x16x16_bf16 v[64:67], v[224:225], v[206:207], v[172:175]
    v_mfma_f32_16x16x16_bf16 v[80:83], v[222:223], v[206:207], v[180:183]
    v_mfma_f32_16x16x16_bf16 v[68:71], v[226:227], v[208:209], v[172:175]
    v_mfma_f32_16x16x16_bf16 v[84:87], v[222:223], v[208:209], v[184:187]
    v_mfma_f32_16x16x16_bf16 v[72:75], v[228:229], v[210:211], v[172:175]
    v_mfma_f32_16x16x16_bf16 v[88:91], v[224:225], v[210:211], v[176:179]
    v_mfma_f32_16x16x16_bf16 v[76:79], v[230:231], v[212:213], v[172:175]
    v_mfma_f32_16x16x16_bf16 v[92:95], v[226:227], v[212:213], v[176:179]
    v_mfma_f32_16x16x16_bf16 v[112:115], v[2:3], v[214:215], v[172:175]
    v_mfma_f32_16x16x16_bf16 v[128:131], v[228:229], v[214:215], v[176:179]
    v_mfma_f32_16x16x16_bf16 v[116:119], v[4:5], v[216:217], v[172:175]
    v_mfma_f32_16x16x16_bf16 v[132:135], v[230:231], v[216:217], v[176:179]
    v_mfma_f32_16x16x16_bf16 v[120:123], v[6:7], v[218:219], v[172:175]
    v_mfma_f32_16x16x16_bf16 v[136:139], v[2:3], v[218:219], v[176:179]
    v_mfma_f32_16x16x16_bf16 v[124:127], v[8:9], v[220:221], v[172:175]
    v_mfma_f32_16x16x16_bf16 v[140:143], v[4:5], v[220:221], v[176:179]
    v_max_f32 v64, v64, v80
    v_max_f32 v65, v65, v81
    v_max_f32 v66, v66, v82
    v_max_f32 v67, v67, v83
    v_max_f32 v68, v68, v84
    v_max_f32 v69, v69, v85
    v_max_f32 v70, v70, v86
    v_max_f32 v71, v71, v87
    v_max_f32 v72, v72, v88
    v_max_f32 v73, v73, v89
    v_max_f32 v74, v74, v90
    v_max_f32 v75, v75, v91
    v_max_f32 v76, v76, v92
    v_max_f32 v77, v77, v93
    v_max_f32 v78, v78, v94
    v_max_f32 v79, v79, v95
    v_max3_f32 v96, v64, v65, v66
    v_max3_f32 v97, v68, v69, v70
    v_max3_f32 v98, v72, v73, v74
    v_max3_f32 v99, v76, v77, v78
    v_max_f32 v96, v96, v67
    v_max_f32 v97, v97, v71
    v_max_f32 v98, v98, v75
    v_max_f32 v99, v99, v79
    buffer_load_dwordx4 v254, s[48:51], s91 offen offset:3072 lds
    v_max_f32 v112, v112, v128
    v_max_f32 v113, v113, v129
    v_max_f32 v114, v114, v130
    v_max_f32 v115, v115, v131
    v_max_f32 v116, v116, v132
    v_max_f32 v117, v117, v133
    v_max_f32 v118, v118, v134
    v_max_f32 v119, v119, v135
    v_max_f32 v120, v120, v136
    v_max_f32 v121, v121, v137
    v_max_f32 v122, v122, v138
    v_max_f32 v123, v123, v139
    v_max_f32 v124, v124, v140
    v_max_f32 v125, v125, v141
    v_max_f32 v126, v126, v142
    v_max_f32 v127, v127, v143
    v_max3_f32 v144, v112, v113, v114
    v_max3_f32 v145, v116, v117, v118
    v_max3_f32 v146, v120, v121, v122
    v_max3_f32 v147, v124, v125, v126
    v_max_f32 v144, v144, v115
    v_max_f32 v145, v145, v119
    v_max_f32 v146, v146, v123
    v_max_f32 v147, v147, v127
    s_mov_b32 s77, 0xbeb8aa3b
    s_nop 0
    v_permlane32_swap_b32 v96, v97
    v_permlane32_swap_b32 v144, v145
    v_permlane32_swap_b32 v98, v99
    v_permlane32_swap_b32 v146, v147
    v_max_f32 v96, v96, v97
    v_max_f32 v144, v144, v145
    v_max_f32 v98, v98, v99
    v_max_f32 v146, v146, v147
    s_nop 0
    s_nop 0
    v_permlane16_swap_b32 v96, v98
    v_permlane16_swap_b32 v144, v146
    v_max_f32 v96, v96, v98
    v_max_f32 v144, v144, v146
    v_mul_f32 v96, s77, v96
    v_mul_f32 v144, s77, v144
    v_mov_b32 v98, v96
    v_mov_b32 v146, v144
    s_nop 0
    s_nop 0
    v_permlane16_swap_b32 v96, v98
    v_permlane16_swap_b32 v144, v146
    v_mov_b32 v97, v96
    v_mov_b32 v145, v144
    v_mov_b32 v99, v98
    v_mov_b32_e64 v147, v146
    s_nop 0
    s_nop 0
    v_permlane32_swap_b32 v96, v97
    v_permlane32_swap_b32 v144, v145
    v_permlane32_swap_b32 v98, v99
    v_permlane32_swap_b32 v146, v147
    s_xor_b32 s74, s60, 1
    s_lshl_b32 s74, s74, 12
    s_add_u32 s74, s74, 147456
    v_lshlrev_b32_e64 v26, 3, v1
    v_add_u32 v27, s74, v26
    s_lshl_b32 s74, s60, 12
    s_add_u32 s74, s74, 147456
    v_add_u32_e64 v26, s74, v26
    v_fma_f32 v64, v64, s78, v96
    v_fma_f32 v65, v65, s78, v96
    v_fma_f32 v66, v66, s78, v96
    v_fma_f32 v67, v67, s78, v96
    v_fma_f32 v68, v68, s78, v97
    v_fma_f32 v69, v69, s78, v97
    v_fma_f32 v70, v70, s78, v97
    v_fma_f32 v71, v71, s78, v97
    v_fma_f32 v72, v72, s78, v98
    v_fma_f32 v73, v73, s78, v98
    v_fma_f32 v74, v74, s78, v98
    v_fma_f32 v75, v75, s78, v98
    v_fma_f32 v76, v76, s78, v99
    v_fma_f32 v77, v77, s78, v99
    v_fma_f32 v78, v78, s78, v99
    v_fma_f32 v79, v79, s78, v99
    s_add_u32 s91, s80, 327680
    s_add_u32 m0, s82, 114688
    v_exp_f32_e64 v64, v64
    buffer_load_dwordx4 v61, s[48:51], s91 offen offset:0 lds
    v_exp_f32 v65, v65
    v_exp_f32 v66, v66
    v_exp_f32 v67, v67
    v_exp_f32 v68, v68
    v_exp_f32 v69, v69
    v_exp_f32 v70, v70
    v_exp_f32 v71, v71
    v_exp_f32 v72, v72
    v_exp_f32 v73, v73
    v_exp_f32 v74, v74
    v_exp_f32 v75, v75
    v_exp_f32 v76, v76
    v_exp_f32 v77, v77
    v_exp_f32 v78, v78
    v_exp_f32_e64 v79, v79
    buffer_load_dwordx4 v62, s[48:51], s91 offen offset:1024 lds
    s_nop 0
    s_nop 0
    v_cvt_pk_bf16_f32 v64, v64, v65
    v_cvt_pk_bf16_f32 v65, v66, v67
    v_cvt_pk_bf16_f32 v68, v68, v69
    v_cvt_pk_bf16_f32 v69, v70, v71
    v_cvt_pk_bf16_f32 v72, v72, v73
    v_cvt_pk_bf16_f32 v73, v74, v75
    v_cvt_pk_bf16_f32 v76, v76, v77
    v_cvt_pk_bf16_f32 v77, v78, v79
    v_bfi_b32 v80, v188, 0, v64
    v_and_b32_e64 v82, v188, v64
    v_bfi_b32 v81, v189, 0, v65
    v_and_b32_e64 v83, v189, v65
    v_bfi_b32 v84, v188, 0, v68
    v_and_b32_e64 v86, v188, v68
    v_bfi_b32 v85, v189, 0, v69
    v_and_b32_e64 v87, v189, v69
    v_bfi_b32 v88, v188, 0, v72
    v_and_b32_e64 v90, v188, v72
    v_bfi_b32 v89, v189, 0, v73
    v_and_b32_e64 v91, v189, v73
    v_bfi_b32 v92, v188, 0, v76
    v_and_b32_e64 v94, v188, v76
    v_bfi_b32 v93, v189, 0, v77
    v_and_b32 v95, v189, v77
    s_nop 1
    v_mfma_f32_16x16x32_bf16 v[190:193], v[160:163], v[80:83], 0
    v_mfma_f32_16x16x32_bf16 v[64:67], v[38:41], v[80:83], 0
    v_mfma_f32_16x16x32_bf16 v[194:197], v[160:163], v[84:87], 0
    v_mfma_f32_16x16x32_bf16 v[68:71], v[48:51], v[84:87], 0
    v_mfma_f32_16x16x32_bf16 v[198:201], v[160:163], v[88:91], 0
    v_mfma_f32_16x16x32_bf16 v[72:75], v[40:43], v[88:91], 0
    v_mfma_f32_16x16x32_bf16 v[202:205], v[160:163], v[92:95], 0
    v_mfma_f32_16x16x32_bf16 v[76:79], v[50:53], v[92:95], 0
    v_fma_f32 v112, v112, s78, v144
    v_fma_f32 v113, v113, s78, v144
    v_fma_f32 v114, v114, s78, v144
    v_fma_f32 v115, v115, s78, v144
    v_fma_f32 v116, v116, s78, v145
    v_fma_f32 v117, v117, s78, v145
    v_fma_f32 v118, v118, s78, v145
    v_fma_f32 v119, v119, s78, v145
    v_fma_f32 v120, v120, s78, v146
    v_fma_f32 v121, v121, s78, v146
    v_fma_f32 v122, v122, s78, v146
    v_fma_f32 v123, v123, s78, v146
    v_fma_f32 v124, v124, s78, v147
    v_fma_f32 v125, v125, s78, v147
    v_fma_f32 v126, v126, s78, v147
    v_fma_f32 v127, v127, s78, v147
    buffer_load_dwordx4 v252, s[48:51], s91 offen offset:2048 lds
    v_exp_f32 v112, v112
    v_exp_f32 v113, v113
    v_exp_f32 v114, v114
    v_exp_f32 v115, v115
    v_exp_f32 v116, v116
    v_exp_f32 v117, v117
    v_exp_f32 v118, v118
    v_exp_f32 v119, v119
    v_exp_f32 v120, v120
    v_exp_f32 v121, v121
    v_exp_f32 v122, v122
    v_exp_f32 v123, v123
    v_exp_f32 v124, v124
    v_exp_f32 v125, v125
    v_exp_f32 v126, v126
    v_exp_f32 v127, v127
    buffer_load_dwordx4 v254, s[48:51], s91 offen offset:3072 lds
    s_nop 0
    s_nop 0
    v_cvt_pk_bf16_f32 v112, v112, v113
    v_cvt_pk_bf16_f32 v113, v114, v115
    v_cvt_pk_bf16_f32 v116, v116, v117
    v_cvt_pk_bf16_f32 v117, v118, v119
    v_cvt_pk_bf16_f32 v120, v120, v121
    v_cvt_pk_bf16_f32 v121, v122, v123
    v_cvt_pk_bf16_f32 v124, v124, v125
    v_cvt_pk_bf16_f32 v125, v126, v127
    v_bfi_b32 v128, v188, 0, v112
    v_and_b32_e64 v130, v188, v112
    v_bfi_b32 v129, v189, 0, v113
    v_and_b32_e64 v131, v189, v113
    v_bfi_b32 v132, v188, 0, v116
    v_and_b32_e64 v134, v188, v116
    v_bfi_b32 v133, v189, 0, v117
    v_and_b32_e64 v135, v189, v117
    v_bfi_b32 v136, v188, 0, v120
    v_and_b32_e64 v138, v188, v120
    v_bfi_b32 v137, v189, 0, v121
    v_and_b32_e64 v139, v189, v121
    v_bfi_b32 v140, v188, 0, v124
    v_and_b32_e64 v142, v188, v124
    v_bfi_b32 v141, v189, 0, v125
    v_and_b32 v143, v189, v125
    s_nop 1
    v_mfma_f32_16x16x32_bf16 v[10:13], v[160:163], v[128:131], 0
    v_mfma_f32_16x16x32_bf16 v[112:115], v[42:45], v[128:131], 0
    v_mfma_f32_16x16x32_bf16 v[14:17], v[160:163], v[132:135], 0
    v_mfma_f32_16x16x32_bf16 v[116:119], v[52:55], v[132:135], 0
    v_mfma_f32_16x16x32_bf16 v[18:21], v[160:163], v[136:139], 0
    v_mfma_f32_16x16x32_bf16 v[120:123], v[44:47], v[136:139], 0
    v_mfma_f32_16x16x32_bf16 v[22:25], v[160:163], v[140:143], 0
    v_mfma_f32_16x16x32_bf16 v[124:127], v[54:57], v[140:143], 0
    v_rcp_f32 v190, v190
    v_rcp_f32 v194, v194
    v_rcp_f32_e64 v198, v198
    v_rcp_f32 v202, v202
    s_nop 0
    v_pk_mul_f32 v[64:65], v[64:65], v[190:191] op_sel:[0,0] op_sel_hi:[1,0]
    v_pk_mul_f32 v[66:67], v[66:67], v[190:191] op_sel:[0,0] op_sel_hi:[1,0]
    v_pk_mul_f32 v[68:69], v[68:69], v[194:195] op_sel:[0,0] op_sel_hi:[1,0]
    v_pk_mul_f32 v[70:71], v[70:71], v[194:195] op_sel:[0,0] op_sel_hi:[1,0]
    v_pk_mul_f32 v[72:73], v[72:73], v[198:199] op_sel:[0,0] op_sel_hi:[1,0]
    v_pk_mul_f32 v[74:75], v[74:75], v[198:199] op_sel:[0,0] op_sel_hi:[1,0]
    v_pk_mul_f32 v[76:77], v[76:77], v[202:203] op_sel:[0,0] op_sel_hi:[1,0]
    v_pk_mul_f32 v[78:79], v[78:79], v[202:203] op_sel:[0,0] op_sel_hi:[1,0]
    v_cvt_pk_bf16_f32 v100, v64, v65
    v_cvt_pk_bf16_f32 v101, v66, v67
    v_cvt_pk_bf16_f32 v102, v68, v69
    v_cvt_pk_bf16_f32 v103, v70, v71
    v_cvt_pk_bf16_f32 v104, v72, v73
    v_cvt_pk_bf16_f32 v105, v74, v75
    v_cvt_pk_bf16_f32 v106, v76, v77
    v_cvt_pk_bf16_f32 v107, v78, v79
    v_rcp_f32 v10, v10
    v_rcp_f32 v14, v14
    v_rcp_f32_e64 v18, v18
    v_rcp_f32 v22, v22
    s_nop 0
    v_pk_mul_f32 v[112:113], v[112:113], v[10:11] op_sel:[0,0] op_sel_hi:[1,0]
    v_pk_mul_f32 v[114:115], v[114:115], v[10:11] op_sel:[0,0] op_sel_hi:[1,0]
    v_pk_mul_f32 v[116:117], v[116:117], v[14:15] op_sel:[0,0] op_sel_hi:[1,0]
    v_pk_mul_f32 v[118:119], v[118:119], v[14:15] op_sel:[0,0] op_sel_hi:[1,0]
    v_pk_mul_f32 v[120:121], v[120:121], v[18:19] op_sel:[0,0] op_sel_hi:[1,0]
    v_pk_mul_f32 v[122:123], v[122:123], v[18:19] op_sel:[0,0] op_sel_hi:[1,0]
    v_pk_mul_f32 v[124:125], v[124:125], v[22:23] op_sel:[0,0] op_sel_hi:[1,0]
    v_pk_mul_f32 v[126:127], v[126:127], v[22:23] op_sel:[0,0] op_sel_hi:[1,0]
    v_cvt_pk_bf16_f32 v148, v112, v113
    v_cvt_pk_bf16_f32 v149, v114, v115
    v_cvt_pk_bf16_f32 v150, v116, v117
    v_cvt_pk_bf16_f32 v151, v118, v119
    v_cvt_pk_bf16_f32 v152, v120, v121
    v_cvt_pk_bf16_f32 v153, v122, v123
    v_cvt_pk_bf16_f32 v154, v124, v125
    v_cvt_pk_bf16_f32 v155, v126, v127
    s_cmp_eq_u32 s69, 0
    s_cbranch_scc0 EX_5
    ds_write_b64 v27, v[102:103] offset:0
    ds_write_b64 v27, v[106:107] offset:512
    ds_write_b64 v27, v[150:151] offset:1024
    ds_write_b64 v27, v[154:155] offset:1536
    s_waitcnt lgkmcnt(0)
    s_barrier
    ds_read_b64 v[102:103], v26 offset:0
    ds_read_b64 v[106:107], v26 offset:512
    ds_read_b64 v[150:151], v26 offset:1024
    ds_read_b64 v[154:155], v26 offset:1536
    s_branch EX_5_e
EX_5:
    s_nop 0
    ds_write_b64 v27, v[100:101] offset:0
    ds_write_b64 v27, v[104:105] offset:512
    ds_write_b64 v27, v[148:149] offset:1024
    ds_write_b64 v27, v[152:153] offset:1536
    s_waitcnt lgkmcnt(0)
    s_barrier
    ds_read_b64 v[100:101], v26 offset:0
    ds_read_b64 v[104:105], v26 offset:512
    ds_read_b64 v[148:149], v26 offset:1024
    ds_read_b64 v[152:153], v26 offset:1536
EX_5_e:
    s_add_u32 s90, s10, 294912
    s_waitcnt lgkmcnt(0)
    s_nop 0
    buffer_store_dwordx4 v[100:103], v63, s[36:39], s10 offen offset:0 sc1
    buffer_store_dwordx4 v[104:107], v63, s[36:39], s10 offen offset:2048 sc1
    buffer_store_dwordx4 v[148:151], v63, s[36:39], s90 offen offset:0 sc1
    buffer_store_dwordx4 v[152:155], v63, s[36:39], s90 offen offset:2048 sc1
    v_mov_b32 v2, s66
    v_mov_b32 v3, s67
    s_add_u32 s91, s80, 360448
    s_add_u32 m0, s82, 131072
    v_accvgpr_read_b32 v42, a104
    buffer_load_dwordx4 v61, s[48:51], s91 offen offset:0 lds
    v_accvgpr_read_b32 v43, a105
    v_accvgpr_read_b32 v44, a106
    v_accvgpr_read_b32 v45, a107
    v_accvgpr_read_b32 v46, a108
    v_accvgpr_read_b32 v47, a109
    v_accvgpr_read_b32 v48, a110
    v_accvgpr_read_b32 v49, a111
    v_accvgpr_read_b32 v50, a96
    v_accvgpr_read_b32 v51, a97
    v_accvgpr_read_b32 v52, a98
    v_accvgpr_read_b32 v53, a99
    buffer_load_dwordx4 v62, s[48:51], s91 offen offset:1024 lds
    v_accvgpr_read_b32 v54, a100
    v_accvgpr_read_b32 v55, a101
    v_accvgpr_read_b32 v56, a102
    v_accvgpr_read_b32 v57, a103
    v_mov_b32_e64 v58, v239
    s_lshr_b32 s74, s64, 1
    s_lshl_b32 s74, s74, 13
    s_add_u32 s74, s74, 9568256
    v_lshlrev_b32_e64 v4, 7, v1
    v_add_u32 v4, s74, v4
    s_and_b32 s74, s64, 1
    s_lshl_b32 s74, s74, 1
    s_lshl_b32 s75, s60, 3
    buffer_load_dwordx4 v252, s[48:51], s91 offen offset:2048 lds
    s_add_u32 s74, s74, s75
    s_lshl_b32 s85, 0x33, s74
    s_mov_b32 s84, 0
    s_nop 0
    s_lshl_b32 s88, 0x55555555, s69
    s_mov_b32 s89, 0
    s_nop 0
    v_mov_b32 v5, 2146435072
    v_cndmask_b32 v59, v5, v4, s[84:85]
    v_cndmask_b32 v60, v5, v4, s[88:89]
    s_mul_i32 s10, s64, 294912
    s_mul_i32 s74, s60, 57344
    s_add_u32 s86, s10, s74
    s_lshl_b32 s74, s60, 10
    s_add_u32 s10, s10, s74
    s_nop 0
    buffer_load_dwordx4 v254, s[48:51], s91 offen offset:3072 lds
    s_add_u32 s10, s10, 229376
    v_subrev_u32_e64 v224, s82, v240
    v_add_u32 v228, 0x10000, v224
    v_add_u32 v232, 0x20000, v224
    v_subrev_u32_e64 v225, s82, v241
    v_add_u32 v229, 0x10000, v225
    v_add_u32 v233, 0x20000, v225
    v_subrev_u32_e64 v226, s82, v242
    v_add_u32 v230, 0x10000, v226
    v_add_u32 v234, 0x20000, v226
    v_subrev_u32_e64 v227, s82, v243
    v_add_u32 v231, 0x10000, v227
    v_add_u32 v235, 0x20000, v227
    s_waitcnt vmcnt(4)
    s_nop 0
    buffer_store_dwordx2 v[2:3], v238, s[36:39], 0 offen sc1
    s_waitcnt vmcnt(33)
    s_nop 0
    ds_read_b64_tr_b16 a[176:177], v240 offset:0
    ds_read_b64_tr_b16 a[178:179], v240 offset:2048
    ds_read_b64_tr_b16 a[180:181], v241 offset:0
    ds_read_b64_tr_b16 a[182:183], v241 offset:2048
    ds_read_b64_tr_b16 a[184:185], v242 offset:0
    ds_read_b64_tr_b16 a[186:187], v242 offset:2048
    ds_read_b64_tr_b16 a[188:189], v243 offset:0
    ds_read_b64_tr_b16 a[190:191], v243 offset:2048
    ds_read_b64_tr_b16 a[192:193], v240 offset:16384
    ds_read_b64_tr_b16 a[194:195], v240 offset:18432
    ds_read_b64_tr_b16 a[196:197], v241 offset:16384
    ds_read_b64_tr_b16 a[198:199], v241 offset:18432
    ds_read_b64_tr_b16 a[200:201], v242 offset:16384
    ds_read_b64_tr_b16 a[202:203], v242 offset:18432
    ds_read_b64_tr_b16 a[204:205], v243 offset:16384
    ds_read_b64_tr_b16 a[206:207], v243 offset:18432
    s_waitcnt lgkmcnt(0)
    s_nop 0
    s_add_u32 s91, s80, 393216
    s_add_u32 m0, s82, 0
    s_nop 0
    buffer_load_dwordx4 v61, s[48:51], s91 offen offset:0 lds
    buffer_load_dwordx4 v62, s[48:51], s91 offen offset:1024 lds
    buffer_load_dwordx4 v252, s[48:51], s91 offen offset:2048 lds
    buffer_load_dwordx4 v254, s[48:51], s91 offen offset:3072 lds
    s_add_u32 s91, s80, 425984
    s_add_u32 m0, s82, 16384
    s_nop 0
    s_nop 0
    buffer_load_dwordx4 v61, s[48:51], s91 offen offset:0 lds
    buffer_load_dwordx4 v62, s[48:51], s91 offen offset:1024 lds
    buffer_load_dwordx4 v252, s[48:51], s91 offen offset:2048 lds
    buffer_load_dwordx4 v254, s[48:51], s91 offen offset:3072 lds
    s_waitcnt vmcnt(29)
    s_nop 0
    ds_read_b64_tr_b16 a[208:209], v240 offset:32768
    ds_read_b64_tr_b16 a[210:211], v240 offset:34816
    ds_read_b64_tr_b16 a[212:213], v241 offset:32768
    ds_read_b64_tr_b16 a[214:215], v241 offset:34816
    ds_read_b64_tr_b16 a[216:217], v242 offset:32768
    ds_read_b64_tr_b16 a[218:219], v242 offset:34816
    ds_read_b64_tr_b16 a[220:221], v243 offset:32768
    ds_read_b64_tr_b16 a[222:223], v243 offset:34816
    ds_read_b64_tr_b16 a[224:225], v240 offset:49152
    ds_read_b64_tr_b16 a[226:227], v240 offset:51200
    ds_read_b64_tr_b16 a[228:229], v241 offset:49152
    ds_read_b64_tr_b16 a[230:231], v241 offset:51200
    ds_read_b64_tr_b16 a[232:233], v242 offset:49152
    ds_read_b64_tr_b16 a[234:235], v242 offset:51200
    ds_read_b64_tr_b16 a[236:237], v243 offset:49152
    ds_read_b64_tr_b16 a[238:239], v243 offset:51200
    ds_read_b64_tr_b16 a[240:241], v244 offset:0
    ds_read_b64_tr_b16 a[242:243], v244 offset:2048
    ds_read_b64_tr_b16 a[244:245], v245 offset:0
    ds_read_b64_tr_b16 a[246:247], v245 offset:2048
    ds_read_b64_tr_b16 a[248:249], v246 offset:0
    ds_read_b64_tr_b16 a[250:251], v246 offset:2048
    ds_read_b64_tr_b16 a[252:253], v247 offset:0
    ds_read_b64_tr_b16 a[254:255], v247 offset:2048
    s_waitcnt lgkmcnt(0)
    s_nop 0
    s_add_u32 s91, s81, 458752
    s_add_u32 m0, s82, 32768
    s_nop 0
    s_nop 0
    buffer_load_dwordx4 v61, s[52:55], s91 offen offset:0 lds
    buffer_load_dwordx4 v62, s[52:55], s91 offen offset:1024 lds
    buffer_load_dwordx4 v252, s[52:55], s91 offen offset:2048 lds
    buffer_load_dwordx4 v254, s[52:55], s91 offen offset:3072 lds
    s_add_u32 s91, s81, 491520
    s_add_u32 m0, s82, 49152
    s_nop 0
    s_nop 0
    buffer_load_dwordx4 v61, s[52:55], s91 offen offset:0 lds
    buffer_load_dwordx4 v62, s[52:55], s91 offen offset:1024 lds
    buffer_load_dwordx4 v252, s[52:55], s91 offen offset:2048 lds
    buffer_load_dwordx4 v254, s[52:55], s91 offen offset:3072 lds
    s_add_u32 s91, s81, 524288
    s_add_u32 m0, s82, 65536
    s_nop 0
    s_nop 0
    buffer_load_dwordx4 v61, s[52:55], s91 offen offset:0 lds
    buffer_load_dwordx4 v62, s[52:55], s91 offen offset:1024 lds
L_P2:
    buffer_load_dwordx2 v[6:7], v59, s[36:39], 0 offen sc1
    buffer_load_dwordx4 v252, s[52:55], s91 offen offset:2048 lds
    buffer_load_dwordx4 v254, s[52:55], s91 offen offset:3072 lds
    s_add_u32 s91, s81, 557056
    s_add_u32 m0, s82, 147456
    s_nop 0
    s_nop 0
    buffer_load_dwordx4 v61, s[52:55], s91 offen offset:0 lds
    buffer_load_dwordx4 v62, s[52:55], s91 offen offset:1024 lds
    buffer_load_dwordx4 v252, s[52:55], s91 offen offset:2048 lds
    buffer_load_dwordx4 v254, s[52:55], s91 offen offset:3072 lds
    s_xor_b32 s74, s60, 0
    s_lshl_b32 s74, s74, 10
    v_add_u32 v236, s74, v63
    s_xor_b32 s74, s60, 1
    s_lshl_b32 s74, s74, 10
    v_add_u32 v237, s74, v63
    s_xor_b32 s74, s60, 2
    s_lshl_b32 s74, s74, 10
    v_add_u32_e64 v238, s74, v63
    s_xor_b32 s74, s60, 3
    s_lshl_b32 s74, s74, 10
    v_add_u32 v239, s74, v63
    s_waitcnt vmcnt(6)
SP2_6:
    v_cmp_ne_u64 vcc, s[66:67], v[6:7]
    s_and_b64 vcc, vcc, s[84:85]
    s_cbranch_vccz SP2_6_ok
    s_sleep 1
    buffer_load_dwordx2 v[6:7], v59, s[36:39], 0 offen sc1
    s_waitcnt vmcnt(0)
    s_branch SP2_6
SP2_6_ok:
    s_add_u32 s90, s86, 0
    s_nop 0
    buffer_load_dwordx4 v[64:67], v236, s[36:39], s90 offen sc1
    buffer_load_dwordx4 v[68:71], v237, s[36:39], s90 offen sc1
    buffer_load_dwordx4 v[72:75], v238, s[36:39], s90 offen sc1
    buffer_load_dwordx4 v[76:79], v239, s[36:39], s90 offen sc1
    s_add_u32 s90, s86, 4096
    buffer_load_dwordx4 v[80:83], v236, s[36:39], s90 offen sc1
    buffer_load_dwordx4 v[84:87], v237, s[36:39], s90 offen sc1
    buffer_load_dwordx4 v[88:91], v238, s[36:39], s90 offen sc1
    buffer_load_dwordx4 v[92:95], v239, s[36:39], s90 offen sc1
    s_add_u32 s90, s86, 8192
    buffer_load_dwordx4 v[96:99], v236, s[36:39], s90 offen sc1
    buffer_load_dwordx4 v[100:103], v237, s[36:39], s90 offen sc1
    buffer_load_dwordx4 v[104:107], v238, s[36:39], s90 offen sc1
    buffer_load_dwordx4 v[108:111], v239, s[36:39], s90 offen sc1
    s_waitcnt vmcnt(8)
    s_nop 0
    v_mfma_f32_16x16x32_bf16 a[0:3], a[128:131], v[64:67], 0
    v_mfma_f32_16x16x32_bf16 a[4:7], a[132:135], v[64:67], 0
    v_lshlrev_b32_e64 v160, 16, v50
    s_add_u32 s90, s86, 12288
    v_mfma_f32_16x16x32_bf16 a[8:11], a[136:139], v[64:67], 0
    v_mfma_f32_16x16x32_bf16 a[12:15], a[140:143], v[64:67], 0
    v_and_b32 v161, 0xffff0000, v50
    v_mfma_f32_16x16x32_bf16 a[16:19], a[128:131], v[68:71], 0
    buffer_load_dwordx4 v[112:115], v236, s[36:39], s90 offen sc1
    v_mfma_f32_16x16x32_bf16 a[20:23], a[132:135], v[68:71], 0
    v_lshlrev_b32_e64 v176, 16, v42
    v_mfma_f32_16x16x32_bf16 a[24:27], a[136:139], v[68:71], 0
    v_mfma_f32_16x16x32_bf16 a[28:31], a[140:143], v[68:71], 0
    v_and_b32 v177, 0xffff0000, v42
    buffer_load_dwordx4 v[116:119], v237, s[36:39], s90 offen sc1
    v_mfma_f32_16x16x32_bf16 a[32:35], a[128:131], v[72:75], 0
    v_mfma_f32_16x16x32_bf16 a[36:39], a[132:135], v[72:75], 0
    v_lshlrev_b32_e64 v162, 16, v51
    v_mfma_f32_16x16x32_bf16 a[40:43], a[136:139], v[72:75], 0
    buffer_load_dwordx4 v[120:123], v238, s[36:39], s90 offen sc1
    v_mfma_f32_16x16x32_bf16 a[44:47], a[140:143], v[72:75], 0
    v_and_b32 v163, 0xffff0000, v51
    v_mfma_f32_16x16x32_bf16 a[48:51], a[128:131], v[76:79], 0
    v_mfma_f32_16x16x32_bf16 a[52:55], a[132:135], v[76:79], 0
    v_lshlrev_b32_e64 v178, 16, v43
    buffer_load_dwordx4 v[124:127], v239, s[36:39], s90 offen sc1
    v_mfma_f32_16x16x32_bf16 a[56:59], a[136:139], v[76:79], 0
    v_mfma_f32_16x16x32_bf16 a[60:63], a[140:143], v[76:79], 0
    v_and_b32 v179, 0xffff0000, v43
    s_waitcnt vmcnt(8)
    s_barrier
    v_mfma_f32_16x16x32_bf16 a[0:3], a[144:147], v[80:83], a[0:3]
    ds_read_b64_tr_b16 a[64:65], v224 offset:40960
    v_mfma_f32_16x16x32_bf16 a[4:7], a[148:151], v[80:83], a[4:7]
    v_lshlrev_b32_e64 v164, 16, v52
    s_add_u32 s90, s86, 16384
    v_mfma_f32_16x16x32_bf16 a[8:11], a[152:155], v[80:83], a[8:11]
    ds_read_b64_tr_b16 a[66:67], v224 offset:43008
    v_mfma_f32_16x16x32_bf16 a[12:15], a[156:159], v[80:83], a[12:15]
    v_and_b32 v165, 0xffff0000, v52
    v_mfma_f32_16x16x32_bf16 a[16:19], a[144:147], v[84:87], a[16:19]
    ds_read_b64_tr_b16 a[68:69], v225 offset:40960
    buffer_load_dwordx4 v[64:67], v236, s[36:39], s90 offen sc1
    v_mfma_f32_16x16x32_bf16 a[20:23], a[148:151], v[84:87], a[20:23]
    v_lshlrev_b32_e64 v180, 16, v44
    ds_read_b64_tr_b16 a[70:71], v225 offset:43008
    v_mfma_f32_16x16x32_bf16 a[24:27], a[152:155], v[84:87], a[24:27]
    v_mfma_f32_16x16x32_bf16 a[28:31], a[156:159], v[84:87], a[28:31]
    v_and_b32 v181, 0xffff0000, v44
    ds_read_b64_tr_b16 a[72:73], v226 offset:40960
    buffer_load_dwordx4 v[68:71], v237, s[36:39], s90 offen sc1
    v_mfma_f32_16x16x32_bf16 a[32:35], a[144:147], v[88:91], a[32:35]
    ds_read_b64_tr_b16 a[74:75], v226 offset:43008
    v_mfma_f32_16x16x32_bf16 a[36:39], a[148:151], v[88:91], a[36:39]
    v_lshlrev_b32_e64 v166, 16, v53
    v_mfma_f32_16x16x32_bf16 a[40:43], a[152:155], v[88:91], a[40:43]
    ds_read_b64_tr_b16 a[76:77], v227 offset:40960
    buffer_load_dwordx4 v[72:75], v238, s[36:39], s90 offen sc1
    v_mfma_f32_16x16x32_bf16 a[44:47], a[156:159], v[88:91], a[44:47]
    v_and_b32 v167, 0xffff0000, v53
    v_mfma_f32_16x16x32_bf16 a[48:51], a[144:147], v[92:95], a[48:51]
    ds_read_b64_tr_b16 a[78:79], v227 offset:43008
    v_mfma_f32_16x16x32_bf16 a[52:55], a[148:151], v[92:95], a[52:55]
    v_lshlrev_b32_e64 v182, 16, v45
    ds_read_b64_tr_b16 a[80:81], v224 offset:57344
    buffer_load_dwordx4 v[76:79], v239, s[36:39], s90 offen sc1
    v_mfma_f32_16x16x32_bf16 a[56:59], a[152:155], v[92:95], a[56:59]
    v_mfma_f32_16x16x32_bf16 a[60:63], a[156:159], v[92:95], a[60:63]
    v_and_b32 v183, 0xffff0000, v45
    ds_read_b64_tr_b16 a[82:83], v224 offset:59392
    s_waitcnt vmcnt(8)
    s_nop 0
    v_mfma_f32_16x16x32_bf16 a[0:3], a[160:163], v[96:99], a[0:3]
    ds_read_b64_tr_b16 a[84:85], v225 offset:57344
    v_mfma_f32_16x16x32_bf16 a[4:7], a[164:167], v[96:99], a[4:7]
    v_lshlrev_b32_e64 v168, 16, v54
    s_add_u32 s90, s86, 20480
    v_mfma_f32_16x16x32_bf16 a[8:11], a[168:171], v[96:99], a[8:11]
    ds_read_b64_tr_b16 a[86:87], v225 offset:59392
    v_mfma_f32_16x16x32_bf16 a[12:15], a[172:175], v[96:99], a[12:15]
    v_and_b32 v169, 0xffff0000, v54
    ds_read_b64_tr_b16 a[88:89], v226 offset:57344
    v_mfma_f32_16x16x32_bf16 a[16:19], a[160:163], v[100:103], a[16:19]
    buffer_load_dwordx4 v[80:83], v236, s[36:39], s90 offen sc1
    v_mfma_f32_16x16x32_bf16 a[20:23], a[164:167], v[100:103], a[20:23]
    v_lshlrev_b32_e64 v184, 16, v46
    ds_read_b64_tr_b16 a[90:91], v226 offset:59392
    v_mfma_f32_16x16x32_bf16 a[24:27], a[168:171], v[100:103], a[24:27]
    ds_read_b64_tr_b16 a[92:93], v227 offset:57344
    v_mfma_f32_16x16x32_bf16 a[28:31], a[172:175], v[100:103], a[28:31]
    v_and_b32 v185, 0xffff0000, v46
    buffer_load_dwordx4 v[84:87], v237, s[36:39], s90 offen sc1
    v_mfma_f32_16x16x32_bf16 a[32:35], a[160:163], v[104:107], a[32:35]
    ds_read_b64_tr_b16 a[94:95], v227 offset:59392
    v_mfma_f32_16x16x32_bf16 a[36:39], a[164:167], v[104:107], a[36:39]
    v_lshlrev_b32_e64 v170, 16, v55
    ds_read_b64_tr_b16 a[96:97], v228 offset:8192
    v_mfma_f32_16x16x32_bf16 a[40:43], a[168:171], v[104:107], a[40:43]
    buffer_load_dwordx4 v[88:91], v238, s[36:39], s90 offen sc1
    ds_read_b64_tr_b16 a[98:99], v228 offset:10240
    v_mfma_f32_16x16x32_bf16 a[44:47], a[172:175], v[104:107], a[44:47]
    v_and_b32 v171, 0xffff0000, v55
    v_mfma_f32_16x16x32_bf16 a[48:51], a[160:163], v[108:111], a[48:51]
    ds_read_b64_tr_b16 a[100:101], v229 offset:8192
    v_mfma_f32_16x16x32_bf16 a[52:55], a[164:167], v[108:111], a[52:55]
    v_lshlrev_b32_e64 v186, 16, v47
    buffer_load_dwordx4 v[92:95], v239, s[36:39], s90 offen sc1
    ds_read_b64_tr_b16 a[102:103], v229 offset:10240
    v_mfma_f32_16x16x32_bf16 a[56:59], a[168:171], v[108:111], a[56:59]
    v_mfma_f32_16x16x32_bf16 a[60:63], a[172:175], v[108:111], a[60:63]
    v_and_b32 v187, 0xffff0000, v47
    ds_read_b64_tr_b16 a[104:105], v230 offset:8192
    s_waitcnt vmcnt(8)
    s_cmp_eq_u32 s69, 0
    s_cbranch_scc0 SW_7
    v_swap_b32 v114, v116
    v_swap_b32 v115, v117
    v_swap_b32 v122, v124
    v_swap_b32 v123, v125
    s_branch SW_7_e
SW_7:
    v_swap_b32 v112, v118
    v_swap_b32 v113, v119
    v_swap_b32 v120, v126
    v_swap_b32 v121, v127
SW_7_e:
    s_nop 1
    s_nop 0
    v_mfma_f32_16x16x32_bf16 a[0:3], a[176:179], v[112:115], a[0:3]
    ds_read_b64_tr_b16 a[106:107], v230 offset:10240
    v_mfma_f32_16x16x32_bf16 a[4:7], a[180:183], v[112:115], a[4:7]
    v_lshlrev_b32_e64 v172, 16, v56
    s_add_u32 s90, s86, 24576
    v_mfma_f32_16x16x32_bf16 a[8:11], a[184:187], v[112:115], a[8:11]
    ds_read_b64_tr_b16 a[108:109], v231 offset:8192
    v_mfma_f32_16x16x32_bf16 a[12:15], a[188:191], v[112:115], a[12:15]
    v_and_b32 v173, 0xffff0000, v56
    ds_read_b64_tr_b16 a[110:111], v231 offset:10240
    v_mfma_f32_16x16x32_bf16 a[16:19], a[176:179], v[116:119], a[16:19]
    buffer_load_dwordx4 v[96:99], v236, s[36:39], s90 offen sc1
    v_mfma_f32_16x16x32_bf16 a[20:23], a[180:183], v[116:119], a[20:23]
    v_lshlrev_b32_e64 v188, 16, v48
    ds_read_b64_tr_b16 a[112:113], v232 offset:24576
    v_mfma_f32_16x16x32_bf16 a[24:27], a[184:187], v[116:119], a[24:27]
    ds_read_b64_tr_b16 a[114:115], v232 offset:26624
    v_mfma_f32_16x16x32_bf16 a[28:31], a[188:191], v[116:119], a[28:31]
    v_and_b32 v189, 0xffff0000, v48
    buffer_load_dwordx4 v[100:103], v237, s[36:39], s90 offen sc1
    v_mfma_f32_16x16x32_bf16 a[32:35], a[176:179], v[120:123], a[32:35]
    ds_read_b64_tr_b16 a[116:117], v233 offset:24576
    v_mfma_f32_16x16x32_bf16 a[36:39], a[180:183], v[120:123], a[36:39]
    v_lshlrev_b32_e64 v174, 16, v57
    ds_read_b64_tr_b16 a[118:119], v233 offset:26624
    v_mfma_f32_16x16x32_bf16 a[40:43], a[184:187], v[120:123], a[40:43]
    buffer_load_dwordx4 v[104:107], v238, s[36:39], s90 offen sc1
    ds_read_b64_tr_b16 a[120:121], v234 offset:24576
    v_mfma_f32_16x16x32_bf16 a[44:47], a[188:191], v[120:123], a[44:47]
    v_and_b32 v175, 0xffff0000, v57
    v_mfma_f32_16x16x32_bf16 a[48:51], a[176:179], v[124:127], a[48:51]
    ds_read_b64_tr_b16 a[122:123], v234 offset:26624
    v_mfma_f32_16x16x32_bf16 a[52:55], a[180:183], v[124:127], a[52:55]
    v_lshlrev_b32_e64 v190, 16, v49
    buffer_load_dwordx4 v[108:111], v239, s[36:39], s90 offen sc1
    ds_read_b64_tr_b16 a[124:125], v235 offset:24576
    v_mfma_f32_16x16x32_bf16 a[56:59], a[184:187], v[124:127], a[56:59]
    v_mfma_f32_16x16x32_bf16 a[60:63], a[188:191], v[124:127], a[60:63]
    v_and_b32 v191, 0xffff0000, v49
    ds_read_b64_tr_b16 a[126:127], v235 offset:26624
    buffer_load_dwordx2 v[6:7], v60, s[36:39], 0 offen sc1
    s_waitcnt vmcnt(9)
    s_nop 0
    v_mfma_f32_16x16x32_bf16 a[0:3], a[192:195], v[64:67], a[0:3]
    v_lshlrev_b32_e64 v8, 4, v1
    ds_read_b64_tr_b16 a[128:129], v224 offset:32768
    v_mfma_f32_16x16x32_bf16 a[4:7], a[196:199], v[64:67], a[4:7]
    s_add_u32 s90, s86, 28672
    v_add_u32 v8, 81920, v8
    v_mfma_f32_16x16x32_bf16 a[8:11], a[200:203], v[64:67], a[8:11]
    ds_read_b64_tr_b16 a[130:131], v224 offset:34816
    v_mfma_f32_16x16x32_bf16 a[12:15], a[204:207], v[64:67], a[12:15]
    s_lshl_b32 s75, s60, 14
    s_nop 0
    v_mfma_f32_16x16x32_bf16 a[16:19], a[192:195], v[68:71], a[16:19]
    ds_read_b64_tr_b16 a[132:133], v225 offset:32768
    s_xor_b32 s74, s60, 1
    s_nop 0
    buffer_load_dwordx4 v[112:115], v236, s[36:39], s90 offen sc1
    v_mfma_f32_16x16x32_bf16 a[20:23], a[196:199], v[68:71], a[20:23]
    s_lshl_b32 s76, s74, 14
    s_nop 0
    ds_read_b64_tr_b16 a[134:135], v225 offset:34816
    v_mfma_f32_16x16x32_bf16 a[24:27], a[200:203], v[68:71], a[24:27]
    s_add_u32 s76, s76, s82
    s_nop 0
    v_mfma_f32_16x16x32_bf16 a[28:31], a[204:207], v[68:71], a[28:31]
    ds_read_b64_tr_b16 a[136:137], v226 offset:32768
    buffer_load_dwordx4 v[116:119], v237, s[36:39], s90 offen sc1
    v_mfma_f32_16x16x32_bf16 a[32:35], a[192:195], v[72:75], a[32:35]
    v_add_u32_e64 v2, s76, v8
    ds_read_b64_tr_b16 a[138:139], v226 offset:34816
    v_mfma_f32_16x16x32_bf16 a[36:39], a[196:199], v[72:75], a[36:39]
    s_lshl_b32 s74, s74, 12
    s_nop 0
    v_mfma_f32_16x16x32_bf16 a[40:43], a[200:203], v[72:75], a[40:43]
    ds_read_b64_tr_b16 a[140:141], v227 offset:32768
    s_add_u32 s74, s74, s75
    s_nop 0
    buffer_load_dwordx4 v[120:123], v238, s[36:39], s90 offen sc1
    v_mfma_f32_16x16x32_bf16 a[44:47], a[204:207], v[72:75], a[44:47]
    v_add_u32_e64 v3, s74, v8
    v_mfma_f32_16x16x32_bf16 a[48:51], a[192:195], v[76:79], a[48:51]
    ds_read_b64_tr_b16 a[142:143], v227 offset:34816
    s_xor_b32 s74, s60, 2
    s_nop 0
    v_mfma_f32_16x16x32_bf16 a[52:55], a[196:199], v[76:79], a[52:55]
    ds_read_b64_tr_b16 a[144:145], v224 offset:49152
    buffer_load_dwordx4 v[124:127], v239, s[36:39], s90 offen sc1
    v_mfma_f32_16x16x32_bf16 a[56:59], a[200:203], v[76:79], a[56:59]
    s_lshl_b32 s76, s74, 14
    s_nop 0
    v_mfma_f32_16x16x32_bf16 a[60:63], a[204:207], v[76:79], a[60:63]
    ds_read_b64_tr_b16 a[146:147], v224 offset:51200
    s_add_u32 s76, s76, s82
    s_waitcnt vmcnt(9)
    v_mfma_f32_16x16x32_bf16 a[0:3], a[208:211], v[80:83], a[0:3]
    v_add_u32_e64 v9, s76, v8
    ds_read_b64_tr_b16 a[148:149], v225 offset:49152
    v_mfma_f32_16x16x32_bf16 a[4:7], a[212:215], v[80:83], a[4:7]
    s_add_u32 s90, s86, 32768
    s_lshl_b32 s74, s74, 12
    s_nop 0
    v_mfma_f32_16x16x32_bf16 a[8:11], a[216:219], v[80:83], a[8:11]
    ds_read_b64_tr_b16 a[150:151], v225 offset:51200
    v_mfma_f32_16x16x32_bf16 a[12:15], a[220:223], v[80:83], a[12:15]
    s_add_u32 s74, s74, s75
    s_nop 0
    ds_read_b64_tr_b16 a[152:153], v226 offset:49152
    v_mfma_f32_16x16x32_bf16 a[16:19], a[208:211], v[84:87], a[16:19]
    v_add_u32_e64 v4, s74, v8
    buffer_load_dwordx4 v[64:67], v236, s[36:39], s90 offen sc1
    v_mfma_f32_16x16x32_bf16 a[20:23], a[212:215], v[84:87], a[20:23]
    ds_read_b64_tr_b16 a[154:155], v226 offset:51200
    s_xor_b32 s74, s60, 3
    s_nop 0
    v_mfma_f32_16x16x32_bf16 a[24:27], a[216:219], v[84:87], a[24:27]
    ds_read_b64_tr_b16 a[156:157], v227 offset:49152
    s_lshl_b32 s76, s74, 14
    s_nop 0
    v_mfma_f32_16x16x32_bf16 a[28:31], a[220:223], v[84:87], a[28:31]
    buffer_load_dwordx4 v[68:71], v237, s[36:39], s90 offen sc1
    v_mfma_f32_16x16x32_bf16 a[32:35], a[208:211], v[88:91], a[32:35]
    s_add_u32 s76, s76, s82
    s_nop 0
    ds_read_b64_tr_b16 a[158:159], v227 offset:51200
    v_mfma_f32_16x16x32_bf16 a[36:39], a[212:215], v[88:91], a[36:39]
    v_add_u32_e64 v61, s76, v8
    ds_read_b64_tr_b16 a[160:161], v228 offset:0
    v_mfma_f32_16x16x32_bf16 a[40:43], a[216:219], v[88:91], a[40:43]
    s_lshl_b32 s74, s74, 12
    s_nop 0
    buffer_load_dwordx4 v[72:75], v238, s[36:39], s90 offen sc1
    ds_read_b64_tr_b16 a[162:163], v228 offset:2048
    v_mfma_f32_16x16x32_bf16 a[44:47], a[220:223], v[88:91], a[44:47]
    s_add_u32 s74, s74, s75
    s_nop 0
    v_mfma_f32_16x16x32_bf16 a[48:51], a[208:211], v[92:95], a[48:51]
    ds_read_b64_tr_b16 a[164:165], v229 offset:0
    v_add_u32_e64 v5, s74, v8
    v_mfma_f32_16x16x32_bf16 a[52:55], a[212:215], v[92:95], a[52:55]
    buffer_load_dwordx4 v[76:79], v239, s[36:39], s90 offen sc1
    ds_read_b64_tr_b16 a[166:167], v229 offset:2048
    v_mfma_f32_16x16x32_bf16 a[56:59], a[216:219], v[92:95], a[56:59]
    s_mov_b32 s76, 0xbfb8aa3b
    v_mfma_f32_16x16x32_bf16 a[60:63], a[220:223], v[92:95], a[60:63]
    ds_read_b64_tr_b16 a[168:169], v230 offset:0
    s_mov_b32 s77, 0xbfb8aa3b
    s_waitcnt vmcnt(9)
    s_waitcnt vmcnt(8)
SP3_8:
    v_cmp_ne_u64 vcc, s[66:67], v[6:7]
    s_and_b64 vcc, vcc, s[88:89]
    s_cbranch_vccz SP3_8_ok
    s_sleep 1
    buffer_load_dwordx2 v[6:7], v60, s[36:39], 0 offen sc1
    s_waitcnt vmcnt(0)
    s_branch SP3_8
SP3_8_ok:
    v_mfma_f32_16x16x32_bf16 a[0:3], a[224:227], v[96:99], a[0:3]
    ds_read_b64_tr_b16 a[170:171], v230 offset:2048
    v_mfma_f32_16x16x32_bf16 a[4:7], a[228:231], v[96:99], a[4:7]
    s_add_u32 s90, s10, 32768
    buffer_load_dwordx4 v[80:83], v63, s[36:39], s90 offen sc1
    v_mfma_f32_16x16x32_bf16 a[8:11], a[232:235], v[96:99], a[8:11]
    ds_read_b64_tr_b16 a[172:173], v231 offset:0
    v_mfma_f32_16x16x32_bf16 a[12:15], a[236:239], v[96:99], a[12:15]
    ds_read_b64_tr_b16 a[174:175], v231 offset:2048
    v_mfma_f32_16x16x32_bf16 a[16:19], a[224:227], v[100:103], a[16:19]
    v_mfma_f32_16x16x32_bf16 a[20:23], a[228:231], v[100:103], a[20:23]
    ds_read_b64_tr_b16 a[176:177], v232 offset:16384
    s_add_u32 s90, s10, 36864
    buffer_load_dwordx4 v[84:87], v63, s[36:39], s90 offen sc1
    v_mfma_f32_16x16x32_bf16 a[24:27], a[232:235], v[100:103], a[24:27]
    ds_read_b64_tr_b16 a[178:179], v232 offset:18432
    v_mfma_f32_16x16x32_bf16 a[28:31], a[236:239], v[100:103], a[28:31]
    v_mfma_f32_16x16x32_bf16 a[32:35], a[224:227], v[104:107], a[32:35]
    ds_read_b64_tr_b16 a[180:181], v233 offset:16384
    v_mfma_f32_16x16x32_bf16 a[36:39], a[228:231], v[104:107], a[36:39]
    ds_read_b64_tr_b16 a[182:183], v233 offset:18432
    s_add_u32 s90, s10, 40960
    buffer_load_dwordx4 v[88:91], v63, s[36:39], s90 offen sc1
    v_mfma_f32_16x16x32_bf16 a[40:43], a[232:235], v[104:107], a[40:43]
    ds_read_b64_tr_b16 a[184:185], v234 offset:16384
    v_mfma_f32_16x16x32_bf16 a[44:47], a[236:239], v[104:107], a[44:47]
    v_mfma_f32_16x16x32_bf16 a[48:51], a[224:227], v[108:111], a[48:51]
    ds_read_b64_tr_b16 a[186:187], v234 offset:18432
    v_mfma_f32_16x16x32_bf16 a[52:55], a[228:231], v[108:111], a[52:55]
    s_add_u32 s90, s10, 45056
    buffer_load_dwordx4 v[92:95], v63, s[36:39], s90 offen sc1
    ds_read_b64_tr_b16 a[188:189], v235 offset:16384
    v_mfma_f32_16x16x32_bf16 a[56:59], a[232:235], v[108:111], a[56:59]
    v_mfma_f32_16x16x32_bf16 a[60:63], a[236:239], v[108:111], a[60:63]
    ds_read_b64_tr_b16 a[190:191], v235 offset:18432
    s_waitcnt vmcnt(8)
    s_nop 0
    v_mfma_f32_16x16x32_bf16 a[0:3], a[240:243], v[112:115], a[0:3]
    ds_read_b64_tr_b16 v[10:11], v244 offset:16384
    v_mfma_f32_16x16x32_bf16 a[4:7], a[244:247], v[112:115], a[4:7]
    ds_read_b64_tr_b16 v[12:13], v244 offset:18432
    s_add_u32 s90, s10, 0
    s_nop 0
    buffer_load_dwordx4 v[96:99], v63, s[36:39], s90 offen sc1
    v_mfma_f32_16x16x32_bf16 a[8:11], a[248:251], v[112:115], a[8:11]
    ds_read_b64_tr_b16 v[14:15], v245 offset:16384
    v_mfma_f32_16x16x32_bf16 a[12:15], a[252:255], v[112:115], a[12:15]
    ds_read_b64_tr_b16 v[16:17], v245 offset:18432
    v_mfma_f32_16x16x32_bf16 a[16:19], a[240:243], v[116:119], a[16:19]
    ds_read_b64_tr_b16 v[18:19], v246 offset:16384
    v_mfma_f32_16x16x32_bf16 a[20:23], a[244:247], v[116:119], a[20:23]
    ds_read_b64_tr_b16 v[20:21], v246 offset:18432
    s_add_u32 s90, s10, 4096
    buffer_load_dwordx4 v[100:103], v63, s[36:39], s90 offen sc1
    v_mfma_f32_16x16x32_bf16 a[24:27], a[248:251], v[116:119], a[24:27]
    ds_read_b64_tr_b16 v[22:23], v247 offset:16384
    v_mfma_f32_16x16x32_bf16 a[28:31], a[252:255], v[116:119], a[28:31]
    ds_read_b64_tr_b16 v[24:25], v247 offset:18432
    v_mfma_f32_16x16x32_bf16 a[32:35], a[240:243], v[120:123], a[32:35]
    v_mfma_f32_16x16x32_bf16 a[36:39], a[244:247], v[120:123], a[36:39]
    s_add_u32 s90, s10, 8192
    buffer_load_dwordx4 v[104:107], v63, s[36:39], s90 offen sc1
    v_mfma_f32_16x16x32_bf16 a[40:43], a[248:251], v[120:123], a[40:43]
    v_mfma_f32_16x16x32_bf16 a[44:47], a[252:255], v[120:123], a[44:47]
    v_mfma_f32_16x16x32_bf16 a[48:51], a[240:243], v[124:127], a[48:51]
    v_mfma_f32_16x16x32_bf16 a[52:55], a[244:247], v[124:127], a[52:55]
    s_add_u32 s90, s10, 12288
    buffer_load_dwordx4 v[108:111], v63, s[36:39], s90 offen sc1
    v_mfma_f32_16x16x32_bf16 a[56:59], a[248:251], v[124:127], a[56:59]
    v_mfma_f32_16x16x32_bf16 a[60:63], a[252:255], v[124:127], a[60:63]
    s_waitcnt vmcnt(8) lgkmcnt(0)
    s_nop 0
    v_mfma_f32_16x16x32_bf16 a[0:3], v[10:13], v[64:67], a[0:3]
    ds_read_b64_tr_b16 v[26:27], v244 offset:32768
    v_mfma_f32_16x16x32_bf16 a[4:7], v[14:17], v[64:67], a[4:7]
    ds_read_b64_tr_b16 v[28:29], v244 offset:34816
    s_add_u32 s90, s86, 36864
    v_mfma_f32_16x16x32_bf16 a[8:11], v[18:21], v[64:67], a[8:11]
    ds_read_b64_tr_b16 v[30:31], v245 offset:32768
    v_mfma_f32_16x16x32_bf16 a[12:15], v[22:25], v[64:67], a[12:15]
    ds_read_b64_tr_b16 v[32:33], v245 offset:34816
    v_mfma_f32_16x16x32_bf16 a[16:19], v[10:13], v[68:71], a[16:19]
    ds_read_b64_tr_b16 v[34:35], v246 offset:32768
    buffer_load_dwordx4 v[112:115], v236, s[36:39], s90 offen sc1
    v_mfma_f32_16x16x32_bf16 a[20:23], v[14:17], v[68:71], a[20:23]
    ds_read_b64_tr_b16 v[36:37], v246 offset:34816
    v_mfma_f32_16x16x32_bf16 a[24:27], v[18:21], v[68:71], a[24:27]
    ds_read_b64_tr_b16 v[38:39], v247 offset:32768
    ds_read_b64_tr_b16 a[192:193], v224 offset:36864
    v_mfma_f32_16x16x32_bf16 a[28:31], v[22:25], v[68:71], a[28:31]
    ds_read_b64_tr_b16 v[40:41], v247 offset:34816
    buffer_load_dwordx4 v[116:119], v237, s[36:39], s90 offen sc1
    ds_read_b64_tr_b16 a[194:195], v224 offset:38912
    v_mfma_f32_16x16x32_bf16 a[32:35], v[10:13], v[72:75], a[32:35]
    ds_read_b64_tr_b16 a[196:197], v225 offset:36864
    v_mfma_f32_16x16x32_bf16 a[36:39], v[14:17], v[72:75], a[36:39]
    ds_read_b64_tr_b16 a[198:199], v225 offset:38912
    v_mfma_f32_16x16x32_bf16 a[40:43], v[18:21], v[72:75], a[40:43]
    buffer_load_dwordx4 v[120:123], v238, s[36:39], s90 offen sc1
    ds_read_b64_tr_b16 a[200:201], v226 offset:36864
    v_mfma_f32_16x16x32_bf16 a[44:47], v[22:25], v[72:75], a[44:47]
    ds_read_b64_tr_b16 a[202:203], v226 offset:38912
    v_mfma_f32_16x16x32_bf16 a[48:51], v[10:13], v[76:79], a[48:51]
    ds_read_b64_tr_b16 a[204:205], v227 offset:36864
    v_mfma_f32_16x16x32_bf16 a[52:55], v[14:17], v[76:79], a[52:55]
    ds_read_b64_tr_b16 a[206:207], v227 offset:38912
    buffer_load_dwordx4 v[124:127], v239, s[36:39], s90 offen sc1
    v_mfma_f32_16x16x32_bf16 a[56:59], v[18:21], v[76:79], a[56:59]
    ds_read_b64_tr_b16 a[208:209], v224 offset:53248
    v_mfma_f32_16x16x32_bf16 a[60:63], v[22:25], v[76:79], a[60:63]
    ds_read_b64_tr_b16 a[210:211], v224 offset:55296
    s_waitcnt vmcnt(8) lgkmcnt(0)
    s_nop 0
    v_mfma_f32_16x16x32_bf16 v[192:195], a[64:67], v[80:83], 0
    v_mfma_f32_16x16x32_bf16 v[196:199], a[68:71], v[80:83], 0
    s_add_u32 s90, s86, 40960
    v_mfma_f32_16x16x32_bf16 v[200:203], a[72:75], v[80:83], 0
    v_mfma_f32_16x16x32_bf16 v[204:207], a[76:79], v[80:83], 0
    v_mfma_f32_16x16x32_bf16 v[192:195], a[80:83], v[84:87], v[192:195]
    buffer_load_dwordx4 v[64:67], v236, s[36:39], s90 offen sc1
    v_mfma_f32_16x16x32_bf16 v[196:199], a[84:87], v[84:87], v[196:199]
    v_mfma_f32_16x16x32_bf16 v[200:203], a[88:91], v[84:87], v[200:203]
    ds_read_b64_tr_b16 a[212:213], v225 offset:53248
    v_mfma_f32_16x16x32_bf16 v[204:207], a[92:95], v[84:87], v[204:207]
    buffer_load_dwordx4 v[68:71], v237, s[36:39], s90 offen sc1
    ds_read_b64_tr_b16 a[214:215], v225 offset:55296
    v_mfma_f32_16x16x32_bf16 v[192:195], a[96:99], v[88:91], v[192:195]
    ds_read_b64_tr_b16 a[216:217], v226 offset:53248
    v_mfma_f32_16x16x32_bf16 v[196:199], a[100:103], v[88:91], v[196:199]
    ds_read_b64_tr_b16 a[218:219], v226 offset:55296
    v_mfma_f32_16x16x32_bf16 v[200:203], a[104:107], v[88:91], v[200:203]
    ds_read_b64_tr_b16 a[220:221], v227 offset:53248
    buffer_load_dwordx4 v[72:75], v238, s[36:39], s90 offen sc1
    v_mfma_f32_16x16x32_bf16 v[204:207], a[108:111], v[88:91], v[204:207]
    ds_read_b64_tr_b16 a[222:223], v227 offset:55296
    v_mfma_f32_16x16x32_bf16 v[192:195], a[112:115], v[92:95], v[192:195]
    ds_read_b64_tr_b16 a[224:225], v228 offset:4096
    ds_read_b64_tr_b16 a[226:227], v228 offset:6144
    v_mfma_f32_16x16x32_bf16 v[196:199], a[116:119], v[92:95], v[196:199]
    buffer_load_dwordx4 v[76:79], v239, s[36:39], s90 offen sc1
    ds_read_b64_tr_b16 a[228:229], v229 offset:4096
    v_mfma_f32_16x16x32_bf16 v[200:203], a[120:123], v[92:95], v[200:203]
    ds_read_b64_tr_b16 a[230:231], v229 offset:6144
    v_mfma_f32_16x16x32_bf16 v[204:207], a[124:127], v[92:95], v[204:207]
    ds_read_b64_tr_b16 a[232:233], v230 offset:4096
    s_waitcnt vmcnt(8) lgkmcnt(0)
    s_nop 0
    v_mfma_f32_16x16x32_bf16 v[192:195], a[128:131], v[96:99], v[192:195]
    v_mfma_f32_16x16x32_bf16 v[196:199], a[132:135], v[96:99], v[196:199]
    s_add_u32 s90, s86, 45056
    v_mfma_f32_16x16x32_bf16 v[200:203], a[136:139], v[96:99], v[200:203]
    v_mfma_f32_16x16x32_bf16 v[204:207], a[140:143], v[96:99], v[204:207]
    v_mfma_f32_16x16x32_bf16 v[192:195], a[144:147], v[100:103], v[192:195]
    buffer_load_dwordx4 v[80:83], v236, s[36:39], s90 offen sc1
    v_mfma_f32_16x16x32_bf16 v[196:199], a[148:151], v[100:103], v[196:199]
    v_mfma_f32_16x16x32_bf16 v[200:203], a[152:155], v[100:103], v[200:203]
    ds_read_b64_tr_b16 a[234:235], v230 offset:6144
    v_mfma_f32_16x16x32_bf16 v[204:207], a[156:159], v[100:103], v[204:207]
    buffer_load_dwordx4 v[84:87], v237, s[36:39], s90 offen sc1
    ds_read_b64_tr_b16 a[236:237], v231 offset:4096
    v_mfma_f32_16x16x32_bf16 v[192:195], a[160:163], v[104:107], v[192:195]
    ds_read_b64_tr_b16 a[238:239], v231 offset:6144
    v_mfma_f32_16x16x32_bf16 v[196:199], a[164:167], v[104:107], v[196:199]
    ds_read_b64_tr_b16 a[240:241], v232 offset:20480
    v_mfma_f32_16x16x32_bf16 v[200:203], a[168:171], v[104:107], v[200:203]
    ds_read_b64_tr_b16 a[242:243], v232 offset:22528
    buffer_load_dwordx4 v[88:91], v238, s[36:39], s90 offen sc1
    v_mfma_f32_16x16x32_bf16 v[204:207], a[172:175], v[104:107], v[204:207]
    ds_read_b64_tr_b16 a[244:245], v233 offset:20480
    v_mfma_f32_16x16x32_bf16 v[192:195], a[176:179], v[108:111], v[192:195]
    ds_read_b64_tr_b16 a[246:247], v233 offset:22528
    ds_read_b64_tr_b16 a[248:249], v234 offset:20480
    v_mfma_f32_16x16x32_bf16 v[196:199], a[180:183], v[108:111], v[196:199]
    buffer_load_dwordx4 v[92:95], v239, s[36:39], s90 offen sc1
    ds_read_b64_tr_b16 a[250:251], v234 offset:22528
    v_mfma_f32_16x16x32_bf16 v[200:203], a[184:187], v[108:111], v[200:203]
    ds_read_b64_tr_b16 a[252:253], v235 offset:20480
    v_mfma_f32_16x16x32_bf16 v[204:207], a[188:191], v[108:111], v[204:207]
    ds_read_b64_tr_b16 a[254:255], v235 offset:22528
    s_waitcnt vmcnt(8) lgkmcnt(0)
    s_nop 0
    v_mfma_f32_16x16x32_bf16 a[0:3], v[26:29], v[112:115], a[0:3]
    ds_read_b64_tr_b16 v[10:11], v244 offset:49152
    v_mfma_f32_16x16x32_bf16 a[4:7], v[30:33], v[112:115], a[4:7]
    ds_read_b64_tr_b16 v[12:13], v244 offset:51200
    s_add_u32 s90, s86, 49152
    v_mfma_f32_16x16x32_bf16 a[8:11], v[34:37], v[112:115], a[8:11]
    ds_read_b64_tr_b16 v[14:15], v245 offset:49152
    v_mfma_f32_16x16x32_bf16 a[12:15], v[38:41], v[112:115], a[12:15]
    ds_read_b64_tr_b16 v[16:17], v245 offset:51200
    v_mfma_f32_16x16x32_bf16 a[16:19], v[26:29], v[116:119], a[16:19]
    ds_read_b64_tr_b16 v[18:19], v246 offset:49152
    buffer_load_dwordx4 v[96:99], v236, s[36:39], s90 offen sc1
    v_mfma_f32_16x16x32_bf16 a[20:23], v[30:33], v[116:119], a[20:23]
    ds_read_b64_tr_b16 v[20:21], v246 offset:51200
    v_mfma_f32_16x16x32_bf16 a[24:27], v[34:37], v[116:119], a[24:27]
    ds_read_b64_tr_b16 v[22:23], v247 offset:49152
    v_mfma_f32_16x16x32_bf16 a[28:31], v[38:41], v[116:119], a[28:31]
    ds_read_b64_tr_b16 a[64:65], v224 offset:45056
    ds_read_b64_tr_b16 v[24:25], v247 offset:51200
    buffer_load_dwordx4 v[100:103], v237, s[36:39], s90 offen sc1
    v_mfma_f32_16x16x32_bf16 a[32:35], v[26:29], v[120:123], a[32:35]
    ds_read_b64_tr_b16 a[66:67], v224 offset:47104
    v_mfma_f32_16x16x32_bf16 a[36:39], v[30:33], v[120:123], a[36:39]
    ds_read_b64_tr_b16 a[68:69], v225 offset:45056
    v_mfma_f32_16x16x32_bf16 a[40:43], v[34:37], v[120:123], a[40:43]
    ds_read_b64_tr_b16 a[70:71], v225 offset:47104
    buffer_load_dwordx4 v[104:107], v238, s[36:39], s90 offen sc1
    v_mfma_f32_16x16x32_bf16 a[44:47], v[38:41], v[120:123], a[44:47]
    ds_read_b64_tr_b16 a[72:73], v226 offset:45056
    v_mfma_f32_16x16x32_bf16 a[48:51], v[26:29], v[124:127], a[48:51]
    v_mfma_f32_16x16x32_bf16 a[52:55], v[30:33], v[124:127], a[52:55]
    ds_read_b64_tr_b16 a[74:75], v226 offset:47104
    buffer_load_dwordx4 v[108:111], v239, s[36:39], s90 offen sc1
    v_mfma_f32_16x16x32_bf16 a[56:59], v[34:37], v[124:127], a[56:59]
    ds_read_b64_tr_b16 a[76:77], v227 offset:45056
    v_mfma_f32_16x16x32_bf16 a[60:63], v[38:41], v[124:127], a[60:63]
    ds_read_b64_tr_b16 a[78:79], v227 offset:47104
    s_waitcnt vmcnt(8) lgkmcnt(0)
    s_cmp_eq_u32 s69, 0
    s_cbranch_scc0 SW_9
    v_swap_b32 v66, v68
    v_swap_b32 v67, v69
    v_swap_b32 v74, v76
    v_swap_b32 v75, v77
    s_branch SW_9_e
SW_9:
    v_swap_b32 v64, v70
    v_swap_b32 v65, v71
    v_swap_b32 v72, v78
    v_swap_b32 v73, v79
SW_9_e:
    s_nop 1
    s_nop 0
    v_mfma_f32_16x16x32_bf16 a[0:3], v[10:13], v[64:67], a[0:3]
    ds_read_b64_tr_b16 v[26:27], v248 offset:0
    v_mfma_f32_16x16x32_bf16 a[4:7], v[14:17], v[64:67], a[4:7]
    ds_read_b64_tr_b16 v[28:29], v248 offset:2048
    s_add_u32 s90, s86, 53248
    v_mfma_f32_16x16x32_bf16 a[8:11], v[18:21], v[64:67], a[8:11]
    ds_read_b64_tr_b16 v[30:31], v249 offset:0
    v_mfma_f32_16x16x32_bf16 a[12:15], v[22:25], v[64:67], a[12:15]
    ds_read_b64_tr_b16 v[32:33], v249 offset:2048
    v_mfma_f32_16x16x32_bf16 a[16:19], v[10:13], v[68:71], a[16:19]
    ds_read_b64_tr_b16 v[34:35], v250 offset:0
    buffer_load_dwordx4 v[112:115], v236, s[36:39], s90 offen sc1
    v_mfma_f32_16x16x32_bf16 a[20:23], v[14:17], v[68:71], a[20:23]
    ds_read_b64_tr_b16 v[36:37], v250 offset:2048
    v_mfma_f32_16x16x32_bf16 a[24:27], v[18:21], v[68:71], a[24:27]
    ds_read_b64_tr_b16 v[38:39], v251 offset:0
    v_mfma_f32_16x16x32_bf16 a[28:31], v[22:25], v[68:71], a[28:31]
    ds_read_b64_tr_b16 a[80:81], v224 offset:61440
    ds_read_b64_tr_b16 v[40:41], v251 offset:2048
    buffer_load_dwordx4 v[116:119], v237, s[36:39], s90 offen sc1
    v_mfma_f32_16x16x32_bf16 a[32:35], v[10:13], v[72:75], a[32:35]
    ds_read_b64_tr_b16 a[82:83], v224 offset:63488
    v_mfma_f32_16x16x32_bf16 a[36:39], v[14:17], v[72:75], a[36:39]
    ds_read_b64_tr_b16 a[84:85], v225 offset:61440
    v_mfma_f32_16x16x32_bf16 a[40:43], v[18:21], v[72:75], a[40:43]
    ds_read_b64_tr_b16 a[86:87], v225 offset:63488
    buffer_load_dwordx4 v[120:123], v238, s[36:39], s90 offen sc1
    v_mfma_f32_16x16x32_bf16 a[44:47], v[22:25], v[72:75], a[44:47]
    ds_read_b64_tr_b16 a[88:89], v226 offset:61440
    v_mfma_f32_16x16x32_bf16 a[48:51], v[10:13], v[76:79], a[48:51]
    v_mfma_f32_16x16x32_bf16 a[52:55], v[14:17], v[76:79], a[52:55]
    ds_read_b64_tr_b16 a[90:91], v226 offset:63488
    buffer_load_dwordx4 v[124:127], v239, s[36:39], s90 offen sc1
    v_mfma_f32_16x16x32_bf16 a[56:59], v[18:21], v[76:79], a[56:59]
    ds_read_b64_tr_b16 a[92:93], v227 offset:61440
    v_mfma_f32_16x16x32_bf16 a[60:63], v[22:25], v[76:79], a[60:63]
    ds_read_b64_tr_b16 a[94:95], v227 offset:63488
    s_waitcnt vmcnt(8) lgkmcnt(0)
    s_nop 0
    v_mfma_f32_16x16x32_bf16 a[0:3], v[26:29], v[80:83], a[0:3]
    ds_read_b64_tr_b16 v[10:11], v240 offset:0
    v_mfma_f32_16x16x32_bf16 a[4:7], v[30:33], v[80:83], a[4:7]
    ds_read_b64_tr_b16 v[12:13], v240 offset:2048
    s_add_u32 s90, s10, 16384
    buffer_load_dwordx4 v[64:67], v63, s[36:39], s90 offen sc1
    v_mfma_f32_16x16x32_bf16 a[8:11], v[34:37], v[80:83], a[8:11]
    ds_read_b64_tr_b16 v[14:15], v241 offset:0
    v_mfma_f32_16x16x32_bf16 a[12:15], v[38:41], v[80:83], a[12:15]
    ds_read_b64_tr_b16 v[16:17], v241 offset:2048
    v_mfma_f32_16x16x32_bf16 a[16:19], v[26:29], v[84:87], a[16:19]
    ds_read_b64_tr_b16 v[18:19], v242 offset:0
    v_mfma_f32_16x16x32_bf16 a[20:23], v[30:33], v[84:87], a[20:23]
    ds_read_b64_tr_b16 v[20:21], v242 offset:2048
    s_add_u32 s90, s10, 20480
    buffer_load_dwordx4 v[68:71], v63, s[36:39], s90 offen sc1
    v_mfma_f32_16x16x32_bf16 a[24:27], v[34:37], v[84:87], a[24:27]
    ds_read_b64_tr_b16 v[22:23], v243 offset:0
    v_mfma_f32_16x16x32_bf16 a[28:31], v[38:41], v[84:87], a[28:31]
    ds_read_b64_tr_b16 a[96:97], v228 offset:12288
    ds_read_b64_tr_b16 v[24:25], v243 offset:2048
    v_mfma_f32_16x16x32_bf16 a[32:35], v[26:29], v[88:91], a[32:35]
    ds_read_b64_tr_b16 a[98:99], v228 offset:14336
    v_mfma_f32_16x16x32_bf16 a[36:39], v[30:33], v[88:91], a[36:39]
    ds_read_b64_tr_b16 a[100:101], v229 offset:12288
    s_add_u32 s90, s10, 24576
    buffer_load_dwordx4 v[72:75], v63, s[36:39], s90 offen sc1
    v_mfma_f32_16x16x32_bf16 a[40:43], v[34:37], v[88:91], a[40:43]
    ds_read_b64_tr_b16 a[102:103], v229 offset:14336
    v_mfma_f32_16x16x32_bf16 a[44:47], v[38:41], v[88:91], a[44:47]
    ds_read_b64_tr_b16 a[104:105], v230 offset:12288
    v_mfma_f32_16x16x32_bf16 a[48:51], v[26:29], v[92:95], a[48:51]
    v_mfma_f32_16x16x32_bf16 a[52:55], v[30:33], v[92:95], a[52:55]
    ds_read_b64_tr_b16 a[106:107], v230 offset:14336
    s_add_u32 s90, s10, 28672
    buffer_load_dwordx4 v[76:79], v63, s[36:39], s90 offen sc1
    v_mfma_f32_16x16x32_bf16 a[56:59], v[34:37], v[92:95], a[56:59]
    ds_read_b64_tr_b16 a[108:109], v231 offset:12288
    v_mfma_f32_16x16x32_bf16 a[60:63], v[38:41], v[92:95], a[60:63]
    ds_read_b64_tr_b16 a[110:111], v231 offset:14336
    s_waitcnt vmcnt(8) lgkmcnt(0)
    s_nop 0
    v_mfma_f32_16x16x32_bf16 a[0:3], v[10:13], v[96:99], a[0:3]
    ds_read_b64_tr_b16 v[26:27], v240 offset:16384
    v_mfma_f32_16x16x32_bf16 a[4:7], v[14:17], v[96:99], a[4:7]
    ds_read_b64_tr_b16 v[28:29], v240 offset:18432
    s_add_u32 s90, s10, 49152
    buffer_load_dwordx4 v[80:83], v63, s[36:39], s90 offen sc1
    v_mfma_f32_16x16x32_bf16 a[8:11], v[18:21], v[96:99], a[8:11]
    ds_read_b64_tr_b16 v[30:31], v241 offset:16384
    v_mfma_f32_16x16x32_bf16 a[12:15], v[22:25], v[96:99], a[12:15]
    ds_read_b64_tr_b16 v[32:33], v241 offset:18432
    v_mfma_f32_16x16x32_bf16 a[16:19], v[10:13], v[100:103], a[16:19]
    ds_read_b64_tr_b16 v[34:35], v242 offset:16384
    v_mfma_f32_16x16x32_bf16 a[20:23], v[14:17], v[100:103], a[20:23]
    ds_read_b64_tr_b16 v[36:37], v242 offset:18432
    s_add_u32 s90, s10, 53248
    buffer_load_dwordx4 v[84:87], v63, s[36:39], s90 offen sc1
    v_mfma_f32_16x16x32_bf16 a[24:27], v[18:21], v[100:103], a[24:27]
    ds_read_b64_tr_b16 v[38:39], v243 offset:16384
    v_mfma_f32_16x16x32_bf16 a[28:31], v[22:25], v[100:103], a[28:31]
    ds_read_b64_tr_b16 a[112:113], v232 offset:28672
    ds_read_b64_tr_b16 v[40:41], v243 offset:18432
    v_mfma_f32_16x16x32_bf16 a[32:35], v[10:13], v[104:107], a[32:35]
    ds_read_b64_tr_b16 a[114:115], v232 offset:30720
    v_mfma_f32_16x16x32_bf16 a[36:39], v[14:17], v[104:107], a[36:39]
    ds_read_b64_tr_b16 a[116:117], v233 offset:28672
    s_add_u32 s90, s10, 57344
    buffer_load_dwordx4 v[88:91], v63, s[36:39], s90 offen sc1
    v_mfma_f32_16x16x32_bf16 a[40:43], v[18:21], v[104:107], a[40:43]
    ds_read_b64_tr_b16 a[118:119], v233 offset:30720
    v_mfma_f32_16x16x32_bf16 a[44:47], v[22:25], v[104:107], a[44:47]
    ds_read_b64_tr_b16 a[120:121], v234 offset:28672
    v_mfma_f32_16x16x32_bf16 a[48:51], v[10:13], v[108:111], a[48:51]
    v_mfma_f32_16x16x32_bf16 a[52:55], v[14:17], v[108:111], a[52:55]
    ds_read_b64_tr_b16 a[122:123], v234 offset:30720
    s_add_u32 s90, s10, 61440
    buffer_load_dwordx4 v[92:95], v63, s[36:39], s90 offen sc1
    v_mfma_f32_16x16x32_bf16 a[56:59], v[18:21], v[108:111], a[56:59]
    ds_read_b64_tr_b16 a[124:125], v235 offset:28672
    v_mfma_f32_16x16x32_bf16 a[60:63], v[22:25], v[108:111], a[60:63]
    ds_read_b64_tr_b16 a[126:127], v235 offset:30720
    s_waitcnt vmcnt(8) lgkmcnt(0)
    s_nop 0
    v_mfma_f32_16x16x32_bf16 a[16:19], v[26:29], v[116:119], a[16:19]
    v_mfma_f32_16x16x32_bf16 a[20:23], v[30:33], v[116:119], a[20:23]
    v_mfma_f32_16x16x32_bf16 a[24:27], v[34:37], v[116:119], a[24:27]
    v_mfma_f32_16x16x32_bf16 a[28:31], v[38:41], v[116:119], a[28:31]
    v_mfma_f32_16x16x32_bf16 a[32:35], v[26:29], v[120:123], a[32:35]
    v_mfma_f32_16x16x32_bf16 a[36:39], v[30:33], v[120:123], a[36:39]
    v_mfma_f32_16x16x32_bf16 a[40:43], v[34:37], v[120:123], a[40:43]
    v_mfma_f32_16x16x32_bf16 a[44:47], v[38:41], v[120:123], a[44:47]
    v_mfma_f32_16x16x32_bf16 a[48:51], v[26:29], v[124:127], a[48:51]
    ds_write_b128 v2, a[16:19] offset:0
    v_mfma_f32_16x16x32_bf16 a[52:55], v[30:33], v[124:127], a[52:55]
    v_mfma_f32_16x16x32_bf16 a[56:59], v[34:37], v[124:127], a[56:59]
    ds_write_b128 v2, a[20:23] offset:1024
    v_mfma_f32_16x16x32_bf16 a[60:63], v[38:41], v[124:127], a[60:63]
    v_mfma_f32_16x16x32_bf16 a[0:3], v[26:29], v[112:115], a[0:3]
    ds_write_b128 v2, a[24:27] offset:2048
    v_mfma_f32_16x16x32_bf16 a[4:7], v[30:33], v[112:115], a[4:7]
    v_mfma_f32_16x16x32_bf16 a[8:11], v[34:37], v[112:115], a[8:11]
    ds_write_b128 v2, a[28:31] offset:3072
    v_mfma_f32_16x16x32_bf16 a[12:15], v[38:41], v[112:115], a[12:15]
    ds_write_b128 v9, a[32:35] offset:0
    s_waitcnt vmcnt(4)
    s_nop 0
    v_mfma_f32_16x16x32_bf16 v[192:195], a[192:195], v[64:67], v[192:195]
    v_mfma_f32_16x16x32_bf16 v[196:199], a[196:199], v[64:67], v[196:199]
    ds_write_b128 v9, a[36:39] offset:1024
    v_mfma_f32_16x16x32_bf16 v[200:203], a[200:203], v[64:67], v[200:203]
    v_mfma_f32_16x16x32_bf16 v[204:207], a[204:207], v[64:67], v[204:207]
    ds_write_b128 v9, a[40:43] offset:2048
    v_mfma_f32_16x16x32_bf16 v[192:195], a[208:211], v[68:71], v[192:195]
    v_mfma_f32_16x16x32_bf16 v[196:199], a[212:215], v[68:71], v[196:199]
    ds_write_b128 v9, a[44:47] offset:3072
    v_mfma_f32_16x16x32_bf16 v[200:203], a[216:219], v[68:71], v[200:203]
    ds_write_b128 v61, a[48:51] offset:0
    v_mfma_f32_16x16x32_bf16 v[204:207], a[220:223], v[68:71], v[204:207]
    v_mfma_f32_16x16x32_bf16 v[192:195], a[224:227], v[72:75], v[192:195]
    v_accvgpr_read_b32 v42, a0
    ds_write_b128 v61, a[52:55] offset:1024
    v_accvgpr_read_b32 v43, a1
    v_accvgpr_read_b32 v44, a2
    v_mfma_f32_16x16x32_bf16 v[196:199], a[228:231], v[72:75], v[196:199]
    v_accvgpr_read_b32 v45, a3
    v_accvgpr_read_b32 v46, a4
    v_accvgpr_read_b32 v47, a5
    v_mfma_f32_16x16x32_bf16 v[200:203], a[232:235], v[72:75], v[200:203]
    v_accvgpr_read_b32 v48, a6
    ds_write_b128 v61, a[56:59] offset:2048
    v_accvgpr_read_b32 v49, a7
    v_accvgpr_read_b32 v50, a8
    v_mfma_f32_16x16x32_bf16 v[204:207], a[236:239], v[72:75], v[204:207]
    v_accvgpr_read_b32 v51, a9
    v_accvgpr_read_b32 v52, a10
    v_accvgpr_read_b32 v53, a11
    ds_write_b128 v61, a[60:63] offset:3072
    v_mfma_f32_16x16x32_bf16 v[192:195], a[240:243], v[76:79], v[192:195]
    v_accvgpr_read_b32 v54, a12
    v_accvgpr_read_b32 v55, a13
    v_accvgpr_read_b32 v56, a14
    v_mfma_f32_16x16x32_bf16 v[196:199], a[244:247], v[76:79], v[196:199]
    v_accvgpr_read_b32 v57, a15
    v_pk_add_f32 v[176:177], v[176:177], v[42:43]
    v_pk_add_f32 v[178:179], v[178:179], v[44:45]
    v_mfma_f32_16x16x32_bf16 v[200:203], a[248:251], v[76:79], v[200:203]
    v_pk_add_f32 v[180:181], v[180:181], v[46:47]
    v_pk_add_f32 v[182:183], v[182:183], v[48:49]
    v_pk_add_f32 v[184:185], v[184:185], v[50:51]
    v_mfma_f32_16x16x32_bf16 v[204:207], a[252:255], v[76:79], v[204:207]
    v_pk_add_f32 v[186:187], v[186:187], v[52:53]
    v_pk_add_f32 v[188:189], v[188:189], v[54:55]
    v_pk_add_f32 v[190:191], v[190:191], v[56:57]
    s_waitcnt lgkmcnt(0)
    s_barrier
    s_waitcnt vmcnt(0)
    s_nop 0
    v_mfma_f32_16x16x32_bf16 v[192:195], a[64:67], v[80:83], v[192:195]
    ds_read_b128 v[42:45], v3 offset:0
    ds_read_b128 v[46:49], v3 offset:1024
    ds_read_b128 v[50:53], v3 offset:2048
    ds_read_b128 v[54:57], v3 offset:3072
    v_mfma_f32_16x16x32_bf16 v[196:199], a[68:71], v[80:83], v[196:199]
    ds_read_b128 v[208:211], v4 offset:0
    ds_read_b128 v[212:215], v4 offset:1024
    ds_read_b128 v[216:219], v4 offset:2048
    ds_read_b128 v[220:223], v4 offset:3072
    v_mfma_f32_16x16x32_bf16 v[200:203], a[72:75], v[80:83], v[200:203]
    ds_read_b128 v[112:115], v5 offset:0
    ds_read_b128 v[116:119], v5 offset:1024
    ds_read_b128 v[120:123], v5 offset:2048
    v_mfma_f32_16x16x32_bf16 v[204:207], a[76:79], v[80:83], v[204:207]
    ds_read_b128 v[124:127], v5 offset:3072
    s_waitcnt lgkmcnt(8)
    s_nop 0
    v_pk_add_f32 v[176:177], v[176:177], v[42:43]
    v_pk_add_f32 v[178:179], v[178:179], v[44:45]
    v_mfma_f32_16x16x32_bf16 v[192:195], a[80:83], v[84:87], v[192:195]
    v_pk_add_f32 v[180:181], v[180:181], v[46:47]
    v_pk_add_f32 v[182:183], v[182:183], v[48:49]
    v_pk_add_f32 v[184:185], v[184:185], v[50:51]
    v_pk_add_f32 v[186:187], v[186:187], v[52:53]
    v_mfma_f32_16x16x32_bf16 v[196:199], a[84:87], v[84:87], v[196:199]
    v_pk_add_f32 v[188:189], v[188:189], v[54:55]
    v_pk_add_f32 v[190:191], v[190:191], v[56:57]
    s_waitcnt lgkmcnt(4)
    s_nop 0
    v_pk_add_f32 v[176:177], v[176:177], v[208:209]
    v_mfma_f32_16x16x32_bf16 v[200:203], a[88:91], v[84:87], v[200:203]
    v_pk_add_f32 v[178:179], v[178:179], v[210:211]
    v_pk_add_f32 v[180:181], v[180:181], v[212:213]
    v_pk_add_f32 v[182:183], v[182:183], v[214:215]
    v_pk_add_f32 v[184:185], v[184:185], v[216:217]
    v_mfma_f32_16x16x32_bf16 v[204:207], a[92:95], v[84:87], v[204:207]
    v_pk_add_f32 v[186:187], v[186:187], v[218:219]
    v_pk_add_f32 v[188:189], v[188:189], v[220:221]
    v_pk_add_f32 v[190:191], v[190:191], v[222:223]
    v_mfma_f32_16x16x32_bf16 v[192:195], a[96:99], v[88:91], v[192:195]
    s_waitcnt lgkmcnt(0)
    s_nop 0
    v_pk_add_f32 v[176:177], v[176:177], v[112:113]
    v_pk_add_f32 v[178:179], v[178:179], v[114:115]
    v_pk_add_f32 v[180:181], v[180:181], v[116:117]
    v_mfma_f32_16x16x32_bf16 v[196:199], a[100:103], v[88:91], v[196:199]
    v_pk_add_f32 v[182:183], v[182:183], v[118:119]
    v_pk_add_f32 v[184:185], v[184:185], v[120:121]
    v_pk_add_f32 v[186:187], v[186:187], v[122:123]
    v_pk_add_f32 v[188:189], v[188:189], v[124:125]
    v_mfma_f32_16x16x32_bf16 v[200:203], a[104:107], v[88:91], v[200:203]
    v_pk_add_f32 v[190:191], v[190:191], v[126:127]
    v_pk_mul_f32 v[208:209], v[176:177], s[76:77]
    v_pk_mul_f32 v[210:211], v[178:179], s[76:77]
    v_pk_mul_f32 v[212:213], v[180:181], s[76:77]
    v_mfma_f32_16x16x32_bf16 v[204:207], a[108:111], v[88:91], v[204:207]
    v_pk_mul_f32 v[214:215], v[182:183], s[76:77]
    v_pk_mul_f32 v[216:217], v[184:185], s[76:77]
    v_pk_mul_f32 v[218:219], v[186:187], s[76:77]
    v_mfma_f32_16x16x32_bf16 v[192:195], a[112:115], v[92:95], v[192:195]
    v_pk_mul_f32 v[220:221], v[188:189], s[76:77]
    v_pk_mul_f32 v[222:223], v[190:191], s[76:77]
    v_exp_f32 v208, v208
    v_exp_f32 v209, v209
    v_mfma_f32_16x16x32_bf16 v[196:199], a[116:119], v[92:95], v[196:199]
    v_exp_f32 v210, v210
    v_exp_f32 v211, v211
    v_exp_f32 v212, v212
    v_exp_f32 v213, v213
    v_mfma_f32_16x16x32_bf16 v[200:203], a[120:123], v[92:95], v[200:203]
    v_exp_f32 v214, v214
    v_exp_f32 v215, v215
    v_exp_f32 v216, v216
    v_exp_f32 v217, v217
    v_mfma_f32_16x16x32_bf16 v[204:207], a[124:127], v[92:95], v[204:207]
    v_exp_f32 v218, v218
    v_exp_f32 v219, v219
    v_exp_f32 v220, v220
    v_exp_f32 v221, v221
    v_exp_f32_e64 v222, v222
    v_exp_f32 v223, v223
    s_nop 0
    v_pk_add_f32 v[208:209], v[208:209], 1.0 op_sel_hi:[1,0]
    v_pk_add_f32 v[210:211], v[210:211], 1.0 op_sel_hi:[1,0]
    v_pk_add_f32 v[212:213], v[212:213], 1.0 op_sel_hi:[1,0]
    v_pk_add_f32 v[214:215], v[214:215], 1.0 op_sel_hi:[1,0]
    v_pk_add_f32 v[216:217], v[216:217], 1.0 op_sel_hi:[1,0]
    v_pk_add_f32 v[218:219], v[218:219], 1.0 op_sel_hi:[1,0]
    v_pk_add_f32 v[220:221], v[220:221], 1.0 op_sel_hi:[1,0]
    v_pk_add_f32 v[222:223], v[222:223], 1.0 op_sel_hi:[1,0]
    v_rcp_f32 v208, v208
    v_rcp_f32 v209, v209
    v_rcp_f32 v210, v210
    v_rcp_f32 v211, v211
    v_rcp_f32 v212, v212
    v_rcp_f32 v213, v213
    v_rcp_f32 v214, v214
    v_rcp_f32 v215, v215
    v_rcp_f32 v216, v216
    v_rcp_f32 v217, v217
    v_rcp_f32 v218, v218
    v_rcp_f32 v219, v219
    v_rcp_f32 v220, v220
    v_rcp_f32 v221, v221
    v_rcp_f32_e64 v222, v222
    v_rcp_f32 v223, v223
    s_nop 0
    v_pk_mul_f32 v[208:209], v[208:209], v[176:177]
    v_pk_mul_f32 v[210:211], v[210:211], v[178:179]
    v_pk_mul_f32 v[212:213], v[212:213], v[180:181]
    v_pk_mul_f32 v[214:215], v[214:215], v[182:183]
    v_pk_mul_f32 v[216:217], v[216:217], v[184:185]
    v_pk_mul_f32 v[218:219], v[218:219], v[186:187]
    v_pk_mul_f32 v[220:221], v[220:221], v[188:189]
    v_pk_mul_f32 v[222:223], v[222:223], v[190:191]
    s_nop 4
    s_nop 0
    v_pk_fma_f32 v[192:193], v[192:193], v[208:209], v[160:161]
    v_pk_fma_f32 v[194:195], v[194:195], v[210:211], v[162:163]
    v_pk_fma_f32 v[196:197], v[196:197], v[212:213], v[164:165]
    v_pk_fma_f32 v[198:199], v[198:199], v[214:215], v[166:167]
    v_cvt_pk_bf16_f32 v42, v192, v193
    v_cvt_pk_bf16_f32 v43, v194, v195
    v_cvt_pk_bf16_f32 v44, v196, v197
    v_cvt_pk_bf16_f32 v45, v198, v199
    s_nop 1
    v_permlane16_swap_b32 v42, v44
    v_permlane16_swap_b32 v43, v45
    s_nop 0
    buffer_store_dwordx4 v[42:45], v58, s[56:59], 0 offen offset:0
    s_nop 0
    s_nop 0
    v_pk_fma_f32 v[200:201], v[200:201], v[216:217], v[168:169]
    v_pk_fma_f32 v[202:203], v[202:203], v[218:219], v[170:171]
    v_pk_fma_f32 v[204:205], v[204:205], v[220:221], v[172:173]
    v_pk_fma_f32 v[206:207], v[206:207], v[222:223], v[174:175]
    v_cvt_pk_bf16_f32 v46, v200, v201
    v_cvt_pk_bf16_f32 v47, v202, v203
    v_cvt_pk_bf16_f32 v48, v204, v205
    v_cvt_pk_bf16_f32 v49, v206, v207
    s_nop 1
    v_permlane16_swap_b32 v46, v48
    v_permlane16_swap_b32 v47, v49
    s_nop 0
    buffer_store_dwordx4 v[46:49], v58, s[56:59], 0 offen offset:64
L_END:
    s_endpgm
L_CODE_END:

.section .rodata,"a"
.p2align 6
.amdhsa_kernel recurrent_scan__sliding_local_dilated__dense_activation_squared_relu__prompt_kernel
  .amdhsa_next_free_vgpr 512
  .amdhsa_next_free_sgpr 102
  .amdhsa_accum_offset 256
  .amdhsa_group_segment_fixed_size 0
  .amdhsa_kernarg_size 88
  .amdhsa_user_sgpr_count 2
  .amdhsa_user_sgpr_kernarg_segment_ptr 1
  .amdhsa_system_sgpr_workgroup_id_x 1
.end_amdhsa_kernel
```
